```python
import torch

def _softmax(x, axis=-1):
    return torch.softmax(x, dim=axis)
def _gelu(x):
    return torch.nn.functional.gelu(x, approximate="tanh")
def _silu(x):
    return torch.nn.functional.silu(x)
def _sigmoid(x):
    return torch.sigmoid(x)
def _layernorm(x, axis=-1, eps=1e-5):
    m = x.mean(dim=axis, keepdim=True)
    v = x.var(dim=axis, keepdim=True, unbiased=False)
    return (x - m) / torch.sqrt(v + eps)
def _scatter_add(tgt, idx, src, axis=0):
    return tgt.clone().index_add_(axis, idx, src)
def _segment_sum(src, seg, n):
    out = torch.zeros((n,) + src.shape[1:], dtype=src.dtype)
    return out.index_add_(0, seg, src)
def _pad(x, pw):
    flat = tuple(v for pair in reversed(pw) for v in pair)
    return torch.nn.functional.pad(x, flat)

kernel_name = 'interleave_layers__sliding_local_dilated__dense_activation_mish__prompt'

def setup_inputs():

    _w = (lambda a: (lambda t: t.to(torch.bfloat16) if t.is_floating_point() else t)(torch.as_tensor(a)))
    def _A_setup():
        B, S, D = 1, 2048, 576
        return {
            "x": _w((lambda *s: torch.randn(*s, dtype=torch.bfloat16) * 0.05)(B, S, D)),
            "wqkv": _w((lambda *s: torch.randn(*s, dtype=torch.bfloat16) * 0.05)(D, 3 * D)),
            "wo": _w((lambda *s: torch.randn(*s, dtype=torch.bfloat16) * 0.05)(D, D)),
        }
    _A_in = _A_setup()

    def _B_setup():
        B, S, D, F = 1, 2048, 576, 4608
        return {
            "x": _w((lambda *s: torch.randn(*s, dtype=torch.bfloat16) * 0.05)(B, S, D)),
            "w1": _w((lambda *s: torch.randn(*s, dtype=torch.bfloat16) * 0.8)(D, F) * (D ** -0.5)),
            "b1": _w((lambda *s: torch.randn(*s, dtype=torch.bfloat16) * 0.8)(F)),
            "w2": _w((lambda *s: torch.randn(*s, dtype=torch.bfloat16) * 0.8)(F, D) * (F ** -0.5)),
        }
    _B_in = _B_setup()

    return {
        "A_x": _A_in["x"],
        "A_wqkv": _A_in["wqkv"],
        "A_wo": _A_in["wo"],
        "B_x": _B_in["x"],
        "B_w1": _B_in["w1"],
        "B_b1": _B_in["b1"],
        "B_w2": _B_in["w2"],
    }

def reference(A_x, A_wqkv, A_wo, B_x, B_w1, B_b1, B_w2):
    def _A_ref(x, wqkv, wo):
        B, S, D = x.shape
        H = 32; Dh = D // H
        W, dil = 8, 2
        qkv = (lambda x, *d: x.permute(*d))((x @ wqkv).reshape(B, S, 3, H, Dh), 2, 0, 3, 1, 4)
        q, k, v = qkv[0], qkv[1], qkv[2]
        scale = Dh ** -0.5
        pos = torch.arange(S)
        off = torch.arange(W) * dil
        idx = pos[:, None] - off[None, :]
        mask = idx >= 0
        idx_c = torch.where(mask, idx, 0).reshape(-1)
        kg = k[:, :, idx_c, :].reshape(B, H, S, W, Dh)
        vg = v[:, :, idx_c, :].reshape(B, H, S, W, Dh)
        logits = torch.einsum("bhsd,bhswd->bhsw", q, kg) * scale
        logits = torch.where(mask[None, None, :, :], logits, -1e9)
        attn = _softmax(logits, axis=-1)
        o = torch.einsum("bhsw,bhswd->bhsd", attn, vg)
        return (lambda x, *d: x.permute(*d))(o, 0, 2, 1, 3).reshape(B, S, D) @ wo

    def _B_ref(x, w1, b1, w2):
        h = torch.einsum("bsd,df->bsf", x, w1) + b1
        sp = torch.log1p(torch.exp(-torch.abs(h))) + torch.where(h > 0, h, torch.zeros_like(h))
        act = h * torch.tanh(sp)
        return torch.einsum("bsf,fd->bsd", act, w2)

    x = A_x
    x = x + _A_ref(_layernorm(x, axis=-1), A_wqkv, A_wo)
    x = x + _B_ref(_layernorm(x, axis=-1), B_w1, B_b1, B_w2)
    x = x + _A_ref(_layernorm(x, axis=-1), A_wqkv, A_wo)
    x = x + _B_ref(_layernorm(x, axis=-1), B_w1, B_b1, B_w2)
    return x
```

```asm
; @launch grid=(256,1,1) block=(256,1,1) lds=163840
.amdgcn_target "amdgcn-amd-amdhsa--gfx950"
.text
.globl interleave_layers__sliding_local_dilated__dense_activation_mish__prompt_kernel
.p2align 8
.type interleave_layers__sliding_local_dilated__dense_activation_mish__prompt_kernel,@function
interleave_layers__sliding_local_dilated__dense_activation_mish__prompt_kernel:
    s_cmp_ge_u32 s2, 256
    s_cbranch_scc1 L_main_end
    s_getpc_b64 s[80:81]
L_inte_pc_1:
    s_add_u32 s80, s80, L_code_begin-L_inte_pc_1
    s_addc_u32 s81, s81, 0
    s_mov_b32 s82, L_code_end-L_code_begin
    s_mov_b32 s83, 0x00020000
    s_lshr_b32 s30, s2, 3
    s_lshl_b32 s30, s30, 11
    v_lshl_add_u32 v252, v0, 3, s30
    buffer_load_dword v253, v252, s[80:83], 0 offen
    s_load_dwordx2 s[40:41], s[0:1], 8
    s_load_dwordx2 s[8:9], s[0:1], 0
    s_load_dwordx2 s[4:5], s[0:1], 72
    s_load_dwordx2 s[14:15], s[0:1], 64
    s_load_dwordx2 s[84:85], s[0:1], 32
    s_load_dwordx2 s[88:89], s[0:1], 16
    s_load_dwordx2 s[44:45], s[0:1], 48
    s_load_dwordx2 s[92:93], s[0:1], 40
L_code_begin:
    s_and_b32 s24, s2, 7
    s_lshr_b32 s25, s2, 3
    s_lshr_b32 s16, s24, 2
    s_lshl_b32 s16, s16, 3
    s_lshr_b32 s26, s25, 2
    s_add_u32 s16, s16, s26
    s_and_b32 s17, s24, 3
    s_lshl_b32 s17, s17, 2
    s_and_b32 s26, s25, 3
    s_add_u32 s17, s17, s26
    s_lshr_b32 s18, s17, 2
    s_and_b32 s19, s17, 3
    v_lshrrev_b32 v1, 6, v0
    v_and_b32 v0, 63, v0
    v_readfirstlane_b32 s20, v1
    s_mov_b32 s6, 82968576
    s_mov_b32 s7, 0x00020000
    s_mov_b32 s42, 1990656
    s_mov_b32 s43, 0x00020000
    s_mov_b32 s10, 2359296
    s_mov_b32 s11, 0x00020000
    v_lshlrev_b32 v1, 4, v0
    s_lshl_b32 s28, s16, 12
    s_or_b32 s27, s17, s20
    s_lshl_b32 s30, s16, 2
    s_add_u32 s30, s30, s20
    s_cmp_lt_u32 s30, 63
    s_cselect_b32 s21, 0, 2147483648
    s_lshl_b32 s30, s30, 6
    v_add_u32 v21, s30, v0
    v_mul_u32_u24 v20, 9363, v21
    v_lshrrev_b32 v20, 20, v20
    v_mul_u32_u24 v25, 112, v20
    v_sub_u32 v21, v21, v25
    v_lshrrev_b32 v22, 4, v21
    v_and_b32 v23, 15, v21
    v_cmp_eq_u32 vcc, 4, v22
    v_bfe_u32 v25, v23, 1, 2
    v_lshrrev_b32 v26, 1, v22
    v_min_u32 v26, 2, v26
    v_cndmask_b32 v25, v26, v25, vcc
    v_lshrrev_b32 v26, 2, v22
    v_xor_b32 v26, v26, v22
    v_lshrrev_b32 v27, 3, v23
    v_cndmask_b32 v26, v26, v27, vcc
    v_and_b32 v26, 1, v26
    v_and_or_b32 v27, v23, 1, 16
    v_cndmask_b32 v24, v23, v27, vcc
    v_mad_u32_u24 v24, v26, 18, v24
    v_add_u32 v26, 1, v25
    v_mul_u32_u24 v26, 576, v26
    v_cmp_gt_u32 vcc, 2, v25
    s_mul_i32 s31, s17, 36
    v_mul_u32_u24 v27, 27648, v20
    v_cndmask_b32 v26, 0, v26, vcc
    v_add3_u32 v24, v24, v26, s31
    v_cmp_eq_u32 vcc, 3, v25
    v_add_lshl_u32 v24, v24, v27, 1
    v_mov_b32 v26, 2147483648
    v_or_b32 v24, s21, v24
    v_cndmask_b32 v24, v24, v26, vcc
    s_cmp_lg_u32 s27, 0
    s_cbranch_scc1 L_inte_z_2
    v_mov_b32 v4, 0
    v_mov_b32 v5, 0
    v_mov_b32 v6, 0
    v_mov_b32 v7, 0
    s_waitcnt lgkmcnt(0)
    buffer_store_dwordx4 v[4:7], v1, s[4:7], s28 offen offset:0 sc1
    buffer_store_dwordx4 v[4:7], v1, s[4:7], s28 offen offset:1024 sc1
    buffer_store_dwordx4 v[4:7], v1, s[4:7], s28 offen offset:2048 sc1
    buffer_store_dwordx4 v[4:7], v1, s[4:7], s28 offen offset:3072 sc1
L_inte_z_2:
    v_lshrrev_b32 v56, 3, v0
    v_and_b32 v57, 7, v0
    v_mul_u32_u24 v58, 1152, v56
    v_lshl_add_u32 v58, v57, 4, v58
    s_lshl_b32 s30, s16, 4
    s_add_u32 s30, s30, s17
    s_mul_i32 s30, s30, 9216
    s_lshl_b32 s31, s20, 7
    s_add_u32 s30, s30, s31
    s_cmp_eq_u32 s20, 0
    s_cselect_b32 s33, 0, 2147483648
    v_or_b32 v62, s33, v58
    s_waitcnt lgkmcnt(0)
    buffer_load_dwordx4 v[64:67], v58, s[8:11], s30 offen nt
    buffer_load_dwordx4 v[68:71], v58, s[8:11], s30 offen offset:512 nt
    buffer_load_dwordx4 v[72:75], v62, s[8:11], s30 offen offset:1024 nt
    buffer_load_ushort v28, v24, s[40:43], 0 offen offset:0 nt
    buffer_load_ushort v29, v24, s[40:43], 0 offen offset:3456 nt
    s_mov_b32 s32, 6912
    buffer_load_ushort v30, v24, s[40:43], s32 offen offset:0 nt
    buffer_load_ushort v31, v24, s[40:43], s32 offen offset:3456 nt
    s_mov_b32 s32, 13824
    buffer_load_ushort v32, v24, s[40:43], s32 offen offset:0 nt
    buffer_load_ushort v33, v24, s[40:43], s32 offen offset:3456 nt
    s_mov_b32 s32, 20736
    buffer_load_ushort v34, v24, s[40:43], s32 offen offset:0 nt
    buffer_load_ushort v35, v24, s[40:43], s32 offen offset:3456 nt
    s_mov_b32 s32, 27648
    buffer_load_ushort v36, v24, s[40:43], s32 offen offset:0 nt
    buffer_load_ushort v37, v24, s[40:43], s32 offen offset:3456 nt
    s_mov_b32 s32, 34560
    buffer_load_ushort v38, v24, s[40:43], s32 offen offset:0 nt
    buffer_load_ushort v39, v24, s[40:43], s32 offen offset:3456 nt
    s_mov_b32 s32, 41472
    buffer_load_ushort v40, v24, s[40:43], s32 offen offset:0 nt
    buffer_load_ushort v41, v24, s[40:43], s32 offen offset:3456 nt
    s_mov_b32 s32, 48384
    buffer_load_ushort v42, v24, s[40:43], s32 offen offset:0 nt
    buffer_load_ushort v43, v24, s[40:43], s32 offen offset:3456 nt
    s_cmp_lg_u32 s27, 0
    s_cbranch_scc1 L_inte_z_3
    s_mov_b32 s57, 1
    s_waitcnt vmcnt(19)
    s_atomic_add s57, s[14:15], 0
L_inte_z_3:
    s_mov_b32 s86, 5308416
    s_mov_b32 s87, 0x00020000
    s_mov_b32 s90, 663552
    s_mov_b32 s91, 0x00020000
    s_mov_b32 s46, 5308416
    s_mov_b32 s47, 0x00020000
    s_mov_b32 s94, 9216
    s_mov_b32 s95, 0x00020000
    s_lshl_b32 s39, s20, 4
    s_add_u32 s39, s39, s16
    s_cmp_lt_u32 s39, 36
    s_cselect_b32 s24, 1, 0
    s_sub_u32 s38, s39, 54
    s_lshl_b32 s38, s38, 2
    s_add_u32 s38, s38, s18
    s_mov_b32 s25, 0
    s_mov_b32 s26, 0
    s_cmp_lt_u32 s38, 18
    s_cselect_b32 s38, s38, 0
    s_cselect_b32 s30, 2, 0
    s_or_b32 s24, s24, s30
    s_cmp_ge_u32 s39, 28
    s_cselect_b32 s30, 4, 0
    s_or_b32 s24, s24, s30
    s_mul_i32 s42, s20, 9216
    v_mov_b32 v81, 2147483648
    s_bitcmp0_b32 s24, 0
    s_cbranch_scc1 L_inte_wo_4
    s_and_b32 s30, s17, 1
    s_lshr_b32 s31, s16, 2
    s_lshl_b32 s31, s31, 1
    s_add_u32 s31, s31, s20
    s_add_u32 s31, s31, s30
    s_xor_b32 s30, s30, 1
    s_lshl_b32 s30, s30, 3
    s_cmp_lt_u32 s20, 2
    s_cselect_b32 s31, s31, s30
    s_mul_i32 s30, s17, 9
    s_add_u32 s31, s31, s30
    s_and_b32 s32, s16, 3
    s_lshl_b32 s33, s31, 2
    s_add_u32 s33, s33, s32
    s_mul_i32 s25, s33, 9216
    s_add_u32 s25, s25, 5242880
    s_lshr_b32 s33, s33, 1
    s_lshl_b32 s26, s33, 9
    s_and_b32 s33, s32, 1
    s_lshl_b32 s33, s33, 3
    s_add_u32 s26, s26, s33
    s_add_u32 s26, s26, 360448
    s_mul_i32 s30, s32, 1327104
    s_lshl_b32 s31, s31, 6
    s_add_u32 s30, s30, s31
    s_cmp_lt_u32 s32, 2
    s_cselect_b32 s3, s31, 2147483648
    v_lshrrev_b32 v80, 2, v0
    v_mul_u32_u24 v80, 9216, v80
    v_and_b32 v81, 3, v0
    v_lshl_add_u32 v80, v81, 4, v80
    s_mov_b32 s96, s30
    s_nop 1
    s_branch L_inte_ja_5
L_inte_wo_4:
    v_and_b32 v83, 15, v0
    v_lshlrev_b32 v80, 4, v83
    v_lshrrev_b32 v82, 1, v0
    s_mov_b32 s34, s38
    s_mul_i32 s30, s34, 41472
    s_sub_u32 s31, s34, 16
    s_mul_i32 s31, s31, 331776
    s_add_u32 s31, s31, 18432
    s_cmp_lt_u32 s34, 16
    s_cselect_b64 vcc, -1, 0
    s_cselect_b32 s30, s30, s31
    s_cselect_b32 s32, 4, 36
    s_cselect_b32 s33, 2, 0
    s_mul_i32 s32, s32, 1152
    s_mul_i32 s33, s33, 1152
    s_lshl_b32 s31, s19, 8
    s_add_u32 s30, s30, s31
    v_lshrrev_b32 v83, 4, v0
    v_lshrrev_b32 v84, 5, v0
    v_lshl_add_u32 v84, v84, 4, v83
    v_cndmask_b32 v83, v84, v83, vcc
    v_mul_u32_u24 v83, 1152, v83
    v_add_u32 v80, v80, v83
    v_lshrrev_b32 v83, 4, v82
    v_lshl_add_u32 v83, v83, 1, v82
    v_lshrrev_b32 v84, 1, v82
    v_lshl_add_u32 v84, v84, 4, v82
    v_cndmask_b32 v83, v84, v83, vcc
    v_mul_u32_u24 v83, 1152, v83
    v_and_b32 v84, 1, v0
    v_lshl_add_u32 v83, v84, 4, v83
    s_mul_i32 s31, s19, 224
    s_sub_u32 s31, 1024, s31
    v_add_u32 v81, s31, v83
    s_bitcmp1_b32 s24, 1
    s_cselect_b32 s31, 0, 2147483648
    v_or_b32 v80, s31, v80
    v_or_b32 v81, s31, v81
    s_mov_b32 s96, s30
    s_mov_b32 s97, s32
    s_mov_b32 s98, s33
    s_mov_b32 s3, 2147483648
    s_mul_i32 s30, s38, 9216
    s_mul_i32 s31, s19, 165888
    s_add_u32 s30, s30, s31
    s_add_u32 s25, s30, 2588672
L_inte_ja_5:
    v_and_b32 v82, 31, v0
    v_lshl_add_u32 v82, v82, 1, s3
    v_add_u32 v2, 65536, v1
    v_add_u32 v3, 131072, v1
    v_add_u32 v12, 4096, v1
    v_add_u32 v13, 8192, v1
    v_lshlrev_b32 v4, 2, v0
    v_and_b32 v90, 15, v0
    v_lshrrev_b32 v91, 4, v0
    v_lshlrev_b32 v5, 9, v91
    v_lshl_add_u32 v5, v90, 4, v5
    v_mov_b32 v10, 1
    v_mov_b32 v11, 0
    v_mov_b32 v92, 2147483648
    v_mov_b32 v254, v92
    s_lshr_b32 s79, s2, 3
    s_lshl_b32 s79, s79, 2
    s_add_u32 s79, s79, s20
    s_lshl_b32 s79, s79, 9
    s_min_u32 s79, s79, L_code_end-L_code_begin-512
    s_mov_b32 s59, 0
    s_mov_b32 s27, 2000000
    s_lshl_b32 s30, s17, 8
    s_add_u32 s29, s28, s30
    s_add_u32 s12, s4, s29
    s_addc_u32 s13, s5, 0
    v_cmp_gt_u32 vcc, 16, v0
    s_cmp_eq_u32 s16, 15
    s_cselect_b32 s31, 16, 32
    s_cmp_eq_u32 s20, 0
    s_cselect_b32 s32, 16, 0
    s_cselect_b32 s31, s31, 0
    v_lshlrev_b32 v93, 8, v0
    v_add_u32 v94, 120, v93
    v_cndmask_b32 v94, v94, v93, vcc
    v_cmp_gt_u32 vcc, s32, v0
    s_nop 1
    v_cndmask_b32 v6, v92, v93, vcc
    v_cmp_gt_u32 vcc, s31, v0
    s_nop 1
    v_cndmask_b32 v7, v92, v94, vcc
    s_cmp_ge_u32 s17, 14
    s_cselect_b32 s31, s31, s32
    v_add_u32 v94, 8, v93
    v_add_u32 v94, s28, v94
    v_cmp_gt_u32 vcc, s31, v0
    s_nop 1
    v_cndmask_b32 v94, v92, v94, vcc
    v_lshl_add_u32 v93, v90, 12, s30
    v_add_u32 v93, 128, v93
    v_subrev_u32 v95, 32, v0
    v_cmp_gt_u32 vcc, s32, v95
    s_nop 1
    v_cndmask_b32 v94, v94, v93, vcc
    s_add_u32 s30, s19, 1
    v_add_u32 v93, s30, v0
    v_and_b32 v93, 3, v93
    s_lshl_b32 s30, s18, 2
    v_add_u32 v93, s30, v93
    v_lshlrev_b32 v93, 8, v93
    v_cmp_gt_u32 vcc, 3, v0
    s_nop 1
    v_cndmask_b32 v8, v92, v93, vcc
    s_add_u32 s30, s18, 1
    v_add_u32 v93, s30, v0
    v_and_b32 v93, 3, v93
    v_lshlrev_b32 v93, 2, v93
    v_add_u32 v93, s19, v93
    v_lshlrev_b32 v93, 8, v93
    v_cndmask_b32 v9, v92, v93, vcc
    v_cmp_eq_u32 vcc, 2, v0
    s_nop 1
    v_cndmask_b32 v14, v92, v93, vcc
    s_lshl_b32 s30, s16, 2
    s_add_u32 s30, s30, s18
    s_mul_i32 s31, s30, 36864
    s_lshl_b32 s32, s20, 12
    s_add_u32 s31, s31, s32
    s_lshl_b32 s32, s19, 7
    s_add_u32 s31, s31, s32
    s_add_u32 s31, s31, 15859712
    s_add_u32 s34, s31, 16384
    s_add_u32 s35, s31, 32768
    s_cmp_eq_u32 s20, 0
    s_cselect_b32 s33, 0, 2147483648
    v_lshlrev_b32 v59, 9, v57
    v_lshl_add_u32 v59, v56, 4, v59
    v_or_b32 v62, s33, v59
    s_waitcnt vmcnt(18)
    buffer_store_dwordx4 v[64:67], v59, s[4:7], s31 offen sc1
    s_waitcnt vmcnt(18)
    buffer_store_dwordx4 v[68:71], v59, s[4:7], s34 offen sc1
    s_waitcnt vmcnt(18)
    buffer_store_dwordx4 v[72:75], v62, s[4:7], s35 offen sc1
    s_mov_b32 s36, 1065369472
    v_mov_b32 v60, 0
    v_mov_b32 v61, 0
    v_dot2c_f32_bf16 v60, s36, v64
    v_dot2c_f32_bf16 v61, v64, v64
    v_dot2c_f32_bf16 v60, s36, v65
    v_dot2c_f32_bf16 v61, v65, v65
    v_dot2c_f32_bf16 v60, s36, v66
    v_dot2c_f32_bf16 v61, v66, v66
    v_dot2c_f32_bf16 v60, s36, v67
    v_dot2c_f32_bf16 v61, v67, v67
    v_dot2c_f32_bf16 v60, s36, v68
    v_dot2c_f32_bf16 v61, v68, v68
    v_dot2c_f32_bf16 v60, s36, v69
    v_dot2c_f32_bf16 v61, v69, v69
    v_dot2c_f32_bf16 v60, s36, v70
    v_dot2c_f32_bf16 v61, v70, v70
    v_dot2c_f32_bf16 v60, s36, v71
    v_dot2c_f32_bf16 v61, v71, v71
    v_dot2c_f32_bf16 v60, s36, v72
    v_dot2c_f32_bf16 v61, v72, v72
    v_dot2c_f32_bf16 v60, s36, v73
    v_dot2c_f32_bf16 v61, v73, v73
    v_dot2c_f32_bf16 v60, s36, v74
    v_dot2c_f32_bf16 v61, v74, v74
    v_dot2c_f32_bf16 v60, s36, v75
    v_dot2c_f32_bf16 v61, v75, v75
    s_nop 1
    v_add_f32_dpp v60, v60, v60 quad_perm:[1,0,3,2] row_mask:0xf bank_mask:0xf
    v_add_f32_dpp v61, v61, v61 quad_perm:[1,0,3,2] row_mask:0xf bank_mask:0xf
    s_nop 0
    v_add_f32_dpp v60, v60, v60 quad_perm:[2,3,0,1] row_mask:0xf bank_mask:0xf
    v_add_f32_dpp v61, v61, v61 quad_perm:[2,3,0,1] row_mask:0xf bank_mask:0xf
    s_nop 0
    v_add_f32_dpp v60, v60, v60 row_half_mirror row_mask:0xf bank_mask:0xf
    v_add_f32_dpp v61, v61, v61 row_half_mirror row_mask:0xf bank_mask:0xf
    v_cmp_eq_u32 vcc, 1, v57
    v_lshlrev_b32 v62, 7, v57
    v_lshl_add_u32 v62, v56, 2, v62
    v_cndmask_b32 v60, v60, v61, vcc
    v_cmp_gt_u32 vcc, 2, v57
    s_lshl_b32 s32, s20, 8
    v_add_u32 v62, s32, v62
    v_mov_b32 v63, 2147483648
    v_cndmask_b32 v62, v63, v62, vcc
    s_lshl_b32 s30, s30, 12
    s_lshl_b32 s32, s19, 5
    s_add_u32 s30, s30, s32
    s_add_u32 s30, s30, 18219008
    buffer_store_dword v60, v62, s[4:7], s30 offen sc1
    v_lshrrev_b32 v25, 1, v20
    v_mad_u32_u24 v25, v25, 7, v22
    v_and_b32 v26, 1, v20
    v_lshl_add_u32 v25, v25, 1, v26
    v_lshlrev_b32 v25, 9, v25
    v_lshl_add_u32 v25, v23, 4, v25
    v_or_b32 v25, s21, v25
    v_lshl_add_u32 v26, v20, 7, v21
    v_lshlrev_b32 v26, 2, v26
    v_or_b32 v26, s21, v26
    s_mul_i32 s31, s17, 129024
    s_add_u32 s31, s31, 524288
    s_mul_i32 s32, s17, 18432
    s_add_u32 s32, s32, 65536
    s_mov_b32 s36, 1065369472
    v_mov_b32 v27, 0
    s_waitcnt vmcnt(18)
    v_lshl_or_b32 v44, v29, 16, v28
    s_waitcnt vmcnt(16)
    v_lshl_or_b32 v45, v31, 16, v30
    s_waitcnt vmcnt(14)
    v_lshl_or_b32 v46, v33, 16, v32
    s_waitcnt vmcnt(12)
    v_lshl_or_b32 v47, v35, 16, v34
    buffer_store_dwordx4 v[44:47], v25, s[4:7], s31 offen offset:0 sc1
    s_waitcnt vmcnt(11)
    v_lshl_or_b32 v48, v37, 16, v36
    s_waitcnt vmcnt(9)
    v_lshl_or_b32 v49, v39, 16, v38
    s_waitcnt vmcnt(7)
    v_lshl_or_b32 v50, v41, 16, v40
    s_waitcnt vmcnt(5)
    v_lshl_or_b32 v51, v43, 16, v42
    buffer_store_dwordx4 v[48:51], v25, s[4:7], s31 offen offset:256 sc1
    v_dot2c_f32_bf16 v27, s36, v44
    v_dot2c_f32_bf16 v27, s36, v45
    v_dot2c_f32_bf16 v27, s36, v46
    v_dot2c_f32_bf16 v27, s36, v47
    v_dot2c_f32_bf16 v27, s36, v48
    v_dot2c_f32_bf16 v27, s36, v49
    v_dot2c_f32_bf16 v27, s36, v50
    v_dot2c_f32_bf16 v27, s36, v51
    s_nop 2
    buffer_store_dword v27, v26, s[4:7], s32 offen sc1
    s_bitcmp0_b32 s24, 0
    s_cbranch_scc1 L_inte_wo_6
    s_add_u32 m0, s42, 0
    s_add_u32 s99, s96, 0
    buffer_load_dwordx4 v80, s[84:87], s99 offen nt lds
    s_add_u32 m0, s42, 1024
    s_add_u32 s99, s96, 147456
    buffer_load_dwordx4 v80, s[84:87], s99 offen nt lds
    s_add_u32 m0, s42, 2048
    s_add_u32 s99, s96, 294912
    buffer_load_dwordx4 v80, s[84:87], s99 offen nt lds
    s_add_u32 m0, s42, 3072
    s_add_u32 s99, s96, 442368
    buffer_load_dwordx4 v80, s[84:87], s99 offen nt lds
    s_add_u32 m0, s42, 4096
    s_add_u32 s99, s96, 589824
    buffer_load_dwordx4 v80, s[84:87], s99 offen nt lds
    s_branch L_inte_ja_7
L_inte_wo_6:
    s_add_u32 m0, s42, 0
    s_mov_b32 s99, s96
    buffer_load_dwordx4 v80, s[88:91], s99 offen nt lds
    s_add_u32 m0, s42, 1024
    s_add_u32 s99, s99, s97
    buffer_load_dwordx4 v80, s[88:91], s99 offen nt lds
    s_add_u32 m0, s42, 2048
    s_add_u32 s99, s99, s97
    buffer_load_dwordx4 v80, s[88:91], s99 offen nt lds
    s_add_u32 m0, s42, 3072
    s_add_u32 s99, s99, s97
    buffer_load_dwordx4 v80, s[88:91], s99 offen nt lds
    s_add_u32 m0, s42, 4096
    s_add_u32 s99, s99, s97
    s_add_u32 s99, s99, s98
    buffer_load_dwordx4 v80, s[88:91], s99 offen nt lds
L_inte_ja_7:
    s_mov_b32 s21, 0
    s_mov_b32 s22, 0
    s_lshl_b32 s23, s16, 2
    s_add_u32 s23, s23, s20
    s_mul_i32 s40, s17, 129024
    s_cmp_eq_u32 s16, 0
    s_cselect_b32 s56, 16, 18
    v_and_b32 v99, 15, v0
    v_lshlrev_b32 v16, 4, v99
    v_lshrrev_b32 v98, 1, v0
    s_max_u32 s34, s39, 28
    s_sub_u32 s34, s34, 28
    s_lshr_b32 s31, s34, 2
    s_mov_b32 s30, 50462976
    s_cmp_eq_u32 s31, 1
    s_cselect_b32 s30, 268829956, s30
    s_cmp_eq_u32 s31, 2
    s_cselect_b32 s30, 554774560, s30
    s_cmp_eq_u32 s31, 3
    s_cselect_b32 s30, 841093681, s30
    s_cmp_eq_u32 s31, 4
    s_cselect_b32 s30, 338895635, s30
    s_cmp_eq_u32 s31, 5
    s_cselect_b32 s30, 622146596, s30
    s_cmp_eq_u32 s31, 6
    s_cselect_b32 s30, 908465717, s30
    s_cmp_eq_u32 s31, 7
    s_cselect_b32 s30, 925308679, s30
    s_cmp_eq_u32 s31, 8
    s_cselect_b32 s30, 942151688, s30
    s_and_b32 s31, s34, 3
    s_lshl_b32 s31, s31, 3
    s_lshr_b32 s30, s30, s31
    s_and_b32 s31, s30, 15
    s_lshr_b32 s30, s30, 4
    s_add_u32 s30, s30, s19
    s_and_b32 s30, s30, 3
    s_lshl_b32 s32, s18, 2
    s_add_u32 s30, s30, s32
    s_mul_i32 s30, s30, 9
    s_add_u32 s30, s30, s31
    s_mul_i32 s30, s30, 36864
    s_lshl_b32 s31, s19, 8
    s_add_u32 s30, s30, s31
    v_lshrrev_b32 v99, 4, v0
    v_mul_u32_u24 v99, 1152, v99
    v_add_u32 v16, v16, v99
    v_and_b32 v17, 3, v98
    v_and_b32 v99, 12, v98
    v_lshl_add_u32 v17, v99, 1, v17
    v_lshrrev_b32 v99, 4, v98
    v_lshl_add_u32 v17, v99, 2, v17
    v_mul_u32_u24 v17, 1152, v17
    v_and_b32 v99, 1, v0
    v_lshl_add_u32 v17, v99, 4, v17
    s_mul_i32 s31, s19, 224
    s_sub_u32 s31, 1024, s31
    v_add_u32 v17, s31, v17
    s_mov_b32 s63, s30
    s_mul_i32 s30, s17, 331776
    s_mul_i32 s33, s34, 64
    s_lshr_b32 s33, s33, 8
    s_mul_i32 s31, s33, 4
    s_sub_u32 s31, s34, s31
    s_lshl_b32 s31, s31, 10
    s_add_u32 s30, s30, s31
    s_mul_i32 s31, s33, 24576
    s_add_u32 s31, s31, s30
    s_add_u32 s60, s31, 10551296
    s_mul_i32 s31, s33, 4096
    s_add_u32 s31, s31, s30
    s_add_u32 s61, s31, 10772480
    s_mul_i32 s31, s33, 8192
    s_add_u32 s31, s31, s30
    s_add_u32 s62, s31, 10809344
    s_load_dword s3, s[14:15], 0
    s_lshl_b32 s30, s16, 2
    s_max_u32 s30, s30, 1
    s_sub_u32 s30, s30, 1
    s_cmp_eq_u32 s16, 0
    s_cselect_b32 s31, 2147483648, 0
    s_mul_i32 s52, s23, 36864
    s_add_u32 s52, s52, 15859712
    s_mul_i32 s53, s30, 36864
    s_add_u32 s53, s53, 15859712
    v_or_b32 v178, s31, v5
    v_add_u32 v178, 256, v178
    s_lshl_b32 s38, s20, 10
    s_lshl_b32 s39, s20, 11
    s_add_u32 s39, s39, s53
    s_xor_b32 s32, s20, 0
    s_lshl_b32 s32, s32, 10
    v_add_u32 v173, s32, v1
    v_add_u32 v168, 73728, v173
    s_xor_b32 s32, s20, 1
    s_lshl_b32 s32, s32, 10
    v_add_u32 v174, s32, v1
    v_add_u32 v169, 73728, v174
    s_xor_b32 s32, s20, 2
    s_lshl_b32 s32, s32, 10
    v_add_u32 v175, s32, v1
    v_add_u32 v170, 73728, v175
    s_xor_b32 s32, s20, 3
    s_lshl_b32 s32, s32, 10
    v_add_u32 v176, s32, v1
    v_add_u32 v171, 73728, v176
    v_add_u32 v172, 73728, v1
    s_lshl_b32 s32, s23, 12
    s_add_u32 s32, s32, s21
    s_add_u32 s32, s32, 18219008
    s_lshl_b32 s33, s30, 12
    s_add_u32 s33, s33, s21
    s_add_u32 s33, s33, 18219008
    v_and_b32 v210, 15, v0
    v_lshlrev_b32 v179, 2, v210
    v_bfe_u32 v211, v0, 4, 1
    v_lshl_add_u32 v179, v211, 9, v179
    v_lshrrev_b32 v211, 5, v0
    v_lshl_add_u32 v179, v211, 7, v179
    v_add_u32 v179, 64, v179
    v_or_b32 v179, s31, v179
    v_mul_u32_u24 v210, 240, v210
    v_lshrrev_b32 v212, 4, v0
    v_lshl_add_u32 v210, v212, 3, v210
    v_add_u32 v204, 73728, v210
    s_lshl_b32 s34, s20, 5
    v_add_u32 v203, s34, v204
    s_mul_i32 s34, s20, 7680
    s_add_u32 s34, s34, 3840
    v_add_u32 v202, s34, v204
    v_lshlrev_b32 v212, 4, v212
    v_add_u32 v212, 156672, v212
    v_and_b32 v210, 31, v0
    v_mul_u32_u24 v207, 240, v210
    s_sub_u32 s34, s34, -70368
    v_add_u32 v207, s34, v207
    v_lshl_add_u32 v206, v211, 5, v207
    v_lshl_add_u32 v207, v211, 4, v207
    v_lshlrev_b32 v205, 3, v210
    v_lshl_add_u32 v205, v211, 2, v205
    v_lshlrev_b32 v189, 4, v210
    v_lshl_add_u32 v189, v211, 10, v189
    s_mul_i32 s48, s23, 36864
    s_add_u32 s48, s48, s21
    s_add_u32 s48, s48, 18481152
    s_lshl_b32 s49, s17, 8
    s_add_u32 s49, s49, s48
    s_add_u32 s49, s49, 32768
    s_lshl_b32 s34, s17, 11
    s_add_u32 s48, s48, s34
    s_mov_b32 vcc_lo, 0xffff0000
    s_mov_b32 vcc_hi, 0xffff0000
    s_lshl_b32 s34, s23, 5
    v_add_u32 v210, s34, v210
    s_lshl_b32 s34, s20, 11
    v_add_u32 v208, s34, v1
    s_cmp_lt_u32 s20, 2
    s_cselect_b32 s34, 0, 2147483648
    v_or_b32 v209, s34, v13
    s_mul_i32 s54, s19, 165888
    s_add_u32 s54, s54, 2579456
    s_waitcnt lgkmcnt(0)
    s_cmp_lg_u32 s20, 0
    s_cbranch_scc1 L_inte_init_8_x
    s_cmp_ge_u32 s3, 16
    s_cbranch_scc1 L_inte_init_8_x
L_inte_init_8:
    global_load_dword v96, v11, s[14:15] sc1
    s_waitcnt vmcnt(0)
    v_readfirstlane_b32 s3, v96
    s_nop 0
    s_cmp_ge_u32 s3, 16
    s_cbranch_scc1 L_inte_init_8_x
    s_sleep 2
    s_sub_u32 s27, s27, 1
    s_cmp_gt_i32 s27, 0
    s_cbranch_scc1 L_inte_init_8
L_inte_init_8_x:
    s_waitcnt vmcnt(5)
    s_barrier
    buffer_atomic_add v10, v94, s[4:7], 0 offen sc1
    s_bitcmp0_b32 s24, 0
    s_cbranch_scc1 L_inte_wo_9
    s_add_u32 m0, s42, 5120
    s_add_u32 s99, s96, 737280
    buffer_load_dwordx4 v80, s[84:87], s99 offen nt lds
    s_add_u32 m0, s42, 6144
    s_add_u32 s99, s96, 884736
    buffer_load_dwordx4 v80, s[84:87], s99 offen nt lds
    s_add_u32 m0, s42, 7168
    s_add_u32 s99, s96, 1032192
    buffer_load_dwordx4 v80, s[84:87], s99 offen nt lds
    s_add_u32 m0, s42, 8192
    s_add_u32 s99, s96, 1179648
    buffer_load_dwordx4 v80, s[84:87], s99 offen nt lds
    s_branch L_inte_ja_10
L_inte_wo_9:
    s_add_u32 m0, s42, 5120
    s_add_u32 s99, s99, s97
    buffer_load_dwordx4 v80, s[88:91], s99 offen nt lds
    s_add_u32 m0, s42, 6144
    s_add_u32 s99, s99, s97
    buffer_load_dwordx4 v80, s[88:91], s99 offen nt lds
    s_add_u32 m0, s42, 7168
    s_add_u32 s99, s99, s97
    buffer_load_dwordx4 v80, s[88:91], s99 offen nt lds
    s_add_u32 m0, s42, 8192
    s_nop 0
    buffer_load_dwordx4 v81, s[88:91], s96 offen offset:0 nt lds
L_inte_ja_10:
    buffer_load_ushort v255, v82, s[92:95], 0 offen nt
    s_mul_i32 s15, s19, 7168
    s_sub_u32 s15, 32768, s15
    v_subrev_u32 v190, 2, v210
    v_ashrrev_i32 v190, 31, v190
    v_and_b32 v190, 0xf149f2ca, v190
    v_subrev_u32 v191, 4, v210
    v_ashrrev_i32 v191, 31, v191
    v_and_b32 v191, 0xf149f2ca, v191
    v_subrev_u32 v192, 6, v210
    v_ashrrev_i32 v192, 31, v192
    v_and_b32 v192, 0xf149f2ca, v192
    v_subrev_u32 v193, 8, v210
    v_ashrrev_i32 v193, 31, v193
    v_and_b32 v193, 0xf149f2ca, v193
    v_subrev_u32 v194, 10, v210
    v_ashrrev_i32 v194, 31, v194
    v_and_b32 v194, 0xf149f2ca, v194
    v_subrev_u32 v195, 12, v210
    v_ashrrev_i32 v195, 31, v195
    v_and_b32 v195, 0xf149f2ca, v195
    v_subrev_u32 v196, 14, v210
    v_ashrrev_i32 v196, 31, v196
    v_and_b32 v196, 0xf149f2ca, v196
    s_xor_b32 s35, s20, 0
    s_lshl_b32 s35, s35, 5
    v_add_u32 v198, s35, v202
    s_xor_b32 s35, s20, 1
    s_lshl_b32 s35, s35, 5
    v_add_u32 v199, s35, v202
    s_xor_b32 s35, s20, 2
    s_lshl_b32 s35, s35, 5
    v_add_u32 v200, s35, v202
    s_xor_b32 s35, s20, 3
    s_lshl_b32 s35, s35, 5
    v_add_u32 v201, s35, v202
    v_lshrrev_b32 v136, 3, v0
    v_and_b32 v137, 7, v0
    v_lshlrev_b32 v137, 4, v137
    v_lshl_add_u32 v136, v136, 9, v137
    v_lshlrev_b32 v138, 26, v0
    v_and_b32 v138, 2147483648, v138
    v_or_b32 v138, v138, v136
    s_mul_i32 s36, s17, 18432
    s_lshl_b32 s37, s20, 7
    s_add_u32 s36, s36, s37
    s_add_u32 s36, s36, 65536
    s_add_u32 s37, s37, 156672
    v_add_u32 v137, s37, v137
    s_bitcmp1_b32 s24, 0
    s_cselect_b32 s37, 0, 2147483648
    v_or_b32 v252, s37, v1
    s_bitcmp1_b32 s24, 1
    s_cselect_b32 s37, 0, 2147483648
    v_lshlrev_b32 v253, 10, v0
    v_or_b32 v253, s37, v253
    s_lshl_b32 s37, s19, 8
    s_mul_i32 s50, s20, 7168
    s_add_u32 s51, s50, s40
    s_lshl_b32 s58, s20, 2
    s_min_u32 s58, s58, 10
    s_lshl_b32 s58, s58, 10
    s_cmp_eq_u32 s20, 3
    s_cselect_b32 s43, 138240, 0
    s_sub_u32 s43, s50, s43
    s_sub_u32 s14, s16, 6
    s_cmp_lt_u32 s14, 5
    s_cselect_b32 s14, 2, 3
    s_cmp_lg_u32 s20, s14
    s_cbranch_scc1 L_inte_in_11
L_inte_poll_12:
    s_load_dword s57, s[12:13], 128 glc
    s_load_dword s3, s[12:13], 8 glc
    s_waitcnt lgkmcnt(0)
    s_cmp_ge_u32 s3, s56
    s_cselect_b32 s57, s57, 0
    s_cmp_ge_u32 s57, 16
    s_cbranch_scc1 L_inte_poll_12_x
    s_sub_u32 s27, s27, 1
    s_cmp_gt_i32 s27, 0
    s_cbranch_scc1 L_inte_poll_12
L_inte_poll_12_x:
L_inte_in_11:
    s_barrier
    s_add_u32 m0, s58, 73728
    s_add_u32 s55, s58, s40
    s_add_u32 s55, s55, 524288
    buffer_load_dwordx4 v1, s[4:7], s55 offen offset:0 sc1 lds
    buffer_load_dwordx4 v1, s[4:7], s55 offen offset:1024 sc1 lds
    buffer_load_dwordx4 v1, s[4:7], s55 offen offset:2048 sc1 lds
    buffer_load_dwordx4 v1, s[4:7], s55 offen offset:3072 sc1 lds
    buffer_load_dwordx4 a[0:3], v5, s[4:7], s52 offen offset:0 sc1
    buffer_load_dwordx4 a[4:7], v5, s[4:7], s52 offen offset:256 sc1
    buffer_load_dwordx4 a[8:11], v178, s[4:7], s53 offen offset:0 sc1
    buffer_load_dwordx4 a[12:15], v5, s[4:7], s52 offen offset:2048 sc1
    buffer_load_dwordx4 a[16:19], v5, s[4:7], s52 offen offset:2304 sc1
    buffer_load_dwordx4 a[20:23], v178, s[4:7], s53 offen offset:2048 sc1
    s_add_u32 m0, s50, 88064
    s_add_u32 s55, s51, 538624
    buffer_load_dwordx4 v1, s[4:7], s55 offen offset:0 sc1 lds
    buffer_load_dwordx4 v1, s[4:7], s55 offen offset:1024 sc1 lds
    buffer_load_dwordx4 v1, s[4:7], s55 offen offset:2048 sc1 lds
    buffer_load_dwordx4 v1, s[4:7], s55 offen offset:3072 sc1 lds
    s_waitcnt vmcnt(14)
    s_bitcmp0_b32 s24, 1
    s_cbranch_scc1 L_inte_role_13
    v_lshrrev_b32 v20, 4, v0
    v_bfe_u32 v22, v0, 2, 2
    v_lshl_add_u32 v20, v20, 3, v22
    v_and_b32 v22, 3, v0
    v_lshl_add_u32 v21, v20, 2, v22
    v_lshl_add_u32 v21, v21, 3, s42
    v_lshl_add_u32 v20, v20, 4, v22
    v_lshl_add_u32 v20, v20, 4, s42
    ds_read_b64_tr_b16 v[24:25], v20 offset:0
    ds_read_b64_tr_b16 v[26:27], v20 offset:1024
    ds_read_b64_tr_b16 v[28:29], v20 offset:8
    ds_read_b64_tr_b16 v[30:31], v20 offset:1032
    ds_read_b64_tr_b16 v[32:33], v20 offset:64
    ds_read_b64_tr_b16 v[34:35], v20 offset:1088
    ds_read_b64_tr_b16 v[36:37], v20 offset:72
    ds_read_b64_tr_b16 v[38:39], v20 offset:1096
    ds_read_b64_tr_b16 v[40:41], v20 offset:128
    ds_read_b64_tr_b16 v[42:43], v20 offset:1152
    ds_read_b64_tr_b16 v[44:45], v20 offset:136
    ds_read_b64_tr_b16 v[46:47], v20 offset:1160
    ds_read_b64_tr_b16 v[48:49], v20 offset:192
    ds_read_b64_tr_b16 v[50:51], v20 offset:1216
    ds_read_b64_tr_b16 v[52:53], v20 offset:200
    ds_read_b64_tr_b16 v[54:55], v20 offset:1224
    ds_read_b64_tr_b16 v[56:57], v21 offset:8192
    ds_read_b64_tr_b16 v[58:59], v21 offset:8320
    s_waitcnt lgkmcnt(14)
    buffer_store_dwordx4 v[24:27], v1, s[4:7], s25 offen offset:0 sc1
    buffer_store_dwordx4 v[28:31], v1, s[4:7], s25 offen offset:1024 sc1
    s_waitcnt lgkmcnt(12)
    buffer_store_dwordx4 v[32:35], v1, s[4:7], s25 offen offset:2048 sc1
    s_waitcnt lgkmcnt(10)
    buffer_store_dwordx4 v[36:39], v1, s[4:7], s25 offen offset:3072 sc1
    s_waitcnt lgkmcnt(8)
    buffer_store_dwordx4 v[40:43], v12, s[4:7], s25 offen offset:0 sc1
    s_waitcnt lgkmcnt(6)
    buffer_store_dwordx4 v[44:47], v12, s[4:7], s25 offen offset:1024 sc1
    s_waitcnt lgkmcnt(4)
    buffer_store_dwordx4 v[48:51], v12, s[4:7], s25 offen offset:2048 sc1
    s_waitcnt lgkmcnt(2)
    buffer_store_dwordx4 v[52:55], v12, s[4:7], s25 offen offset:3072 sc1
    s_waitcnt lgkmcnt(0)
    buffer_store_dwordx4 v[56:59], v13, s[4:7], s25 offen offset:0 sc1
L_inte_role_13:
    s_bitcmp0_b32 s24, 0
    s_cbranch_scc1 L_inte_role_14
    v_lshrrev_b32 v20, 5, v0
    v_bfe_u32 v21, v0, 2, 2
    v_lshl_add_u32 v20, v20, 3, v21
    v_bfe_u32 v21, v0, 4, 1
    v_lshl_add_u32 v20, v20, 1, v21
    v_and_b32 v21, 3, v0
    v_lshl_add_u32 v20, v20, 2, v21
    v_lshlrev_b32 v20, 3, v20
    v_add_u32 v20, s42, v20
    ds_read_b64_tr_b16 v[214:215], v20 offset:0
    ds_read_b64_tr_b16 v[216:217], v20 offset:256
    ds_read_b64_tr_b16 v[218:219], v20 offset:1024
    ds_read_b64_tr_b16 v[220:221], v20 offset:1280
    ds_read_b64_tr_b16 v[222:223], v20 offset:2048
    ds_read_b64_tr_b16 v[224:225], v20 offset:2304
    ds_read_b64_tr_b16 v[226:227], v20 offset:3072
    ds_read_b64_tr_b16 v[228:229], v20 offset:3328
    ds_read_b64_tr_b16 v[230:231], v20 offset:4096
    ds_read_b64_tr_b16 v[232:233], v20 offset:4352
    ds_read_b64_tr_b16 v[234:235], v20 offset:5120
    ds_read_b64_tr_b16 v[236:237], v20 offset:5376
    ds_read_b64_tr_b16 v[238:239], v20 offset:6144
    ds_read_b64_tr_b16 v[240:241], v20 offset:6400
    ds_read_b64_tr_b16 v[242:243], v20 offset:7168
    ds_read_b64_tr_b16 v[244:245], v20 offset:7424
    ds_read_b64_tr_b16 v[246:247], v20 offset:8192
    ds_read_b64_tr_b16 v[248:249], v20 offset:8448
    v_lshlrev_b32 v21, 26, v0
    v_and_b32 v21, 2147483648, v21
    v_lshl_or_b32 v254, v0, 4, v21
    s_mov_b32 s2, 1065369472
    v_mov_b32 v20, 0
    s_waitcnt lgkmcnt(14)
    v_dot2c_f32_bf16 v20, s2, v214
    v_dot2c_f32_bf16 v20, s2, v215
    v_dot2c_f32_bf16 v20, s2, v216
    v_dot2c_f32_bf16 v20, s2, v217
    v_dot2c_f32_bf16 v20, s2, v218
    v_dot2c_f32_bf16 v20, s2, v219
    v_dot2c_f32_bf16 v20, s2, v220
    v_dot2c_f32_bf16 v20, s2, v221
    s_waitcnt lgkmcnt(13)
    v_dot2c_f32_bf16 v20, s2, v222
    v_dot2c_f32_bf16 v20, s2, v223
    s_waitcnt lgkmcnt(12)
    v_dot2c_f32_bf16 v20, s2, v224
    v_dot2c_f32_bf16 v20, s2, v225
    s_waitcnt lgkmcnt(11)
    v_dot2c_f32_bf16 v20, s2, v226
    v_dot2c_f32_bf16 v20, s2, v227
    s_waitcnt lgkmcnt(10)
    v_dot2c_f32_bf16 v20, s2, v228
    v_dot2c_f32_bf16 v20, s2, v229
    s_waitcnt lgkmcnt(9)
    v_dot2c_f32_bf16 v20, s2, v230
    v_dot2c_f32_bf16 v20, s2, v231
    s_waitcnt lgkmcnt(8)
    v_dot2c_f32_bf16 v20, s2, v232
    v_dot2c_f32_bf16 v20, s2, v233
    s_waitcnt lgkmcnt(7)
    v_dot2c_f32_bf16 v20, s2, v234
    v_dot2c_f32_bf16 v20, s2, v235
    s_waitcnt lgkmcnt(6)
    v_dot2c_f32_bf16 v20, s2, v236
    v_dot2c_f32_bf16 v20, s2, v237
    s_waitcnt lgkmcnt(5)
    v_dot2c_f32_bf16 v20, s2, v238
    v_dot2c_f32_bf16 v20, s2, v239
    s_waitcnt lgkmcnt(4)
    v_dot2c_f32_bf16 v20, s2, v240
    v_dot2c_f32_bf16 v20, s2, v241
    s_waitcnt lgkmcnt(3)
    v_dot2c_f32_bf16 v20, s2, v242
    v_dot2c_f32_bf16 v20, s2, v243
    s_waitcnt lgkmcnt(2)
    v_dot2c_f32_bf16 v20, s2, v244
    v_dot2c_f32_bf16 v20, s2, v245
    s_waitcnt lgkmcnt(1)
    v_dot2c_f32_bf16 v20, s2, v246
    v_dot2c_f32_bf16 v20, s2, v247
    s_waitcnt lgkmcnt(0)
    v_dot2c_f32_bf16 v20, s2, v248
    v_dot2c_f32_bf16 v20, s2, v249
    s_nop 2
    v_mov_b32 v21, v20
    s_nop 1
    v_permlane32_swap_b32 v20, v21
    v_add_f32 v20, v20, v21
    v_cvt_pk_bf16_f32 v250, v20, v20
    v_and_b32 v21, 0xffff0000, v250
    v_sub_f32 v21, v20, v21
    v_cvt_pk_bf16_f32 v21, v21, 0
    v_lshl_or_b32 v251, v255, 16, v21
L_inte_role_14:
    s_waitcnt lgkmcnt(0)
    s_add_u32 m0, s50, 92160
    s_add_u32 s55, s51, 542720
    buffer_load_dwordx4 v1, s[4:7], s55 offen offset:0 sc1 lds
    buffer_load_dwordx4 v1, s[4:7], s55 offen offset:1024 sc1 lds
    buffer_load_dwordx4 v1, s[4:7], s55 offen offset:2048 sc1 lds
    s_add_u32 m0, s38, 65536
    s_add_u32 s55, s39, 4096
    buffer_load_dwordx4 v178, s[4:7], s55 offen sc1 lds
    s_add_u32 s52, s52, 4096
    buffer_load_dwordx4 a[24:27], v5, s[4:7], s52 offen offset:0 sc1
    buffer_load_dwordx4 a[28:31], v5, s[4:7], s52 offen offset:256 sc1
    buffer_load_dwordx4 a[36:39], v5, s[4:7], s52 offen offset:2048 sc1
    buffer_load_dwordx4 a[40:43], v5, s[4:7], s52 offen offset:2304 sc1
    s_mov_b32 s14, 1
    s_lshl_b32 s29, s20, 10
    s_add_u32 s29, s29, s28
    s_waitcnt vmcnt(18)
    s_barrier
    ds_read_b128 v[84:87], v169 offset:0
    ds_read_b128 v[88:91], v170 offset:0
    ds_read_b128 v[92:95], v171 offset:0
    ds_read_b128 v[96:99], v172 offset:5120
    ds_read_b128 v[100:103], v172 offset:6144
    ds_read_b128 v[104:107], v168 offset:0
    ds_read_b128 v[108:111], v172 offset:4096
    ds_read_b128 v[112:115], v169 offset:7168
    s_waitcnt lgkmcnt(5)
    s_waitcnt vmcnt(16)
    v_mfma_f32_16x16x32_bf16 v[28:31], v[84:87], a[0:3], 0
    ds_read_b128 a[216:219], v170 offset:7168
    ds_read_b128 a[220:223], v171 offset:7168
    v_mfma_f32_16x16x32_bf16 v[32:35], v[84:87], a[4:7], 0
    v_mfma_f32_16x16x32_bf16 v[40:43], v[88:91], a[4:7], 0
    ds_read_b128 a[224:227], v172 offset:12288
    v_mfma_f32_16x16x32_bf16 v[36:39], v[88:91], a[0:3], 0
    v_mfma_f32_16x16x32_bf16 v[44:47], v[92:95], a[0:3], 0
    ds_read_b128 a[228:231], v172 offset:13312
    v_mfma_f32_16x16x32_bf16 v[48:51], v[92:95], a[4:7], 0
    s_waitcnt lgkmcnt(6)
    v_mfma_f32_16x16x32_bf16 v[64:67], v[96:99], a[4:7], 0
    ds_read_b128 v[84:87], v168 offset:7168
    v_mfma_f32_16x16x32_bf16 v[60:63], v[96:99], a[0:3], 0
    v_mfma_f32_16x16x32_bf16 v[68:71], v[100:103], a[0:3], 0
    s_add_u32 m0, s43, 116736
    s_add_u32 s55, s51, 567296
    buffer_load_dwordx4 v1, s[4:7], s55 offen offset:0 sc1 lds
    v_mfma_f32_16x16x32_bf16 v[72:75], v[100:103], a[4:7], 0
    s_waitcnt vmcnt(16)
    buffer_load_dwordx4 v1, s[4:7], s55 offen offset:1024 sc1 lds
    ds_read_b128 v[88:91], v172 offset:11264
    v_mfma_f32_16x16x32_bf16 v[24:27], v[104:107], a[4:7], 0
    buffer_load_dwordx4 v1, s[4:7], s55 offen offset:2048 sc1 lds
    buffer_load_dwordx4 v1, s[4:7], s55 offen offset:3072 sc1 lds
    v_mfma_f32_16x16x32_bf16 v[20:23], v[104:107], a[0:3], 0
    s_add_u32 s52, s52, 4096
    buffer_load_dwordx4 a[48:51], v5, s[4:7], s52 offen offset:0 sc1
    buffer_load_dwordx4 a[52:55], v5, s[4:7], s52 offen offset:256 sc1
    s_waitcnt vmcnt(14)
    buffer_atomic_add v10, v253, s[4:7], s37 offen offset:140 sc1
    s_add_u32 m0, s43, 120832
    s_add_u32 s55, s51, 571392
    buffer_load_dwordx4 v1, s[4:7], s55 offen offset:0 sc1 lds
    v_mfma_f32_16x16x32_bf16 v[76:79], v[104:107], a[8:11], 0
    s_waitcnt lgkmcnt(5)
    s_waitcnt vmcnt(12)
    s_barrier
    ds_read_b128 v[92:95], v169 offset:14336
    v_mfma_f32_16x16x32_bf16 v[52:55], v[108:111], a[0:3], 0
    buffer_load_dwordx4 v1, s[4:7], s55 offen offset:1024 sc1 lds
    v_mfma_f32_16x16x32_bf16 v[56:59], v[108:111], a[4:7], 0
    ds_read_b128 v[96:99], v170 offset:14336
    v_mfma_f32_16x16x32_bf16 v[80:83], v[108:111], a[8:11], 0
    v_mfma_f32_16x16x32_bf16 v[32:35], v[112:115], a[16:19], v[32:35]
    ds_read_b128 v[100:103], v171 offset:14336
    v_mfma_f32_16x16x32_bf16 v[28:31], v[112:115], a[12:15], v[28:31]
    v_mfma_f32_16x16x32_bf16 v[36:39], a[216:219], a[12:15], v[36:39]
    ds_read_b128 v[104:107], v172 offset:19456
    v_mfma_f32_16x16x32_bf16 v[40:43], a[216:219], a[16:19], v[40:43]
    s_waitcnt lgkmcnt(6)
    v_mfma_f32_16x16x32_bf16 v[48:51], a[220:223], a[16:19], v[48:51]
    ds_read_b128 v[108:111], v172 offset:20480
    v_mfma_f32_16x16x32_bf16 v[44:47], a[220:223], a[12:15], v[44:47]
    v_mfma_f32_16x16x32_bf16 v[60:63], a[224:227], a[12:15], v[60:63]
    buffer_load_dwordx4 v1, s[4:7], s55 offen offset:2048 sc1 lds
    s_add_u32 m0, s38, 69632
    ds_read_b128 v[112:115], v168 offset:14336
    v_mfma_f32_16x16x32_bf16 v[64:67], a[224:227], a[16:19], v[64:67]
    s_add_u32 s55, s39, 12288
    v_mfma_f32_16x16x32_bf16 v[72:75], a[228:231], a[16:19], v[72:75]
    v_mfma_f32_16x16x32_bf16 v[68:71], a[228:231], a[12:15], v[68:71]
    s_waitcnt lgkmcnt(5)
    ds_read_b128 a[216:219], v172 offset:18432
    v_mfma_f32_16x16x32_bf16 v[20:23], v[84:87], a[12:15], v[20:23]
    v_mfma_f32_16x16x32_bf16 v[24:27], v[84:87], a[16:19], v[24:27]
    v_mfma_f32_16x16x32_bf16 v[76:79], v[84:87], a[20:23], v[76:79]
    ds_read_b128 a[220:223], v169 offset:21504
    v_mfma_f32_16x16x32_bf16 v[56:59], v[88:91], a[16:19], v[56:59]
    v_mfma_f32_16x16x32_bf16 v[52:55], v[88:91], a[12:15], v[52:55]
    ds_read_b128 a[224:227], v170 offset:21504
    v_mfma_f32_16x16x32_bf16 v[80:83], v[88:91], a[20:23], v[80:83]
    s_waitcnt vmcnt(12)
    v_mfma_f32_16x16x32_bf16 v[28:31], v[92:95], a[24:27], v[28:31]
    buffer_load_dwordx4 v178, s[4:7], s55 offen sc1 lds
    ds_read_b128 a[228:231], v171 offset:21504
    v_mfma_f32_16x16x32_bf16 v[32:35], v[92:95], a[28:31], v[32:35]
    s_waitcnt lgkmcnt(6)
    ds_read_b128 a[32:35], v2 offset:0
    v_mfma_f32_16x16x32_bf16 v[40:43], v[96:99], a[28:31], v[40:43]
    ds_read_b128 v[84:87], v172 offset:26624
    v_mfma_f32_16x16x32_bf16 v[36:39], v[96:99], a[24:27], v[36:39]
    v_mfma_f32_16x16x32_bf16 v[44:47], v[100:103], a[24:27], v[44:47]
    ds_read_b128 v[88:91], v172 offset:27648
    v_mfma_f32_16x16x32_bf16 v[48:51], v[100:103], a[28:31], v[48:51]
    v_mfma_f32_16x16x32_bf16 v[64:67], v[104:107], a[28:31], v[64:67]
    ds_read_b128 v[92:95], v168 offset:21504
    v_mfma_f32_16x16x32_bf16 v[60:63], v[104:107], a[24:27], v[60:63]
    s_waitcnt lgkmcnt(7)
    buffer_load_dwordx4 a[60:63], v5, s[4:7], s52 offen offset:2048 sc1
    v_mfma_f32_16x16x32_bf16 v[68:71], v[108:111], a[24:27], v[68:71]
    v_mfma_f32_16x16x32_bf16 v[72:75], v[108:111], a[28:31], v[72:75]
    ds_read_b128 v[96:99], v172 offset:25600
    v_mfma_f32_16x16x32_bf16 v[24:27], v[112:115], a[28:31], v[24:27]
    s_waitcnt lgkmcnt(4)
    v_mfma_f32_16x16x32_bf16 v[20:23], v[112:115], a[24:27], v[20:23]
    v_mfma_f32_16x16x32_bf16 v[76:79], v[112:115], a[32:35], v[76:79]
    ds_read_b128 v[100:103], v169 offset:28672
    v_mfma_f32_16x16x32_bf16 v[52:55], a[216:219], a[24:27], v[52:55]
    v_mfma_f32_16x16x32_bf16 v[56:59], a[216:219], a[28:31], v[56:59]
    buffer_load_dwordx4 a[64:67], v5, s[4:7], s52 offen offset:2304 sc1
    ds_read_b128 v[104:107], v170 offset:28672
    v_mfma_f32_16x16x32_bf16 v[80:83], a[216:219], a[32:35], v[80:83]
    s_waitcnt vmcnt(13)
    v_mfma_f32_16x16x32_bf16 v[32:35], a[220:223], a[40:43], v[32:35]
    ds_read_b128 v[108:111], v171 offset:28672
    v_mfma_f32_16x16x32_bf16 v[28:31], a[220:223], a[36:39], v[28:31]
    buffer_load_dwordx4 v[116:119], v136, s[4:7], s36 offen sc1
    s_add_u32 s36, s36, 4096
    ds_read_b128 a[44:47], v2 offset:1024
    v_mfma_f32_16x16x32_bf16 v[36:39], a[224:227], a[36:39], v[36:39]
    ds_read_b128 v[112:115], v172 offset:33792
    v_mfma_f32_16x16x32_bf16 v[40:43], a[224:227], a[40:43], v[40:43]
    buffer_load_dwordx4 v[120:123], v136, s[4:7], s36 offen sc1
    s_add_u32 s36, s36, 4096
    v_mfma_f32_16x16x32_bf16 v[48:51], a[228:231], a[40:43], v[48:51]
    ds_read_b128 a[216:219], v172 offset:34816
    v_mfma_f32_16x16x32_bf16 v[44:47], a[228:231], a[36:39], v[44:47]
    s_waitcnt lgkmcnt(7)
    v_mfma_f32_16x16x32_bf16 v[60:63], v[84:87], a[36:39], v[60:63]
    buffer_load_dwordx4 v[124:127], v136, s[4:7], s36 offen sc1
    s_add_u32 s36, s36, 4096
    ds_read_b128 a[220:223], v168 offset:28672
    v_mfma_f32_16x16x32_bf16 v[64:67], v[84:87], a[40:43], v[64:67]
    v_mfma_f32_16x16x32_bf16 v[72:75], v[88:91], a[40:43], v[72:75]
    buffer_load_dwordx4 v[128:131], v136, s[4:7], s36 offen sc1
    s_add_u32 s36, s36, 4096
    v_mfma_f32_16x16x32_bf16 v[68:71], v[88:91], a[36:39], v[68:71]
    ds_read_b128 a[224:227], v172 offset:32768
    v_mfma_f32_16x16x32_bf16 v[20:23], v[92:95], a[36:39], v[20:23]
    s_waitcnt lgkmcnt(4)
    v_mfma_f32_16x16x32_bf16 v[24:27], v[92:95], a[40:43], v[24:27]
    buffer_load_dwordx4 v[132:135], v138, s[4:7], s36 offen sc1
    s_add_u32 s52, s52, 4096
    v_mfma_f32_16x16x32_bf16 v[76:79], v[92:95], a[44:47], v[76:79]
    ds_read_b128 a[228:231], v169 offset:35840
    v_mfma_f32_16x16x32_bf16 v[56:59], v[96:99], a[40:43], v[56:59]
    v_mfma_f32_16x16x32_bf16 v[52:55], v[96:99], a[36:39], v[52:55]
    buffer_load_dwordx4 a[72:75], v5, s[4:7], s52 offen offset:0 sc1
    ds_read_b128 v[84:87], v170 offset:35840
    v_mfma_f32_16x16x32_bf16 v[80:83], v[96:99], a[44:47], v[80:83]
    s_waitcnt vmcnt(13)
    v_mfma_f32_16x16x32_bf16 v[28:31], v[100:103], a[48:51], v[28:31]
    ds_read_b128 v[88:91], v171 offset:35840
    v_mfma_f32_16x16x32_bf16 v[32:35], v[100:103], a[52:55], v[32:35]
    buffer_load_dwordx4 a[76:79], v5, s[4:7], s52 offen offset:256 sc1
    ds_read_b128 a[56:59], v2 offset:2048
    v_mfma_f32_16x16x32_bf16 v[40:43], v[104:107], a[52:55], v[40:43]
    buffer_load_dword v144, v4, s[4:7], s32 offen offset:0 sc1
    ds_read_b128 v[92:95], v172 offset:40960
    v_mfma_f32_16x16x32_bf16 v[36:39], v[104:107], a[48:51], v[36:39]
    s_waitcnt lgkmcnt(7)
    buffer_load_dword v145, v4, s[4:7], s32 offen offset:256 sc1
    v_mfma_f32_16x16x32_bf16 v[44:47], v[108:111], a[48:51], v[44:47]
    buffer_load_dword v146, v4, s[4:7], s32 offen offset:512 sc1
    ds_read_b128 v[96:99], v172 offset:41984
    v_mfma_f32_16x16x32_bf16 v[48:51], v[108:111], a[52:55], v[48:51]
    buffer_load_dword v147, v4, s[4:7], s32 offen offset:768 sc1
    buffer_load_dword v160, v179, s[4:7], s33 offen offset:0 sc1
    v_mfma_f32_16x16x32_bf16 v[64:67], v[112:115], a[52:55], v[64:67]
    buffer_load_dword v161, v179, s[4:7], s33 offen offset:256 sc1
    ds_read_b128 v[100:103], v168 offset:35840
    v_mfma_f32_16x16x32_bf16 v[60:63], v[112:115], a[48:51], v[60:63]
    v_mfma_f32_16x16x32_bf16 v[68:71], a[216:219], a[48:51], v[68:71]
    v_mfma_f32_16x16x32_bf16 v[72:75], a[216:219], a[52:55], v[72:75]
    s_waitcnt lgkmcnt(6)
    buffer_load_dwordx4 a[84:87], v5, s[4:7], s52 offen offset:2048 sc1
    ds_read_b128 v[104:107], v172 offset:39936
    v_mfma_f32_16x16x32_bf16 v[24:27], a[220:223], a[52:55], v[24:27]
    s_waitcnt lgkmcnt(4)
    v_mfma_f32_16x16x32_bf16 v[20:23], a[220:223], a[48:51], v[20:23]
    buffer_load_dwordx4 a[88:91], v5, s[4:7], s52 offen offset:2304 sc1
    s_add_u32 m0, s50, 7168
    s_add_u32 s55, s51, 595968
    v_mfma_f32_16x16x32_bf16 v[76:79], a[220:223], a[56:59], v[76:79]
    s_waitcnt vmcnt(17)
    s_barrier
    ds_read_b128 v[108:111], v169 offset:43008
    v_mfma_f32_16x16x32_bf16 v[52:55], a[224:227], a[48:51], v[52:55]
    buffer_load_dwordx4 v1, s[4:7], s55 offen offset:0 sc1 lds
    v_mfma_f32_16x16x32_bf16 v[56:59], a[224:227], a[52:55], v[56:59]
    ds_read_b128 v[112:115], v170 offset:43008
    v_mfma_f32_16x16x32_bf16 v[80:83], a[224:227], a[56:59], v[80:83]
    s_waitcnt vmcnt(16)
    buffer_load_dwordx4 v1, s[4:7], s55 offen offset:1024 sc1 lds
    v_mfma_f32_16x16x32_bf16 v[32:35], a[228:231], a[64:67], v[32:35]
    ds_read_b128 a[216:219], v171 offset:43008
    v_mfma_f32_16x16x32_bf16 v[28:31], a[228:231], a[60:63], v[28:31]
    s_waitcnt lgkmcnt(6)
    buffer_load_dwordx4 v1, s[4:7], s55 offen offset:2048 sc1 lds
    ds_read_b128 a[68:71], v2 offset:3072
    v_mfma_f32_16x16x32_bf16 v[36:39], v[84:87], a[60:63], v[36:39]
    ds_read_b128 a[220:223], v172 offset:48128
    v_mfma_f32_16x16x32_bf16 v[40:43], v[84:87], a[64:67], v[40:43]
    buffer_load_dwordx4 v1, s[4:7], s55 offen offset:3072 sc1 lds
    s_add_u32 s52, s52, 4096
    v_mfma_f32_16x16x32_bf16 v[48:51], v[88:91], a[64:67], v[48:51]
    ds_read_b128 a[224:227], v172 offset:49152
    v_mfma_f32_16x16x32_bf16 v[44:47], v[88:91], a[60:63], v[44:47]
    v_mfma_f32_16x16x32_bf16 v[60:63], v[92:95], a[60:63], v[60:63]
    buffer_load_dwordx4 a[96:99], v5, s[4:7], s52 offen offset:0 sc1
    ds_read_b128 a[228:231], v168 offset:43008
    v_mfma_f32_16x16x32_bf16 v[64:67], v[92:95], a[64:67], v[64:67]
    s_waitcnt lgkmcnt(7)
    v_mfma_f32_16x16x32_bf16 v[72:75], v[96:99], a[64:67], v[72:75]
    buffer_load_dwordx4 a[100:103], v5, s[4:7], s52 offen offset:256 sc1
    s_add_u32 m0, s50, 11264
    s_add_u32 s55, s51, 600064
    v_mfma_f32_16x16x32_bf16 v[68:71], v[96:99], a[60:63], v[68:71]
    ds_read_b128 v[84:87], v172 offset:47104
    v_mfma_f32_16x16x32_bf16 v[20:23], v[100:103], a[60:63], v[20:23]
    s_waitcnt lgkmcnt(4)
    buffer_load_dwordx4 v1, s[4:7], s55 offen offset:0 sc1 lds
    v_mfma_f32_16x16x32_bf16 v[24:27], v[100:103], a[64:67], v[24:27]
    v_mfma_f32_16x16x32_bf16 v[76:79], v[100:103], a[68:71], v[76:79]
    buffer_load_dwordx4 v1, s[4:7], s55 offen offset:1024 sc1 lds
    ds_read_b128 v[88:91], v169 offset:50176
    v_mfma_f32_16x16x32_bf16 v[56:59], v[104:107], a[64:67], v[56:59]
    v_mfma_f32_16x16x32_bf16 v[52:55], v[104:107], a[60:63], v[52:55]
    ds_read_b128 v[92:95], v170 offset:50176
    v_mfma_f32_16x16x32_bf16 v[80:83], v[104:107], a[68:71], v[80:83]
    s_waitcnt vmcnt(16)
    v_mfma_f32_16x16x32_bf16 v[28:31], v[108:111], a[72:75], v[28:31]
    ds_read_b128 v[96:99], v171 offset:50176
    v_add_f32 v116, v116, v120
    v_add_f32 v117, v117, v121
    v_add_f32 v118, v118, v122
    v_mfma_f32_16x16x32_bf16 v[32:35], v[108:111], a[76:79], v[32:35]
    buffer_load_dwordx4 v1, s[4:7], s55 offen offset:2048 sc1 lds
    s_add_u32 m0, s38, 139264
    ds_read_b128 a[80:83], v2 offset:4096
    v_mfma_f32_16x16x32_bf16 v[40:43], v[112:115], a[76:79], v[40:43]
    s_add_u32 s55, s39, 20480
    ds_read_b128 v[100:103], v172 offset:55296
    v_add_f32 v119, v119, v123
    v_add_f32 v116, v116, v124
    v_add_f32 v117, v117, v125
    v_mfma_f32_16x16x32_bf16 v[36:39], v[112:115], a[72:75], v[36:39]
    v_add_f32 v118, v118, v126
    v_add_f32 v119, v119, v127
    v_add_f32 v116, v116, v128
    v_add_f32 v117, v117, v129
    v_mfma_f32_16x16x32_bf16 v[44:47], a[216:219], a[72:75], v[44:47]
    ds_read_b128 v[104:107], v172 offset:56320
    v_add_f32 v118, v118, v130
    v_add_f32 v119, v119, v131
    v_add_f32 v116, v116, v132
    v_mfma_f32_16x16x32_bf16 v[48:51], a[216:219], a[76:79], v[48:51]
    s_waitcnt lgkmcnt(7)
    buffer_load_dwordx4 v178, s[4:7], s55 offen sc1 lds
    v_add_f32 v117, v117, v133
    v_mfma_f32_16x16x32_bf16 v[64:67], a[220:223], a[76:79], v[64:67]
    ds_read_b128 v[108:111], v168 offset:50176
    v_add_f32 v118, v118, v134
    v_add_f32 v119, v119, v135
    v_add_f32_dpp v116, v116, v116 row_ror:8 row_mask:0xf bank_mask:0xf
    v_mfma_f32_16x16x32_bf16 v[60:63], a[220:223], a[72:75], v[60:63]
    v_add_f32_dpp v117, v117, v117 row_ror:8 row_mask:0xf bank_mask:0xf
    v_add_f32_dpp v118, v118, v118 row_ror:8 row_mask:0xf bank_mask:0xf
    v_add_f32_dpp v119, v119, v119 row_ror:8 row_mask:0xf bank_mask:0xf
    v_mov_b32 v120, v116
    v_mfma_f32_16x16x32_bf16 v[68:71], a[224:227], a[72:75], v[68:71]
    v_mov_b32 v121, v117
    v_mov_b32 v122, v118
    v_mov_b32 v123, v119
    v_mfma_f32_16x16x32_bf16 v[72:75], a[224:227], a[76:79], v[72:75]
    buffer_load_dwordx4 a[108:111], v5, s[4:7], s52 offen offset:2048 sc1
    ds_read_b128 v[112:115], v172 offset:54272
    v_mfma_f32_16x16x32_bf16 v[24:27], a[228:231], a[76:79], v[24:27]
    s_waitcnt lgkmcnt(4)
    v_permlane16_swap_b32 v116, v120
    v_permlane16_swap_b32 v117, v121
    v_mfma_f32_16x16x32_bf16 v[20:23], a[228:231], a[72:75], v[20:23]
    v_permlane16_swap_b32 v118, v122
    v_permlane16_swap_b32 v119, v123
    v_mfma_f32_16x16x32_bf16 v[76:79], a[228:231], a[80:83], v[76:79]
    ds_read_b128 a[216:219], v169 offset:57344
    v_add_f32 v116, v116, v120
    v_add_f32 v117, v117, v121
    v_add_f32 v118, v118, v122
    v_mfma_f32_16x16x32_bf16 v[52:55], v[84:87], a[72:75], v[52:55]
    buffer_load_dwordx4 a[112:115], v5, s[4:7], s52 offen offset:2304 sc1
    s_add_u32 s52, s52, 4096
    v_add_f32 v119, v119, v123
    v_mfma_f32_16x16x32_bf16 v[56:59], v[84:87], a[76:79], v[56:59]
    ds_read_b128 a[220:223], v170 offset:57344
    v_mov_b32 v120, v116
    v_mov_b32 v121, v117
    v_mov_b32 v122, v118
    v_mfma_f32_16x16x32_bf16 v[80:83], v[84:87], a[80:83], v[80:83]
    s_waitcnt vmcnt(12)
    v_mov_b32 v123, v119
    v_permlane32_swap_b32 v116, v120
    v_mfma_f32_16x16x32_bf16 v[32:35], v[88:91], a[88:91], v[32:35]
    buffer_load_dwordx4 a[120:123], v5, s[4:7], s52 offen offset:0 sc1
    ds_read_b128 a[224:227], v171 offset:57344
    v_mfma_f32_16x16x32_bf16 v[28:31], v[88:91], a[84:87], v[28:31]
    ds_read_b128 a[92:95], v2 offset:5120
    v_permlane32_swap_b32 v117, v121
    v_mfma_f32_16x16x32_bf16 v[36:39], v[92:95], a[84:87], v[36:39]
    ds_read_b128 a[228:231], v172 offset:62464
    v_permlane32_swap_b32 v118, v122
    v_mfma_f32_16x16x32_bf16 v[40:43], v[92:95], a[88:91], v[40:43]
    s_waitcnt lgkmcnt(7)
    buffer_load_dwordx4 a[124:127], v5, s[4:7], s52 offen offset:256 sc1
    s_add_u32 m0, s50, 35840
    v_mfma_f32_16x16x32_bf16 v[48:51], v[96:99], a[88:91], v[48:51]
    s_add_u32 s55, s51, 624640
    ds_read_b128 v[84:87], v172 offset:63488
    v_permlane32_swap_b32 v119, v123
    v_add_f32 v116, v116, v120
    v_mfma_f32_16x16x32_bf16 v[44:47], v[96:99], a[84:87], v[44:47]
    buffer_load_dwordx4 v1, s[4:7], s55 offen offset:0 sc1 lds
    v_add_f32 v117, v117, v121
    v_add_f32 v118, v118, v122
    v_mfma_f32_16x16x32_bf16 v[60:63], v[100:103], a[84:87], v[60:63]
    ds_read_b128 v[88:91], v168 offset:57344
    v_add_f32 v119, v119, v123
    v_mfma_f32_16x16x32_bf16 v[64:67], v[100:103], a[88:91], v[64:67]
    ds_write_b128 v137, v[116:119]
    v_mfma_f32_16x16x32_bf16 v[72:75], v[104:107], a[88:91], v[72:75]
    buffer_load_dwordx4 v1, s[4:7], s55 offen offset:1024 sc1 lds
    v_mfma_f32_16x16x32_bf16 v[68:71], v[104:107], a[84:87], v[68:71]
    s_waitcnt lgkmcnt(7)
    ds_read_b128 v[92:95], v172 offset:61440
    v_mfma_f32_16x16x32_bf16 v[20:23], v[108:111], a[84:87], v[20:23]
    s_waitcnt lgkmcnt(5)
    buffer_load_dwordx4 v1, s[4:7], s55 offen offset:2048 sc1 lds
    v_mfma_f32_16x16x32_bf16 v[24:27], v[108:111], a[88:91], v[24:27]
    v_mfma_f32_16x16x32_bf16 v[76:79], v[108:111], a[92:95], v[76:79]
    ds_read_b128 v[96:99], v174 offset:0
    v_mfma_f32_16x16x32_bf16 v[56:59], v[112:115], a[88:91], v[56:59]
    buffer_load_dwordx4 v1, s[4:7], s55 offen offset:3072 sc1 lds
    v_mfma_f32_16x16x32_bf16 v[52:55], v[112:115], a[84:87], v[52:55]
    ds_read_b128 v[100:103], v175 offset:0
    v_mfma_f32_16x16x32_bf16 v[80:83], v[112:115], a[92:95], v[80:83]
    s_waitcnt vmcnt(12)
    v_mfma_f32_16x16x32_bf16 v[28:31], a[216:219], a[96:99], v[28:31]
    ds_read_b128 v[104:107], v176 offset:0
    v_mfma_f32_16x16x32_bf16 v[32:35], a[216:219], a[100:103], v[32:35]
    s_waitcnt lgkmcnt(7)
    buffer_load_dwordx4 a[132:135], v5, s[4:7], s52 offen offset:2048 sc1
    ds_read_b128 a[104:107], v2 offset:6144
    v_mfma_f32_16x16x32_bf16 v[40:43], a[220:223], a[100:103], v[40:43]
    s_load_dword s3, s[12:13], 140 glc
    ds_read_b128 v[108:111], v1 offset:5120
    v_mfma_f32_16x16x32_bf16 v[36:39], a[220:223], a[96:99], v[36:39]
    v_mfma_f32_16x16x32_bf16 v[44:47], a[224:227], a[96:99], v[44:47]
    buffer_load_dwordx4 a[136:139], v5, s[4:7], s52 offen offset:2304 sc1
    s_add_u32 m0, s50, 39936
    ds_read_b128 v[112:115], v1 offset:6144
    v_mfma_f32_16x16x32_bf16 v[48:51], a[224:227], a[100:103], v[48:51]
    s_add_u32 s55, s51, 628736
    v_mfma_f32_16x16x32_bf16 v[64:67], a[228:231], a[100:103], v[64:67]
    ds_read_b128 a[216:219], v173 offset:0
    v_mfma_f32_16x16x32_bf16 v[60:63], a[228:231], a[96:99], v[60:63]
    s_waitcnt lgkmcnt(7)
    buffer_load_dwordx4 v1, s[4:7], s55 offen offset:0 sc1 lds
    v_mfma_f32_16x16x32_bf16 v[68:71], v[84:87], a[96:99], v[68:71]
    v_mfma_f32_16x16x32_bf16 v[72:75], v[84:87], a[100:103], v[72:75]
    ds_read_b128 a[220:223], v1 offset:4096
    v_mfma_f32_16x16x32_bf16 v[24:27], v[88:91], a[100:103], v[24:27]
    s_waitcnt lgkmcnt(4)
    buffer_load_dwordx4 v1, s[4:7], s55 offen offset:1024 sc1 lds
    v_mfma_f32_16x16x32_bf16 v[20:23], v[88:91], a[96:99], v[20:23]
    v_mfma_f32_16x16x32_bf16 v[76:79], v[88:91], a[104:107], v[76:79]
    s_waitcnt vmcnt(12)
    s_barrier
    ds_read_b128 a[224:227], v174 offset:7168
    v_mfma_f32_16x16x32_bf16 v[52:55], v[92:95], a[96:99], v[52:55]
    buffer_load_dwordx4 v1, s[4:7], s55 offen offset:2048 sc1 lds
    s_add_u32 m0, s38, 143360
    s_add_u32 s55, s39, 28672
    v_mfma_f32_16x16x32_bf16 v[56:59], v[92:95], a[100:103], v[56:59]
    buffer_load_dwordx4 v178, s[4:7], s55 offen sc1 lds
    s_add_u32 s52, s52, 4096
    ds_read_b128 a[228:231], v175 offset:7168
    v_mfma_f32_16x16x32_bf16 v[80:83], v[92:95], a[104:107], v[80:83]
    s_waitcnt vmcnt(12)
    s_xor_b32 s35, s20, 0
    s_lshl_b32 s35, s35, 6
    v_add_u32 v213, s35, v212
    v_mfma_f32_16x16x32_bf16 v[32:35], v[96:99], a[112:115], v[32:35]
    ds_read_b128 v[116:119], v213
    s_xor_b32 s35, s20, 1
    s_lshl_b32 s35, s35, 6
    ds_read_b128 v[84:87], v176 offset:7168
    v_mfma_f32_16x16x32_bf16 v[28:31], v[96:99], a[108:111], v[28:31]
    ds_read_b128 a[116:119], v2 offset:7168
    v_add_u32 v213, s35, v212
    v_mfma_f32_16x16x32_bf16 v[36:39], v[100:103], a[108:111], v[36:39]
    ds_read_b128 v[120:123], v213
    s_xor_b32 s35, s20, 2
    s_lshl_b32 s35, s35, 6
    ds_read_b128 v[88:91], v1 offset:12288
    v_mfma_f32_16x16x32_bf16 v[40:43], v[100:103], a[112:115], v[40:43]
    v_add_u32 v213, s35, v212
    v_mfma_f32_16x16x32_bf16 v[48:51], v[104:107], a[112:115], v[48:51]
    ds_read_b128 v[124:127], v213
    s_xor_b32 s35, s20, 3
    s_lshl_b32 s35, s35, 6
    ds_read_b128 v[92:95], v1 offset:13312
    v_mfma_f32_16x16x32_bf16 v[44:47], v[104:107], a[108:111], v[44:47]
    s_waitcnt lgkmcnt(10)
    buffer_load_dwordx4 a[144:147], v5, s[4:7], s52 offen offset:0 sc1
    v_add_u32 v213, s35, v212
    v_mfma_f32_16x16x32_bf16 v[60:63], v[108:111], a[108:111], v[60:63]
    ds_read_b128 v[128:131], v213
    ds_read_b128 v[132:135], v212 offset:256
    ds_read_b128 v[136:139], v212 offset:320
    ds_read_b128 v[96:99], v173 offset:7168
    v_mfma_f32_16x16x32_bf16 v[64:67], v[108:111], a[112:115], v[64:67]
    ds_read_b128 v[140:143], v212 offset:384
    v_add_f32 v144, v144, v145
    v_add_f32 v160, v160, v161
    v_add_f32 v144, v144, v146
    v_mfma_f32_16x16x32_bf16 v[72:75], v[112:115], a[112:115], v[72:75]
    v_add_f32 v144, v144, v147
    v_mov_b32 v161, v160
    v_mfma_f32_16x16x32_bf16 v[68:71], v[112:115], a[108:111], v[68:71]
    ds_read_b128 v[100:103], v1 offset:11264
    v_permlane16_swap_b32 v160, v161
    v_add_f32 v160, v160, v161
    v_mfma_f32_16x16x32_bf16 v[20:23], a[216:219], a[108:111], v[20:23]
    s_waitcnt lgkmcnt(10)
    v_mov_b32 v145, v144
    v_mov_b32 v161, v160
    v_mfma_f32_16x16x32_bf16 v[24:27], a[216:219], a[112:115], v[24:27]
    v_permlane32_swap_b32 v144, v145
    v_permlane32_swap_b32 v160, v161
    v_mfma_f32_16x16x32_bf16 v[76:79], a[216:219], a[116:119], v[76:79]
    ds_read_b128 v[104:107], v174 offset:14336
    v_mul_f32 v180, 0x3ae38e39, v144
    v_mul_f32 v184, 0x3ae38e39, v160
    v_mul_f32 v145, 0x3ae38e39, v145
    v_mfma_f32_16x16x32_bf16 v[56:59], a[220:223], a[112:115], v[56:59]
    buffer_load_dwordx4 a[148:151], v5, s[4:7], s52 offen offset:256 sc1
    v_mul_f32 v161, 0x3ae38e39, v161
    v_fma_f32 v145, -v180, v180, v145
    v_mfma_f32_16x16x32_bf16 v[52:55], a[220:223], a[108:111], v[52:55]
    ds_read_b128 v[108:111], v175 offset:14336
    v_fma_f32 v161, -v184, v184, v161
    v_max_f32 v145, 0, v145
    v_max_f32 v161, 0, v161
    v_mfma_f32_16x16x32_bf16 v[80:83], a[220:223], a[116:119], v[80:83]
    s_waitcnt vmcnt(12)
    v_add_f32 v145, 0x3727c5ac, v145
    v_add_f32 v161, 0x3727c5ac, v161
    v_rsq_f32 v186, v145
    v_mfma_f32_16x16x32_bf16 v[28:31], a[224:227], a[120:123], v[28:31]
    buffer_load_dwordx4 a[156:159], v5, s[4:7], s52 offen offset:2048 sc1
    ds_read_b128 v[112:115], v176 offset:14336
    v_mfma_f32_16x16x32_bf16 v[32:35], a[224:227], a[124:127], v[32:35]
    ds_read_b128 a[128:131], v3 offset:8192
    v_rsq_f32 v188, v161
    v_sub_f32 v180, 0, v180
    v_mfma_f32_16x16x32_bf16 v[40:43], a[228:231], a[124:127], v[40:43]
    ds_read_b128 a[216:219], v1 offset:19456
    v_sub_f32 v184, 0, v184
    v_mov_b32 v182, v180
    v_mov_b32 v187, v186
    v_mfma_f32_16x16x32_bf16 v[36:39], a[228:231], a[120:123], v[36:39]
    s_waitcnt lgkmcnt(11)
    buffer_load_dwordx4 a[160:163], v5, s[4:7], s52 offen offset:2304 sc1
    s_add_u32 s52, s52, 4096
    v_mfma_f32_16x16x32_bf16 v[44:47], v[84:87], a[120:123], v[44:47]
    ds_read_b128 a[220:223], v1 offset:20480
    v_mov_b32 v210, 0
    v_permlane16_swap_b32 v180, v182
    v_mfma_f32_16x16x32_bf16 v[48:51], v[84:87], a[124:127], v[48:51]
    buffer_load_dwordx4 a[168:171], v5, s[4:7], s52 offen offset:0 sc1
    v_permlane16_swap_b32 v186, v187
    v_mfma_f32_16x16x32_bf16 v[64:67], v[88:91], a[124:127], v[64:67]
    s_nop 0
    ds_read_b128 a[224:227], v173 offset:14336
    v_fmac_f32 v28, v120, v180
    v_fmac_f32 v29, v121, v180
    v_fmac_f32 v30, v122, v180
    v_mfma_f32_16x16x32_bf16 v[60:63], v[88:91], a[120:123], v[60:63]
    v_fmac_f32 v31, v123, v180
    v_fmac_f32 v32, v120, v182
    v_fmac_f32 v33, v121, v182
    v_fmac_f32 v34, v122, v182
    v_mfma_f32_16x16x32_bf16 v[68:71], v[92:95], a[120:123], v[68:71]
    buffer_load_dwordx4 a[172:175], v5, s[4:7], s52 offen offset:256 sc1
    v_fmac_f32 v35, v123, v182
    v_fmac_f32 v40, v124, v182
    v_mfma_f32_16x16x32_bf16 v[72:75], v[92:95], a[124:127], v[72:75]
    s_waitcnt lgkmcnt(6)
    ds_read_b128 a[228:231], v1 offset:18432
    v_fmac_f32 v41, v125, v182
    v_fmac_f32 v42, v126, v182
    v_fmac_f32 v43, v127, v182
    v_mfma_f32_16x16x32_bf16 v[24:27], v[96:99], a[124:127], v[24:27]
    s_waitcnt lgkmcnt(4)
    buffer_load_dwordx4 a[180:183], v5, s[4:7], s52 offen offset:2048 sc1
    v_fmac_f32 v36, v124, v180
    v_mfma_f32_16x16x32_bf16 v[20:23], v[96:99], a[120:123], v[20:23]
    v_fmac_f32 v37, v125, v180
    v_fmac_f32 v38, v126, v180
    v_fmac_f32 v39, v127, v180
    v_fmac_f32 v44, v128, v180
    v_mfma_f32_16x16x32_bf16 v[76:79], v[96:99], a[128:131], v[76:79]
    ds_read_b128 v[84:87], v174 offset:21504
    v_fmac_f32 v45, v129, v180
    v_fmac_f32 v46, v130, v180
    v_fmac_f32 v47, v131, v180
    v_mfma_f32_16x16x32_bf16 v[52:55], v[100:103], a[120:123], v[52:55]
    buffer_load_dwordx4 a[184:187], v5, s[4:7], s52 offen offset:2304 sc1
    s_add_u32 s52, s52, 4096
    v_fmac_f32 v48, v128, v182
    v_mfma_f32_16x16x32_bf16 v[56:59], v[100:103], a[124:127], v[56:59]
    ds_read_b128 v[88:91], v175 offset:21504
    v_fmac_f32 v49, v129, v182
    v_fmac_f32 v50, v130, v182
    v_fmac_f32 v51, v131, v182
    v_mfma_f32_16x16x32_bf16 v[80:83], v[100:103], a[128:131], v[80:83]
    s_waitcnt vmcnt(12)
    v_fmac_f32 v64, v136, v182
    v_fmac_f32 v65, v137, v182
    v_fmac_f32 v66, v138, v182
    v_fmac_f32 v67, v139, v182
    v_mfma_f32_16x16x32_bf16 v[32:35], v[104:107], a[136:139], v[32:35]
    buffer_load_dwordx4 a[192:195], v5, s[4:7], s52 offen offset:0 sc1
    ds_read_b128 v[92:95], v176 offset:21504
    v_fmac_f32 v60, v136, v180
    v_mfma_f32_16x16x32_bf16 v[28:31], v[104:107], a[132:135], v[28:31]
    s_waitcnt lgkmcnt(6)
    ds_read_b128 a[140:143], v3 offset:9216
    v_fmac_f32 v61, v137, v180
    v_fmac_f32 v62, v138, v180
    v_fmac_f32 v63, v139, v180
    v_mfma_f32_16x16x32_bf16 v[36:39], v[108:111], a[132:135], v[36:39]
    ds_read_b128 v[96:99], v1 offset:26624
    v_fmac_f32 v68, v140, v180
    v_fmac_f32 v69, v141, v180
    v_fmac_f32 v70, v142, v180
    v_mfma_f32_16x16x32_bf16 v[40:43], v[108:111], a[136:139], v[40:43]
    buffer_load_dwordx4 a[196:199], v5, s[4:7], s52 offen offset:256 sc1
    v_fmac_f32 v71, v143, v180
    v_fmac_f32 v72, v140, v182
    v_mfma_f32_16x16x32_bf16 v[48:51], v[112:115], a[136:139], v[48:51]
    ds_read_b128 v[100:103], v1 offset:27648
    v_fmac_f32 v73, v141, v182
    v_fmac_f32 v74, v142, v182
    v_fmac_f32 v75, v143, v182
    v_mfma_f32_16x16x32_bf16 v[44:47], v[112:115], a[132:135], v[44:47]
    buffer_load_dwordx4 a[204:207], v5, s[4:7], s52 offen offset:2048 sc1
    v_fmac_f32 v24, v116, v182
    v_fmac_f32 v25, v117, v182
    v_mfma_f32_16x16x32_bf16 v[60:63], a[216:219], a[132:135], v[60:63]
    ds_read_b128 v[104:107], v173 offset:21504
    v_fmac_f32 v26, v118, v182
    v_fmac_f32 v27, v119, v182
    v_fmac_f32 v20, v116, v180
    v_mfma_f32_16x16x32_bf16 v[64:67], a[216:219], a[136:139], v[64:67]
    s_waitcnt lgkmcnt(7)
    v_fmac_f32 v21, v117, v180
    v_fmac_f32 v22, v118, v180
    v_fmac_f32 v23, v119, v180
    v_fmac_f32 v76, v116, v184
    v_mfma_f32_16x16x32_bf16 v[72:75], a[220:223], a[136:139], v[72:75]
    buffer_load_dwordx4 a[208:211], v5, s[4:7], s52 offen offset:2304 sc1
    v_fmac_f32 v77, v117, v184
    v_fmac_f32 v78, v118, v184
    v_mfma_f32_16x16x32_bf16 v[68:71], a[220:223], a[132:135], v[68:71]
    s_waitcnt lgkmcnt(0)
    s_cmp_lt_u32 s3, 18
    s_cbranch_scc1 L_inte_chk_15_slow
L_inte_chk_15_back:
    ds_read_b128 v[108:111], v1 offset:25600
    v_fmac_f32 v79, v119, v184
    v_mfma_f32_16x16x32_bf16 v[20:23], a[224:227], a[132:135], v[20:23]
    buffer_store_dwordx4 v[214:217], v252, s[4:7], s25 offen offset:0 sc1
    v_mfma_f32_16x16x32_bf16 v[24:27], a[224:227], a[136:139], v[24:27]
    s_add_u32 s54, s54, 9216
    v_fmac_f32 v52, v132, v180
    v_fmac_f32 v53, v133, v180
    v_fmac_f32 v54, v134, v180
    v_fmac_f32 v55, v135, v180
    v_mfma_f32_16x16x32_bf16 v[76:79], a[224:227], a[140:143], v[76:79]
    ds_read_b128 v[112:115], v174 offset:28672
    v_fmac_f32 v80, v132, v184
    v_fmac_f32 v81, v133, v184
    v_fmac_f32 v82, v134, v184
    v_mfma_f32_16x16x32_bf16 v[56:59], a[228:231], a[136:139], v[56:59]
    buffer_store_dwordx4 v[218:221], v252, s[4:7], s25 offen offset:1024 sc1
    v_mfma_f32_16x16x32_bf16 v[52:55], a[228:231], a[132:135], v[52:55]
    ds_read_b128 a[216:219], v175 offset:28672
    v_mfma_f32_16x16x32_bf16 v[80:83], a[228:231], a[140:143], v[80:83]
    s_waitcnt vmcnt(12)
    v_mfma_f32_16x16x32_bf16 v[28:31], v[84:87], a[144:147], v[28:31]
    ds_read_b128 a[220:223], v176 offset:28672
    v_mfma_f32_16x16x32_bf16 v[32:35], v[84:87], a[148:151], v[32:35]
    ds_read_b128 a[152:155], v3 offset:10240
    v_fmac_f32 v56, v132, v182
    v_fmac_f32 v57, v133, v182
    v_fmac_f32 v58, v134, v182
    v_mfma_f32_16x16x32_bf16 v[40:43], v[88:91], a[148:151], v[40:43]
    ds_read_b128 a[224:227], v1 offset:33792
    v_fmac_f32 v59, v135, v182
    v_fmac_f32 v83, v135, v184
    v_mfma_f32_16x16x32_bf16 v[36:39], v[88:91], a[144:147], v[36:39]
    v_mfma_f32_16x16x32_bf16 v[44:47], v[92:95], a[144:147], v[44:47]
    ds_read_b128 a[228:231], v1 offset:34816
    v_mfma_f32_16x16x32_bf16 v[48:51], v[92:95], a[148:151], v[48:51]
    buffer_load_dwordx4 a[0:3], v208, s[4:7], s54 offen sc1
    v_mfma_f32_16x16x32_bf16 v[64:67], v[96:99], a[148:151], v[64:67]
    ds_read_b128 v[84:87], v173 offset:28672
    v_mfma_f32_16x16x32_bf16 v[60:63], v[96:99], a[144:147], v[60:63]
    v_mfma_f32_16x16x32_bf16 v[68:71], v[100:103], a[144:147], v[68:71]
    v_mfma_f32_16x16x32_bf16 v[72:75], v[100:103], a[148:151], v[72:75]
    s_barrier
    ds_read_b128 v[88:91], v1 offset:32768
    ds_read_b128 v[92:95], v174 offset:35840
    v_mfma_f32_16x16x32_bf16 v[24:27], v[104:107], a[148:151], v[24:27]
    s_waitcnt lgkmcnt(5)
    v_mfma_f32_16x16x32_bf16 v[20:23], v[104:107], a[144:147], v[20:23]
    ds_read_b128 v[96:99], v174 offset:43008
    ds_read_b128 v[100:103], v174 offset:50176
    v_mfma_f32_16x16x32_bf16 v[76:79], v[104:107], a[152:155], v[76:79]
    v_mfma_f32_16x16x32_bf16 v[52:55], v[108:111], a[144:147], v[52:55]
    ds_read_b128 v[104:107], v174 offset:57344
    v_mfma_f32_16x16x32_bf16 v[56:59], v[108:111], a[148:151], v[56:59]
    buffer_store_dwordx4 v[222:225], v252, s[4:7], s25 offen offset:2048 sc1
    v_mfma_f32_16x16x32_bf16 v[80:83], v[108:111], a[152:155], v[80:83]
    s_waitcnt vmcnt(12)
    ds_read_b128 v[108:111], v175 offset:35840
    v_mfma_f32_16x16x32_bf16 v[32:35], v[112:115], a[160:163], v[32:35]
    buffer_load_dwordx4 a[4:7], v208, s[4:7], s54 offen offset:1024 sc1
    v_mfma_f32_16x16x32_bf16 v[28:31], v[112:115], a[156:159], v[28:31]
    ds_read_b128 v[112:115], v175 offset:43008
    ds_read_b128 a[164:167], v3 offset:11264
    v_mfma_f32_16x16x32_bf16 v[36:39], a[216:219], a[156:159], v[36:39]
    buffer_store_dwordx4 v[226:229], v252, s[4:7], s25 offen offset:3072 sc1
    v_mfma_f32_16x16x32_bf16 v[40:43], a[216:219], a[160:163], v[40:43]
    s_waitcnt lgkmcnt(9)
    ds_read_b128 a[216:219], v175 offset:50176
    v_mfma_f32_16x16x32_bf16 v[48:51], a[220:223], a[160:163], v[48:51]
    buffer_load_dwordx4 a[8:11], v209, s[4:7], s54 offen sc1
    v_mfma_f32_16x16x32_bf16 v[44:47], a[220:223], a[156:159], v[44:47]
    s_add_u32 s25, s25, 4096
    s_add_u32 s54, s54, 9216
    ds_read_b128 a[220:223], v175 offset:57344
    v_mfma_f32_16x16x32_bf16 v[60:63], a[224:227], a[156:159], v[60:63]
    buffer_store_dwordx4 v[230:233], v252, s[4:7], s25 offen offset:0 sc1
    v_mfma_f32_16x16x32_bf16 v[64:67], a[224:227], a[160:163], v[64:67]
    ds_read_b128 a[224:227], v176 offset:35840
    v_mfma_f32_16x16x32_bf16 v[72:75], a[228:231], a[160:163], v[72:75]
    buffer_load_dwordx4 a[12:15], v208, s[4:7], s54 offen sc1
    v_mfma_f32_16x16x32_bf16 v[68:71], a[228:231], a[156:159], v[68:71]
    s_waitcnt lgkmcnt(9)
    ds_read_b128 a[228:231], v176 offset:43008
    v_mfma_f32_16x16x32_bf16 v[20:23], v[84:87], a[156:159], v[20:23]
    s_waitcnt lgkmcnt(4)
    buffer_store_dwordx4 v[234:237], v252, s[4:7], s25 offen offset:1024 sc1
    v_mfma_f32_16x16x32_bf16 v[24:27], v[84:87], a[160:163], v[24:27]
    buffer_load_dwordx4 a[16:19], v208, s[4:7], s54 offen offset:1024 sc1
    v_mfma_f32_16x16x32_bf16 v[76:79], v[84:87], a[164:167], v[76:79]
    ds_read_b128 v[84:87], v176 offset:50176
    v_mfma_f32_16x16x32_bf16 v[56:59], v[88:91], a[160:163], v[56:59]
    buffer_store_dwordx4 v[238:241], v252, s[4:7], s25 offen offset:2048 sc1
    v_mfma_f32_16x16x32_bf16 v[52:55], v[88:91], a[156:159], v[52:55]
    v_mfma_f32_16x16x32_bf16 v[80:83], v[88:91], a[164:167], v[80:83]
    s_waitcnt vmcnt(12)
    ds_read_b128 v[88:91], v176 offset:57344
    v_mfma_f32_16x16x32_bf16 v[28:31], v[92:95], a[168:171], v[28:31]
    v_mfma_f32_16x16x32_bf16 v[28:31], v[96:99], a[180:183], v[28:31]
    ds_read_b128 a[176:179], v3 offset:12288
    v_mfma_f32_16x16x32_bf16 v[28:31], v[100:103], a[192:195], v[28:31]
    v_mfma_f32_16x16x32_bf16 v[28:31], v[104:107], a[204:207], v[28:31]
    ds_read_b128 a[188:191], v3 offset:13312
    v_mfma_f32_16x16x32_bf16 v[32:35], v[104:107], a[208:211], v[32:35]
    buffer_load_dwordx4 a[20:23], v209, s[4:7], s54 offen sc1
    v_mfma_f32_16x16x32_bf16 v[32:35], v[100:103], a[196:199], v[32:35]
    ds_read_b128 a[200:203], v3 offset:14336
    v_mfma_f32_16x16x32_bf16 v[32:35], v[96:99], a[184:187], v[32:35]
    v_mfma_f32_16x16x32_bf16 v[32:35], v[92:95], a[172:175], v[32:35]
    s_waitcnt lgkmcnt(7)
    ds_read_b128 v[92:95], v1 offset:40960
    ds_read_b128 v[96:99], v1 offset:48128
    ds_read_b128 a[212:215], v3 offset:15360
    v_mfma_f32_16x16x32_bf16 v[40:43], v[108:111], a[172:175], v[40:43]
    v_cvt_pk_bf16_f32 v28, v28, v29
    v_cvt_pk_bf16_f32 v29, v30, v31
    v_mfma_f32_16x16x32_bf16 v[40:43], v[112:115], a[184:187], v[40:43]
    ds_read_b128 v[100:103], v1 offset:55296
    ds_read_b128 v[104:107], v1 offset:62464
    v_mfma_f32_16x16x32_bf16 v[40:43], a[216:219], a[196:199], v[40:43]
    buffer_store_dwordx4 v[242:245], v252, s[4:7], s25 offen offset:3072 sc1
    v_mfma_f32_16x16x32_bf16 v[40:43], a[220:223], a[208:211], v[40:43]
    s_add_u32 s54, s54, 9216
    s_add_u32 s25, s25, 4096
    v_mfma_f32_16x16x32_bf16 v[36:39], a[220:223], a[204:207], v[36:39]
    ds_write_b64 v199, v[28:29] offset:0
    v_cvt_pk_bf16_f32 v32, v32, v33
    v_mfma_f32_16x16x32_bf16 v[36:39], a[216:219], a[192:195], v[36:39]
    buffer_load_dwordx4 a[24:27], v208, s[4:7], s54 offen sc1
    v_mfma_f32_16x16x32_bf16 v[36:39], v[112:115], a[180:183], v[36:39]
    v_cvt_pk_bf16_f32 v33, v34, v35
    v_cvt_pk_bf16_f32 v40, v40, v41
    v_mfma_f32_16x16x32_bf16 v[36:39], v[108:111], a[168:171], v[36:39]
    s_waitcnt lgkmcnt(9)
    ds_read_b128 v[108:111], v1 offset:41984
    ds_read_b128 v[112:115], v1 offset:49152
    v_mfma_f32_16x16x32_bf16 v[44:47], a[224:227], a[168:171], v[44:47]
    ds_write_b64 v199, v[32:33] offset:3840
    v_cvt_pk_bf16_f32 v41, v42, v43
    v_mfma_f32_16x16x32_bf16 v[44:47], a[228:231], a[180:183], v[44:47]
    ds_read_b128 a[216:219], v1 offset:56320
    ds_read_b128 a[220:223], v1 offset:63488
    v_mfma_f32_16x16x32_bf16 v[44:47], v[84:87], a[192:195], v[44:47]
    buffer_store_dwordx4 v[246:249], v252, s[4:7], s25 offen offset:0 sc1
    v_mfma_f32_16x16x32_bf16 v[44:47], v[88:91], a[204:207], v[44:47]
    ds_write_b64 v200, v[40:41] offset:3840
    v_cvt_pk_bf16_f32 v36, v36, v37
    v_mfma_f32_16x16x32_bf16 v[48:51], v[88:91], a[208:211], v[48:51]
    v_cvt_pk_bf16_f32 v37, v38, v39
    v_mfma_f32_16x16x32_bf16 v[48:51], v[84:87], a[196:199], v[48:51]
    ds_write_b64 v200, v[36:37] offset:0
    v_mfma_f32_16x16x32_bf16 v[48:51], a[228:231], a[184:187], v[48:51]
    buffer_load_dwordx4 a[28:31], v208, s[4:7], s54 offen offset:1024 sc1
    v_mfma_f32_16x16x32_bf16 v[48:51], a[224:227], a[172:175], v[48:51]
    s_waitcnt lgkmcnt(8)
    ds_read_b128 a[224:227], v173 offset:35840
    ds_read_b128 a[228:231], v173 offset:43008
    v_mfma_f32_16x16x32_bf16 v[64:67], v[92:95], a[172:175], v[64:67]
    v_cvt_pk_bf16_f32 v44, v44, v45
    v_cvt_pk_bf16_f32 v45, v46, v47
    v_mfma_f32_16x16x32_bf16 v[64:67], v[96:99], a[184:187], v[64:67]
    ds_read_b128 v[84:87], v173 offset:50176
    ds_read_b128 v[88:91], v173 offset:57344
    v_mfma_f32_16x16x32_bf16 v[64:67], v[100:103], a[196:199], v[64:67]
    ds_write_b64 v201, v[44:45] offset:0
    v_cvt_pk_bf16_f32 v48, v48, v49
    v_mfma_f32_16x16x32_bf16 v[64:67], v[104:107], a[208:211], v[64:67]
    buffer_store_dwordx2 v[250:251], v254, s[4:7], s26 offen sc1
    v_mfma_f32_16x16x32_bf16 v[60:63], v[104:107], a[204:207], v[60:63]
    v_cvt_pk_bf16_f32 v49, v50, v51
    v_mfma_f32_16x16x32_bf16 v[60:63], v[100:103], a[192:195], v[60:63]
    ds_write_b64 v201, v[48:49] offset:3840
    v_mfma_f32_16x16x32_bf16 v[60:63], v[96:99], a[180:183], v[60:63]
    v_mfma_f32_16x16x32_bf16 v[60:63], v[92:95], a[168:171], v[60:63]
    s_waitcnt lgkmcnt(8)
    ds_read_b128 v[92:95], v1 offset:39936
    ds_read_b128 v[96:99], v1 offset:47104
    v_mfma_f32_16x16x32_bf16 v[68:71], v[108:111], a[168:171], v[68:71]
    buffer_load_dwordx4 a[32:35], v209, s[4:7], s54 offen sc1
    v_mfma_f32_16x16x32_bf16 v[68:71], v[112:115], a[180:183], v[68:71]
    ds_read_b128 v[100:103], v1 offset:54272
    ds_read_b128 v[104:107], v1 offset:61440
    v_mfma_f32_16x16x32_bf16 v[68:71], a[216:219], a[192:195], v[68:71]
    v_cvt_pk_bf16_f32 v64, v64, v65
    v_cvt_pk_bf16_f32 v65, v66, v67
    v_mfma_f32_16x16x32_bf16 v[68:71], a[220:223], a[204:207], v[68:71]
    ds_write_b64 v202, v[64:65] offset:4000
    v_cvt_pk_bf16_f32 v60, v60, v61
    v_mfma_f32_16x16x32_bf16 v[72:75], a[220:223], a[208:211], v[72:75]
    v_cvt_pk_bf16_f32 v61, v62, v63
    v_mfma_f32_16x16x32_bf16 v[72:75], a[216:219], a[196:199], v[72:75]
    ds_write_b64 v202, v[60:61] offset:160
    v_mfma_f32_16x16x32_bf16 v[72:75], v[112:115], a[184:187], v[72:75]
    v_mfma_f32_16x16x32_bf16 v[72:75], v[108:111], a[172:175], v[72:75]
    s_waitcnt lgkmcnt(8)
    v_cvt_pk_bf16_f32 v68, v68, v69
    v_cvt_pk_bf16_f32 v69, v70, v71
    v_mfma_f32_16x16x32_bf16 v[24:27], a[224:227], a[172:175], v[24:27]
    ds_write_b64 v202, v[68:69] offset:192
    v_mfma_f32_16x16x32_bf16 v[24:27], a[228:231], a[184:187], v[24:27]
    v_mfma_f32_16x16x32_bf16 v[24:27], v[84:87], a[196:199], v[24:27]
    v_mfma_f32_16x16x32_bf16 v[24:27], v[88:91], a[208:211], v[24:27]
    v_cvt_pk_bf16_f32 v72, v72, v73
    v_cvt_pk_bf16_f32 v73, v74, v75
    v_mfma_f32_16x16x32_bf16 v[20:23], v[88:91], a[204:207], v[20:23]
    ds_write_b64 v202, v[72:73] offset:4032
    v_mfma_f32_16x16x32_bf16 v[20:23], v[84:87], a[192:195], v[20:23]
    v_mfma_f32_16x16x32_bf16 v[20:23], a[228:231], a[180:183], v[20:23]
    v_mfma_f32_16x16x32_bf16 v[20:23], a[224:227], a[168:171], v[20:23]
    v_mfma_f32_16x16x32_bf16 v[76:79], a[224:227], a[176:179], v[76:79]
    v_cvt_pk_bf16_f32 v24, v24, v25
    v_cvt_pk_bf16_f32 v25, v26, v27
    v_mfma_f32_16x16x32_bf16 v[76:79], a[228:231], a[188:191], v[76:79]
    ds_write_b64 v198, v[24:25] offset:3840
    v_mfma_f32_16x16x32_bf16 v[76:79], v[84:87], a[200:203], v[76:79]
    v_mfma_f32_16x16x32_bf16 v[76:79], v[88:91], a[212:215], v[76:79]
    s_waitcnt lgkmcnt(5)
    v_cvt_pk_bf16_f32 v20, v20, v21
    v_cvt_pk_bf16_f32 v21, v22, v23
    v_mfma_f32_16x16x32_bf16 v[52:55], v[92:95], a[168:171], v[52:55]
    ds_write_b64 v198, v[20:21] offset:0
    v_mfma_f32_16x16x32_bf16 v[52:55], v[96:99], a[180:183], v[52:55]
    v_mfma_f32_16x16x32_bf16 v[52:55], v[100:103], a[192:195], v[52:55]
    v_mfma_f32_16x16x32_bf16 v[52:55], v[104:107], a[204:207], v[52:55]
    v_cvt_pk_bf16_f32 v76, v76, v77
    v_cvt_pk_bf16_f32 v77, v78, v79
    v_mfma_f32_16x16x32_bf16 v[56:59], v[104:107], a[208:211], v[56:59]
    ds_write_b64 v203, v[76:77] offset:0
    v_mfma_f32_16x16x32_bf16 v[56:59], v[100:103], a[196:199], v[56:59]
    v_mfma_f32_16x16x32_bf16 v[56:59], v[96:99], a[184:187], v[56:59]
    v_mfma_f32_16x16x32_bf16 v[56:59], v[92:95], a[172:175], v[56:59]
    v_mfma_f32_16x16x32_bf16 v[80:83], v[92:95], a[176:179], v[80:83]
    v_cvt_pk_bf16_f32 v52, v52, v53
    v_cvt_pk_bf16_f32 v53, v54, v55
    v_mfma_f32_16x16x32_bf16 v[80:83], v[96:99], a[188:191], v[80:83]
    v_cndmask_b32 v53, v53, v186, vcc
    v_mfma_f32_16x16x32_bf16 v[80:83], v[100:103], a[200:203], v[80:83]
    ds_write_b64 v202, v[52:53] offset:128
    v_mfma_f32_16x16x32_bf16 v[80:83], v[104:107], a[212:215], v[80:83]
    v_cvt_pk_bf16_f32 v56, v56, v57
    v_cvt_pk_bf16_f32 v57, v58, v59
    v_cndmask_b32 v57, v57, v187, vcc
    s_nop 4
    v_cvt_pk_bf16_f32 v80, v80, v81
    v_cvt_pk_bf16_f32 v81, v82, v83
    v_cndmask_b32 v81, v81, v188, vcc
    ds_write_b64 v202, v[56:57] offset:3968
    ds_write_b64 v204, v[80:81] offset:128
    s_add_u32 s54, s54, 9216
    buffer_load_dwordx4 a[36:39], v208, s[4:7], s54 offen sc1
    buffer_load_dwordx4 a[40:43], v208, s[4:7], s54 offen offset:1024 sc1
    buffer_load_dwordx4 a[44:47], v209, s[4:7], s54 offen sc1
    s_waitcnt lgkmcnt(0)
    s_barrier
    s_bitcmp0_b32 s24, 2
    s_cbranch_scc1 L_inte_role_16
    s_add_u32 m0, s42, 0
    s_add_u32 s31, s63, 0
    buffer_load_dwordx4 v16, s[44:47], s31 offen nt lds
    s_add_u32 m0, s42, 1024
    s_add_u32 s31, s63, 9216
    buffer_load_dwordx4 v16, s[44:47], s31 offen nt lds
    s_add_u32 m0, s42, 2048
    s_add_u32 s31, s63, 18432
    buffer_load_dwordx4 v16, s[44:47], s31 offen nt lds
    s_add_u32 m0, s42, 3072
    s_add_u32 s31, s63, 27648
    buffer_load_dwordx4 v16, s[44:47], s31 offen nt lds
    s_add_u32 m0, s42, 4096
    s_add_u32 s31, s63, 4608
    buffer_load_dwordx4 v16, s[44:47], s31 offen nt lds
    s_add_u32 m0, s42, 5120
    s_add_u32 s31, s63, 13824
    buffer_load_dwordx4 v16, s[44:47], s31 offen nt lds
    s_add_u32 m0, s42, 6144
    s_add_u32 s31, s63, 23040
    buffer_load_dwordx4 v16, s[44:47], s31 offen nt lds
    s_add_u32 m0, s42, 7168
    s_add_u32 s31, s63, 32256
    buffer_load_dwordx4 v16, s[44:47], s31 offen nt lds
    s_add_u32 m0, s42, 8192
    s_nop 0
    buffer_load_dwordx4 v17, s[44:47], s63 offen offset:0 nt lds
L_inte_role_16:
    ds_read_b128 v[20:23], v206 offset:3520
    ds_read_b128 v[24:27], v206 offset:3536
    ds_read_b128 v[28:31], v207 offset:3488
    ds_read_b128 v[60:63], v206 offset:3360
    ds_read_b128 v[64:67], v206 offset:3376
    ds_read_b128 v[32:35], v207 offset:3008
    ds_read_b128 v[68:71], v206 offset:2880
    ds_read_b128 v[72:75], v206 offset:2896
    ds_read_b128 v[36:39], v207 offset:2528
    ds_read_b128 v[76:79], v206 offset:2400
    ds_read_b128 v[80:83], v206 offset:2416
    ds_read_b128 v[40:43], v207 offset:2048
    ds_read_b128 v[84:87], v206 offset:1920
    ds_read_b128 v[88:91], v206 offset:1936
    v_mov_b32 v214, 0
    v_mov_b32 v215, 0
    v_mov_b32 v216, 0
    v_mov_b32 v217, 0
    v_mov_b32 v218, 0
    v_mov_b32 v219, 0
    v_mov_b32 v220, 0
    v_mov_b32 v221, 0
    v_mov_b32 v238, 0
    v_mov_b32 v239, 0
    v_mov_b32 v240, 0
    v_mov_b32 v241, 0
    v_mov_b32 v242, 0
    v_mov_b32 v243, 0
    v_mov_b32 v244, 0
    v_mov_b32 v245, 0
    v_mov_b32 v246, 0
    v_mov_b32 v247, 0
    v_mov_b32 v248, 0
    v_mov_b32 v249, 0
    v_mov_b32 v250, 0
    v_mov_b32 v251, 0
    v_mov_b32 v252, 0
    v_mov_b32 v253, 0
    v_mov_b32 v254, 0
    v_mov_b32 v255, 0
    s_waitcnt lgkmcnt(9)
    ds_read_b128 v[44:47], v207 offset:1568
    ds_read_b128 v[92:95], v206 offset:1440
    ds_read_b128 v[96:99], v206 offset:1456
    v_dot2c_f32_bf16 v214, v20, v60
    v_dot2c_f32_bf16 v214, v21, v61
    v_dot2c_f32_bf16 v214, v22, v62
    v_dot2c_f32_bf16 v214, v23, v63
    v_dot2c_f32_bf16 v214, v24, v64
    v_dot2c_f32_bf16 v214, v25, v65
    v_dot2c_f32_bf16 v214, v26, v66
    v_dot2c_f32_bf16 v214, v27, v67
    v_dot2c_f32_bf16 v214, v30, v28
    s_waitcnt lgkmcnt(9)
    ds_read_b128 v[48:51], v207 offset:1088
    ds_read_b128 v[100:103], v206 offset:960
    ds_read_b128 v[104:107], v206 offset:976
    v_dot2c_f32_bf16 v215, v20, v68
    v_dot2c_f32_bf16 v215, v21, v69
    v_dot2c_f32_bf16 v215, v22, v70
    v_dot2c_f32_bf16 v215, v23, v71
    v_dot2c_f32_bf16 v215, v24, v72
    v_dot2c_f32_bf16 v215, v25, v73
    v_dot2c_f32_bf16 v215, v26, v74
    v_dot2c_f32_bf16 v215, v27, v75
    v_dot2c_f32_bf16 v215, v30, v32
    s_waitcnt lgkmcnt(9)
    ds_read_b128 v[52:55], v207 offset:608
    ds_read_b128 v[108:111], v206 offset:480
    ds_read_b128 v[112:115], v206 offset:496
    v_dot2c_f32_bf16 v216, v20, v76
    v_dot2c_f32_bf16 v216, v21, v77
    v_dot2c_f32_bf16 v216, v22, v78
    v_dot2c_f32_bf16 v216, v23, v79
    v_dot2c_f32_bf16 v216, v24, v80
    v_dot2c_f32_bf16 v216, v25, v81
    v_dot2c_f32_bf16 v216, v26, v82
    v_dot2c_f32_bf16 v216, v27, v83
    v_dot2c_f32_bf16 v216, v30, v36
    s_waitcnt lgkmcnt(9)
    ds_read_b128 v[56:59], v207 offset:128
    ds_read_b128 v[116:119], v206 offset:0
    ds_read_b128 v[120:123], v206 offset:16
    v_dot2c_f32_bf16 v217, v20, v84
    v_dot2c_f32_bf16 v217, v21, v85
    v_dot2c_f32_bf16 v217, v22, v86
    v_dot2c_f32_bf16 v217, v23, v87
    v_dot2c_f32_bf16 v217, v24, v88
    v_dot2c_f32_bf16 v217, v25, v89
    v_dot2c_f32_bf16 v217, v26, v90
    v_dot2c_f32_bf16 v217, v27, v91
    v_dot2c_f32_bf16 v217, v30, v40
    s_waitcnt lgkmcnt(9)
    ds_read_b128 v[124:127], v206 offset:3424
    ds_read_b128 v[128:131], v206 offset:3440
    v_dot2c_f32_bf16 v218, v20, v92
    v_dot2c_f32_bf16 v218, v21, v93
    v_dot2c_f32_bf16 v218, v22, v94
    v_dot2c_f32_bf16 v218, v23, v95
    v_dot2c_f32_bf16 v218, v24, v96
    v_dot2c_f32_bf16 v218, v25, v97
    v_dot2c_f32_bf16 v218, v26, v98
    v_dot2c_f32_bf16 v218, v27, v99
    v_dot2c_f32_bf16 v218, v30, v44
    s_waitcnt lgkmcnt(8)
    ds_read_b128 v[132:135], v206 offset:2944
    ds_read_b128 v[136:139], v206 offset:2960
    v_dot2c_f32_bf16 v219, v20, v100
    v_dot2c_f32_bf16 v219, v21, v101
    v_dot2c_f32_bf16 v219, v22, v102
    v_dot2c_f32_bf16 v219, v23, v103
    v_dot2c_f32_bf16 v219, v24, v104
    v_dot2c_f32_bf16 v219, v25, v105
    v_dot2c_f32_bf16 v219, v26, v106
    v_dot2c_f32_bf16 v219, v27, v107
    v_dot2c_f32_bf16 v219, v30, v48
    s_waitcnt lgkmcnt(7)
    ds_read_b128 v[140:143], v206 offset:2464
    ds_read_b128 v[144:147], v206 offset:2480
    v_dot2c_f32_bf16 v220, v20, v108
    v_dot2c_f32_bf16 v220, v21, v109
    v_dot2c_f32_bf16 v220, v22, v110
    v_dot2c_f32_bf16 v220, v23, v111
    v_dot2c_f32_bf16 v220, v24, v112
    v_dot2c_f32_bf16 v220, v25, v113
    v_dot2c_f32_bf16 v220, v26, v114
    v_dot2c_f32_bf16 v220, v27, v115
    v_dot2c_f32_bf16 v220, v30, v52
    s_waitcnt lgkmcnt(6)
    ds_read_b128 v[148:151], v206 offset:1984
    ds_read_b128 v[152:155], v206 offset:2000
    v_dot2c_f32_bf16 v221, v20, v116
    v_dot2c_f32_bf16 v221, v21, v117
    v_dot2c_f32_bf16 v221, v22, v118
    v_dot2c_f32_bf16 v221, v23, v119
    v_dot2c_f32_bf16 v221, v24, v120
    v_dot2c_f32_bf16 v221, v25, v121
    v_dot2c_f32_bf16 v221, v26, v122
    v_dot2c_f32_bf16 v221, v27, v123
    v_dot2c_f32_bf16 v221, v30, v56
    ds_read_b128 v[156:159], v206 offset:1504
    ds_read_b128 v[160:163], v206 offset:1520
    s_add_u32 s54, s54, 9216
    buffer_load_dwordx4 a[48:51], v208, s[4:7], s54 offen sc1
    v_mul_f32 v197, 0x3eae1a93, v31
    v_mul_f32 v214, v214, v31
    v_mul_f32 v215, v215, v35
    v_mul_f32 v216, v216, v39
    v_mul_f32 v217, v217, v43
    v_mul_f32 v218, v218, v47
    v_mul_f32 v219, v219, v51
    v_mul_f32 v220, v220, v55
    v_mul_f32 v221, v221, v59
    v_mul_f32 v214, v214, v197
    v_fmac_f32 v190, v215, v197
    v_fmac_f32 v191, v216, v197
    v_fmac_f32 v192, v217, v197
    v_fmac_f32 v193, v218, v197
    v_fmac_f32 v194, v219, v197
    v_fmac_f32 v195, v220, v197
    v_fmac_f32 v196, v221, v197
    ds_read_b128 v[164:167], v206 offset:1024
    ds_read_b128 v[168:171], v206 offset:1040
    buffer_load_dwordx4 a[52:55], v208, s[4:7], s54 offen offset:1024 sc1
    v_max3_f32 v210, v214, v190, v191
    v_max3_f32 v211, v192, v193, v194
    v_max3_f32 v210, v210, v195, v196
    v_max_f32 v210, v210, v211
    v_sub_f32 v214, v214, v210
    v_sub_f32 v215, v190, v210
    v_sub_f32 v216, v191, v210
    v_sub_f32 v217, v192, v210
    v_sub_f32 v218, v193, v210
    v_sub_f32 v219, v194, v210
    v_sub_f32 v220, v195, v210
    v_sub_f32 v221, v196, v210
    ds_read_b128 v[172:175], v206 offset:544
    ds_read_b128 v[176:179], v206 offset:560
    buffer_load_dwordx4 a[56:59], v209, s[4:7], s54 offen sc1
    v_exp_f32 v214, v214
    v_exp_f32 v215, v215
    v_exp_f32 v216, v216
    v_exp_f32 v217, v217
    v_exp_f32 v218, v218
    v_exp_f32 v219, v219
    v_exp_f32 v220, v220
    v_exp_f32 v221, v221
    ds_read_b128 v[180:183], v206 offset:64
    ds_read_b128 v[184:187], v206 offset:80
    s_add_u32 s54, s54, 9216
    buffer_load_dwordx4 a[60:63], v208, s[4:7], s54 offen sc1
    v_mul_f32 v230, v214, v31
    v_mul_f32 v231, v215, v35
    v_mul_f32 v232, v216, v39
    v_mul_f32 v233, v217, v43
    v_mul_f32 v234, v218, v47
    v_mul_f32 v235, v219, v51
    v_mul_f32 v236, v220, v55
    v_mul_f32 v237, v221, v59
    v_pk_add_f32 v[214:215], v[214:215], v[216:217]
    v_pk_add_f32 v[218:219], v[218:219], v[220:221]
    v_cvt_pk_bf16_f32 v222, v230, 0
    v_lshlrev_b32 v230, 16, v222
    v_cvt_pk_bf16_f32 v223, v231, 0
    v_lshlrev_b32 v231, 16, v223
    v_cvt_pk_bf16_f32 v224, v232, 0
    v_lshlrev_b32 v232, 16, v224
    v_cvt_pk_bf16_f32 v225, v233, 0
    v_lshlrev_b32 v233, 16, v225
    v_cvt_pk_bf16_f32 v226, v234, 0
    v_lshlrev_b32 v234, 16, v226
    v_cvt_pk_bf16_f32 v227, v235, 0
    v_lshlrev_b32 v235, 16, v227
    v_cvt_pk_bf16_f32 v228, v236, 0
    v_lshlrev_b32 v236, 16, v228
    v_cvt_pk_bf16_f32 v229, v237, 0
    v_lshlrev_b32 v237, 16, v229
    v_pk_add_f32 v[214:215], v[214:215], v[218:219]
    v_add_f32 v214, v214, v215
    v_rcp_f32 v214, v214
    s_waitcnt lgkmcnt(0)
    buffer_load_dwordx4 a[64:67], v208, s[4:7], s54 offen offset:1024 sc1
    buffer_load_dwordx4 a[68:71], v209, s[4:7], s54 offen sc1
    v_dot2c_f32_bf16 v238, v124, v222
    v_dot2c_f32_bf16 v239, v124, v230
    v_dot2c_f32_bf16 v240, v125, v222
    v_dot2c_f32_bf16 v241, v125, v230
    v_dot2c_f32_bf16 v242, v126, v222
    v_dot2c_f32_bf16 v243, v126, v230
    v_dot2c_f32_bf16 v244, v127, v222
    v_dot2c_f32_bf16 v245, v127, v230
    v_dot2c_f32_bf16 v246, v128, v222
    v_dot2c_f32_bf16 v247, v128, v230
    v_dot2c_f32_bf16 v248, v129, v222
    v_dot2c_f32_bf16 v249, v129, v230
    v_dot2c_f32_bf16 v250, v130, v222
    v_dot2c_f32_bf16 v251, v130, v230
    v_dot2c_f32_bf16 v252, v131, v222
    v_dot2c_f32_bf16 v253, v131, v230
    v_dot2c_f32_bf16 v254, v29, v222
    v_dot2c_f32_bf16 v255, v29, v230
    v_dot2c_f32_bf16 v238, v132, v223
    v_dot2c_f32_bf16 v239, v132, v231
    v_dot2c_f32_bf16 v240, v133, v223
    v_dot2c_f32_bf16 v241, v133, v231
    v_dot2c_f32_bf16 v242, v134, v223
    v_dot2c_f32_bf16 v243, v134, v231
    v_dot2c_f32_bf16 v244, v135, v223
    v_dot2c_f32_bf16 v245, v135, v231
    v_dot2c_f32_bf16 v246, v136, v223
    v_dot2c_f32_bf16 v247, v136, v231
    v_dot2c_f32_bf16 v248, v137, v223
    v_dot2c_f32_bf16 v249, v137, v231
    v_dot2c_f32_bf16 v250, v138, v223
    v_dot2c_f32_bf16 v251, v138, v231
    v_dot2c_f32_bf16 v252, v139, v223
    v_dot2c_f32_bf16 v253, v139, v231
    v_dot2c_f32_bf16 v254, v33, v223
    v_dot2c_f32_bf16 v255, v33, v231
    s_add_u32 s54, s54, 9216
    buffer_load_dwordx4 a[72:75], v208, s[4:7], s54 offen sc1
    buffer_load_dwordx4 a[76:79], v208, s[4:7], s54 offen offset:1024 sc1
    v_dot2c_f32_bf16 v238, v140, v224
    v_dot2c_f32_bf16 v239, v140, v232
    v_dot2c_f32_bf16 v240, v141, v224
    v_dot2c_f32_bf16 v241, v141, v232
    v_dot2c_f32_bf16 v242, v142, v224
    v_dot2c_f32_bf16 v243, v142, v232
    v_dot2c_f32_bf16 v244, v143, v224
    v_dot2c_f32_bf16 v245, v143, v232
    v_dot2c_f32_bf16 v246, v144, v224
    v_dot2c_f32_bf16 v247, v144, v232
    v_dot2c_f32_bf16 v248, v145, v224
    v_dot2c_f32_bf16 v249, v145, v232
    v_dot2c_f32_bf16 v250, v146, v224
    v_dot2c_f32_bf16 v251, v146, v232
    v_dot2c_f32_bf16 v252, v147, v224
    v_dot2c_f32_bf16 v253, v147, v232
    v_dot2c_f32_bf16 v254, v37, v224
    v_dot2c_f32_bf16 v255, v37, v232
    v_dot2c_f32_bf16 v238, v148, v225
    v_dot2c_f32_bf16 v239, v148, v233
    v_dot2c_f32_bf16 v240, v149, v225
    v_dot2c_f32_bf16 v241, v149, v233
    v_dot2c_f32_bf16 v242, v150, v225
    v_dot2c_f32_bf16 v243, v150, v233
    v_dot2c_f32_bf16 v244, v151, v225
    v_dot2c_f32_bf16 v245, v151, v233
    v_dot2c_f32_bf16 v246, v152, v225
    v_dot2c_f32_bf16 v247, v152, v233
    v_dot2c_f32_bf16 v248, v153, v225
    v_dot2c_f32_bf16 v249, v153, v233
    v_dot2c_f32_bf16 v250, v154, v225
    v_dot2c_f32_bf16 v251, v154, v233
    v_dot2c_f32_bf16 v252, v155, v225
    v_dot2c_f32_bf16 v253, v155, v233
    v_dot2c_f32_bf16 v254, v41, v225
    v_dot2c_f32_bf16 v255, v41, v233
    buffer_load_dwordx4 a[80:83], v209, s[4:7], s54 offen sc1
    s_add_u32 s54, s54, 9216
    buffer_load_dwordx4 a[84:87], v208, s[4:7], s54 offen sc1
    v_dot2c_f32_bf16 v238, v156, v226
    v_dot2c_f32_bf16 v239, v156, v234
    v_dot2c_f32_bf16 v240, v157, v226
    v_dot2c_f32_bf16 v241, v157, v234
    v_dot2c_f32_bf16 v242, v158, v226
    v_dot2c_f32_bf16 v243, v158, v234
    v_dot2c_f32_bf16 v244, v159, v226
    v_dot2c_f32_bf16 v245, v159, v234
    v_dot2c_f32_bf16 v246, v160, v226
    v_dot2c_f32_bf16 v247, v160, v234
    v_dot2c_f32_bf16 v248, v161, v226
    v_dot2c_f32_bf16 v249, v161, v234
    v_dot2c_f32_bf16 v250, v162, v226
    v_dot2c_f32_bf16 v251, v162, v234
    v_dot2c_f32_bf16 v252, v163, v226
    v_dot2c_f32_bf16 v253, v163, v234
    v_dot2c_f32_bf16 v254, v45, v226
    v_dot2c_f32_bf16 v255, v45, v234
    v_dot2c_f32_bf16 v238, v164, v227
    v_dot2c_f32_bf16 v239, v164, v235
    v_dot2c_f32_bf16 v240, v165, v227
    v_dot2c_f32_bf16 v241, v165, v235
    v_dot2c_f32_bf16 v242, v166, v227
    v_dot2c_f32_bf16 v243, v166, v235
    v_dot2c_f32_bf16 v244, v167, v227
    v_dot2c_f32_bf16 v245, v167, v235
    v_dot2c_f32_bf16 v246, v168, v227
    v_dot2c_f32_bf16 v247, v168, v235
    v_dot2c_f32_bf16 v248, v169, v227
    v_dot2c_f32_bf16 v249, v169, v235
    v_dot2c_f32_bf16 v250, v170, v227
    v_dot2c_f32_bf16 v251, v170, v235
    v_dot2c_f32_bf16 v252, v171, v227
    v_dot2c_f32_bf16 v253, v171, v235
    v_dot2c_f32_bf16 v254, v49, v227
    v_dot2c_f32_bf16 v255, v49, v235
    v_dot2c_f32_bf16 v238, v172, v228
    v_dot2c_f32_bf16 v239, v172, v236
    v_dot2c_f32_bf16 v240, v173, v228
    v_dot2c_f32_bf16 v241, v173, v236
    v_dot2c_f32_bf16 v242, v174, v228
    v_dot2c_f32_bf16 v243, v174, v236
    v_dot2c_f32_bf16 v244, v175, v228
    v_dot2c_f32_bf16 v245, v175, v236
    v_dot2c_f32_bf16 v246, v176, v228
    v_dot2c_f32_bf16 v247, v176, v236
    v_dot2c_f32_bf16 v248, v177, v228
    v_dot2c_f32_bf16 v249, v177, v236
    v_dot2c_f32_bf16 v250, v178, v228
    v_dot2c_f32_bf16 v251, v178, v236
    v_dot2c_f32_bf16 v252, v179, v228
    v_dot2c_f32_bf16 v253, v179, v236
    v_dot2c_f32_bf16 v254, v53, v228
    v_dot2c_f32_bf16 v255, v53, v236
    v_dot2c_f32_bf16 v238, v180, v229
    v_dot2c_f32_bf16 v239, v180, v237
    v_dot2c_f32_bf16 v240, v181, v229
    v_dot2c_f32_bf16 v241, v181, v237
    v_dot2c_f32_bf16 v242, v182, v229
    v_dot2c_f32_bf16 v243, v182, v237
    v_dot2c_f32_bf16 v244, v183, v229
    v_dot2c_f32_bf16 v245, v183, v237
    v_dot2c_f32_bf16 v246, v184, v229
    v_dot2c_f32_bf16 v247, v184, v237
    v_dot2c_f32_bf16 v248, v185, v229
    v_dot2c_f32_bf16 v249, v185, v237
    v_dot2c_f32_bf16 v250, v186, v229
    v_dot2c_f32_bf16 v251, v186, v237
    v_dot2c_f32_bf16 v252, v187, v229
    v_dot2c_f32_bf16 v253, v187, v237
    v_dot2c_f32_bf16 v254, v57, v229
    v_dot2c_f32_bf16 v255, v57, v237
.p2align 3
    v_pk_mul_f32 v[238:239], v[238:239], v[214:215] op_sel_hi:[1,0]
    v_pk_mul_f32 v[240:241], v[240:241], v[214:215] op_sel_hi:[1,0]
    v_pk_mul_f32 v[242:243], v[242:243], v[214:215] op_sel_hi:[1,0]
    v_pk_mul_f32 v[244:245], v[244:245], v[214:215] op_sel_hi:[1,0]
    v_pk_mul_f32 v[246:247], v[246:247], v[214:215] op_sel_hi:[1,0]
    v_pk_mul_f32 v[248:249], v[248:249], v[214:215] op_sel_hi:[1,0]
    v_pk_mul_f32 v[250:251], v[250:251], v[214:215] op_sel_hi:[1,0]
    v_pk_mul_f32 v[252:253], v[252:253], v[214:215] op_sel_hi:[1,0]
    v_pk_mul_f32 v[254:255], v[254:255], v[214:215] op_sel_hi:[1,0]
    v_cvt_pk_bf16_f32 v20, v238, v239
    v_cvt_pk_bf16_f32 v21, v240, v241
    v_cvt_pk_bf16_f32 v22, v242, v243
    v_cvt_pk_bf16_f32 v23, v244, v245
    v_cvt_pk_bf16_f32 v24, v246, v247
    v_cvt_pk_bf16_f32 v25, v248, v249
    v_cvt_pk_bf16_f32 v26, v250, v251
    v_cvt_pk_bf16_f32 v27, v252, v253
    v_cvt_pk_bf16_f32 v28, v254, v255
    buffer_store_dwordx4 v[20:23], v189, s[4:7], s48 offen sc1
    buffer_store_dwordx4 v[24:27], v189, s[4:7], s48 offen offset:512 sc1
    buffer_store_dword v28, v205, s[4:7], s49 offen sc1
    buffer_load_dwordx4 a[88:91], v208, s[4:7], s54 offen offset:1024 sc1
    buffer_load_dwordx4 a[92:95], v209, s[4:7], s54 offen sc1
    s_add_u32 s54, s54, 9216
    buffer_load_dwordx4 a[96:99], v208, s[4:7], s54 offen sc1
    s_waitcnt vmcnt(3)
    s_barrier
    buffer_atomic_add v10, v6, s[4:7], s28 offen offset:0 sc1
    s_lshl_b32 s36, s17, 8
    v_lshlrev_b32 v210, 4, v6
    v_and_b32 v211, 2147483648, v6
    v_or_b32 v210, v210, v211
    buffer_atomic_add v10, v210, s[4:7], s36 offen offset:132 sc1
    buffer_load_dwordx4 a[100:103], v208, s[4:7], s54 offen offset:1024 sc1
    buffer_load_dwordx4 a[104:107], v209, s[4:7], s54 offen sc1
    s_add_u32 s54, s54, 9216
    buffer_load_dwordx4 a[108:111], v208, s[4:7], s54 offen sc1
    buffer_load_dwordx4 a[112:115], v208, s[4:7], s54 offen offset:1024 sc1
    buffer_load_dwordx4 a[116:119], v209, s[4:7], s54 offen sc1
    s_add_u32 s54, s54, 9216
    buffer_load_dwordx4 a[120:123], v208, s[4:7], s54 offen sc1
    buffer_load_dwordx4 a[124:127], v208, s[4:7], s54 offen offset:1024 sc1
    buffer_load_dwordx4 a[128:131], v209, s[4:7], s54 offen sc1
    s_add_u32 s54, s54, 9216
    buffer_load_dwordx4 a[132:135], v208, s[4:7], s54 offen sc1
    buffer_load_dwordx4 a[136:139], v208, s[4:7], s54 offen offset:1024 sc1
    buffer_load_dwordx4 a[140:143], v209, s[4:7], s54 offen sc1
    s_add_u32 s54, s54, 9216
    buffer_load_dwordx4 a[144:147], v208, s[4:7], s54 offen sc1
    buffer_load_dwordx4 a[148:151], v208, s[4:7], s54 offen offset:1024 sc1
    buffer_load_dwordx4 a[152:155], v209, s[4:7], s54 offen sc1
    s_add_u32 s54, s54, 9216
    buffer_load_dwordx4 a[156:159], v208, s[4:7], s54 offen sc1
    buffer_load_dwordx4 a[160:163], v208, s[4:7], s54 offen offset:1024 sc1
    buffer_load_dwordx4 a[164:167], v209, s[4:7], s54 offen sc1
    s_add_u32 s54, s54, 9216
    buffer_load_dwordx4 a[168:171], v208, s[4:7], s54 offen sc1
    buffer_load_dwordx4 a[172:175], v208, s[4:7], s54 offen offset:1024 sc1
    buffer_load_dwordx4 a[176:179], v209, s[4:7], s54 offen sc1
    s_add_u32 s54, s54, 9216
    buffer_load_dwordx4 a[180:183], v208, s[4:7], s54 offen sc1
    buffer_load_dwordx4 a[184:187], v208, s[4:7], s54 offen offset:1024 sc1
    buffer_load_dwordx4 a[188:191], v209, s[4:7], s54 offen sc1
    s_add_u32 s54, s54, 9216
    buffer_load_dwordx4 a[192:195], v208, s[4:7], s54 offen sc1
    buffer_load_dwordx4 a[196:199], v208, s[4:7], s54 offen offset:1024 sc1
    buffer_load_dwordx4 a[200:203], v209, s[4:7], s54 offen sc1
    s_add_u32 s54, s54, 9216
    buffer_load_dwordx4 a[204:207], v208, s[4:7], s54 offen sc1
    buffer_load_dwordx4 a[208:211], v208, s[4:7], s54 offen offset:1024 sc1
    buffer_load_dwordx4 a[212:215], v209, s[4:7], s54 offen sc1
    s_bitcmp0_b32 s24, 2
    s_cbranch_scc1 L_inte_role_17
    v_lshrrev_b32 v120, 4, v0
    v_bfe_u32 v122, v0, 2, 2
    v_lshl_add_u32 v120, v120, 3, v122
    v_and_b32 v122, 3, v0
    v_lshl_add_u32 v121, v120, 2, v122
    v_lshl_add_u32 v121, v121, 3, s42
    v_lshl_add_u32 v120, v120, 4, v122
    v_lshl_add_u32 v120, v120, 4, s42
    s_add_u32 s31, s18, 1
    s_and_b32 s31, s31, 3
    s_lshl_b32 s31, s31, 6
    v_add_u32 v123, s31, v120
    ds_read_b64_tr_b16 v[216:217], v123 offset:0
    ds_read_b64_tr_b16 v[218:219], v123 offset:1024
    ds_read_b64_tr_b16 v[220:221], v123 offset:8
    ds_read_b64_tr_b16 v[222:223], v123 offset:1032
    s_add_u32 s31, s18, 2
    s_and_b32 s31, s31, 3
    s_lshl_b32 s31, s31, 6
    v_add_u32 v123, s31, v120
    ds_read_b64_tr_b16 v[224:225], v123 offset:0
    ds_read_b64_tr_b16 v[226:227], v123 offset:1024
    ds_read_b64_tr_b16 v[228:229], v123 offset:8
    ds_read_b64_tr_b16 v[230:231], v123 offset:1032
    s_add_u32 s31, s18, 3
    s_and_b32 s31, s31, 3
    s_lshl_b32 s31, s31, 6
    v_add_u32 v123, s31, v120
    ds_read_b64_tr_b16 v[232:233], v123 offset:0
    ds_read_b64_tr_b16 v[234:235], v123 offset:1024
    ds_read_b64_tr_b16 v[236:237], v123 offset:8
    ds_read_b64_tr_b16 v[238:239], v123 offset:1032
    ds_read_b64_tr_b16 v[240:241], v121 offset:8192
    ds_read_b64_tr_b16 v[242:243], v121 offset:8320
    s_add_u32 s31, s18, 0
    s_and_b32 s31, s31, 3
    s_lshl_b32 s31, s31, 6
    v_add_u32 v123, s31, v120
    ds_read_b64_tr_b16 v[244:245], v123 offset:0
    ds_read_b64_tr_b16 v[246:247], v123 offset:1024
    ds_read_b64_tr_b16 v[248:249], v123 offset:8
    ds_read_b64_tr_b16 v[250:251], v123 offset:1032
    s_waitcnt lgkmcnt(0)
L_inte_role_17:
    s_load_dwordx2 s[8:9], s[0:1], 56
    s_waitcnt lgkmcnt(0)
    s_branch L_main_p2
L_main_layer:
    s_lshl_b32 s30, s16, 2
    s_max_u32 s30, s30, 1
    s_sub_u32 s30, s30, 1
    s_cmp_eq_u32 s16, 0
    s_cselect_b32 s31, 2147483648, 0
    s_mul_i32 s52, s23, 36864
    s_add_u32 s52, s52, 49414144
    s_mul_i32 s53, s30, 36864
    s_add_u32 s53, s53, 49414144
    v_or_b32 v178, s31, v5
    v_add_u32 v178, 256, v178
    s_lshl_b32 s38, s20, 10
    s_lshl_b32 s39, s20, 11
    s_add_u32 s39, s39, s53
    s_xor_b32 s32, s20, 0
    s_lshl_b32 s32, s32, 10
    v_add_u32 v173, s32, v1
    v_add_u32 v168, 73728, v173
    s_xor_b32 s32, s20, 1
    s_lshl_b32 s32, s32, 10
    v_add_u32 v174, s32, v1
    v_add_u32 v169, 73728, v174
    s_xor_b32 s32, s20, 2
    s_lshl_b32 s32, s32, 10
    v_add_u32 v175, s32, v1
    v_add_u32 v170, 73728, v175
    s_xor_b32 s32, s20, 3
    s_lshl_b32 s32, s32, 10
    v_add_u32 v176, s32, v1
    v_add_u32 v171, 73728, v176
    v_add_u32 v172, 73728, v1
    s_lshl_b32 s32, s23, 12
    s_add_u32 s32, s32, s21
    s_add_u32 s32, s32, 18219008
    s_lshl_b32 s33, s30, 12
    s_add_u32 s33, s33, s21
    s_add_u32 s33, s33, 18219008
    v_and_b32 v210, 15, v0
    v_lshlrev_b32 v179, 2, v210
    v_bfe_u32 v211, v0, 4, 1
    v_lshl_add_u32 v179, v211, 11, v179
    v_lshrrev_b32 v211, 5, v0
    v_lshl_add_u32 v179, v211, 7, v179
    v_add_u32 v179, 64, v179
    v_or_b32 v179, s31, v179
    v_mul_u32_u24 v210, 240, v210
    v_lshrrev_b32 v212, 4, v0
    v_lshl_add_u32 v210, v212, 3, v210
    v_add_u32 v204, 73728, v210
    s_lshl_b32 s34, s20, 5
    v_add_u32 v203, s34, v204
    s_mul_i32 s34, s20, 7680
    s_add_u32 s34, s34, 3840
    v_add_u32 v202, s34, v204
    v_lshlrev_b32 v212, 4, v212
    v_add_u32 v212, 156672, v212
    v_and_b32 v210, 31, v0
    v_mul_u32_u24 v207, 240, v210
    s_sub_u32 s34, s34, -70368
    v_add_u32 v207, s34, v207
    v_lshl_add_u32 v206, v211, 5, v207
    v_lshl_add_u32 v207, v211, 4, v207
    v_lshlrev_b32 v205, 3, v210
    v_lshl_add_u32 v205, v211, 2, v205
    v_lshlrev_b32 v189, 4, v210
    v_lshl_add_u32 v189, v211, 10, v189
    s_mul_i32 s48, s23, 36864
    s_add_u32 s48, s48, s21
    s_add_u32 s48, s48, 18481152
    s_lshl_b32 s49, s17, 8
    s_add_u32 s49, s49, s48
    s_add_u32 s49, s49, 32768
    s_lshl_b32 s34, s17, 11
    s_add_u32 s48, s48, s34
    s_mov_b32 vcc_lo, 0xffff0000
    s_mov_b32 vcc_hi, 0xffff0000
    s_lshl_b32 s34, s23, 5
    v_add_u32 v210, s34, v210
    s_lshl_b32 s34, s20, 11
    v_add_u32 v208, s34, v1
    s_cmp_lt_u32 s20, 2
    s_cselect_b32 s34, 0, 2147483648
    v_or_b32 v209, s34, v13
    s_mul_i32 s54, s19, 165888
    s_add_u32 s54, s54, 2579456
    s_waitcnt vmcnt(0)
    s_barrier
    buffer_atomic_add v10, v7, s[4:7], s28 offen offset:8 sc1
    s_mul_i32 s43, s20, 7168
    s_add_u32 m0, s43, 36864
    s_add_u32 s55, s43, 625664
    s_add_u32 s55, s55, s40
    buffer_load_dwordx4 v1, s[4:7], s55 offen offset:0 sc1 lds
    buffer_load_dwordx4 v1, s[4:7], s55 offen offset:1024 sc1 lds
    buffer_load_dwordx4 v1, s[4:7], s55 offen offset:2048 sc1 lds
    buffer_load_dwordx4 v1, s[4:7], s55 offen offset:3072 sc1 lds
    s_add_u32 m0, s43, 40960
    s_add_u32 s55, s43, 629760
    s_add_u32 s55, s55, s40
    buffer_load_dwordx4 v1, s[4:7], s55 offen offset:0 sc1 lds
    buffer_load_dwordx4 v1, s[4:7], s55 offen offset:1024 sc1 lds
    buffer_load_dwordx4 v1, s[4:7], s55 offen offset:2048 sc1 lds
    v_subrev_u32 v190, 2, v210
    v_ashrrev_i32 v190, 31, v190
    v_and_b32 v190, 0xf149f2ca, v190
    v_subrev_u32 v191, 4, v210
    v_ashrrev_i32 v191, 31, v191
    v_and_b32 v191, 0xf149f2ca, v191
    v_subrev_u32 v192, 6, v210
    v_ashrrev_i32 v192, 31, v192
    v_and_b32 v192, 0xf149f2ca, v192
    v_subrev_u32 v193, 8, v210
    v_ashrrev_i32 v193, 31, v193
    v_and_b32 v193, 0xf149f2ca, v193
    v_subrev_u32 v194, 10, v210
    v_ashrrev_i32 v194, 31, v194
    v_and_b32 v194, 0xf149f2ca, v194
    v_subrev_u32 v195, 12, v210
    v_ashrrev_i32 v195, 31, v195
    v_and_b32 v195, 0xf149f2ca, v195
    v_subrev_u32 v196, 14, v210
    v_ashrrev_i32 v196, 31, v196
    v_and_b32 v196, 0xf149f2ca, v196
    s_xor_b32 s35, s20, 0
    s_lshl_b32 s35, s35, 5
    v_add_u32 v198, s35, v202
    s_xor_b32 s35, s20, 1
    s_lshl_b32 s35, s35, 5
    v_add_u32 v199, s35, v202
    s_xor_b32 s35, s20, 2
    s_lshl_b32 s35, s35, 5
    v_add_u32 v200, s35, v202
    s_xor_b32 s35, s20, 3
    s_lshl_b32 s35, s35, 5
    v_add_u32 v201, s35, v202
    s_xor_b32 s35, s20, 0
    s_lshl_b32 s35, s35, 6
    v_add_u32 v213, s35, v212
    ds_read_b128 v[116:119], v213
    s_xor_b32 s35, s20, 1
    s_lshl_b32 s35, s35, 6
    v_add_u32 v213, s35, v212
    ds_read_b128 v[120:123], v213
    s_xor_b32 s35, s20, 2
    s_lshl_b32 s35, s35, 6
    v_add_u32 v213, s35, v212
    ds_read_b128 v[124:127], v213
    s_xor_b32 s35, s20, 3
    s_lshl_b32 s35, s35, 6
    v_add_u32 v213, s35, v212
    ds_read_b128 v[128:131], v213
    ds_read_b128 v[132:135], v212 offset:256
    ds_read_b128 v[136:139], v212 offset:320
    ds_read_b128 v[140:143], v212 offset:384
    ds_read_b128 v[84:87], v169 offset:0
    ds_read_b128 v[88:91], v170 offset:0
    ds_read_b128 v[92:95], v171 offset:0
    ds_read_b128 v[96:99], v172 offset:5120
    ds_read_b128 v[100:103], v172 offset:6144
    ds_read_b128 v[104:107], v168 offset:0
    ds_read_b128 v[108:111], v172 offset:4096
    ds_read_b128 v[112:115], v169 offset:7168
    s_cmp_lg_u32 s20, 0
    s_cbranch_scc1 L_inte_np_18
L_inte_poll_19:
    s_load_dword s57, s[12:13], 8 glc
    s_load_dword s3, s[12:13], 128 glc
    s_waitcnt lgkmcnt(0)
    s_cmp_ge_u32 s3, s56
    s_cselect_b32 s57, s57, 0
    s_cmp_ge_u32 s57, 16
    s_cbranch_scc1 L_inte_poll_19_x
    s_sub_u32 s27, s27, 1
    s_cmp_gt_i32 s27, 0
    s_cbranch_scc1 L_inte_poll_19
L_inte_poll_19_x:
L_inte_np_18:
    s_barrier
    buffer_load_dwordx4 a[0:3], v5, s[4:7], s52 offen offset:0 sc1
    buffer_load_dwordx4 a[4:7], v5, s[4:7], s52 offen offset:256 sc1
    buffer_load_dwordx4 a[8:11], v178, s[4:7], s53 offen offset:0 sc1
    buffer_load_dwordx4 a[12:15], v5, s[4:7], s52 offen offset:2048 sc1
    buffer_load_dwordx4 a[16:19], v5, s[4:7], s52 offen offset:2304 sc1
    buffer_load_dwordx4 a[20:23], v178, s[4:7], s53 offen offset:2048 sc1
    s_add_u32 m0, s38, 65536
    s_add_u32 s55, s39, 4096
    buffer_load_dwordx4 v178, s[4:7], s55 offen sc1 lds
    s_add_u32 s52, s52, 4096
    buffer_load_dwordx4 a[24:27], v5, s[4:7], s52 offen offset:0 sc1
    buffer_load_dwordx4 a[28:31], v5, s[4:7], s52 offen offset:256 sc1
    s_add_u32 m0, s38, 69632
    s_add_u32 s55, s39, 12288
    buffer_load_dwordx4 v178, s[4:7], s55 offen sc1 lds
    buffer_load_dwordx4 a[36:39], v5, s[4:7], s52 offen offset:2048 sc1
    buffer_load_dwordx4 a[40:43], v5, s[4:7], s52 offen offset:2304 sc1
    s_waitcnt lgkmcnt(5)
    s_waitcnt vmcnt(10)
    v_mfma_f32_16x16x32_bf16 v[28:31], v[84:87], a[0:3], 0
    s_add_u32 s52, s52, 4096
    ds_read_b128 a[216:219], v170 offset:7168
    ds_read_b128 a[220:223], v171 offset:7168
    v_mfma_f32_16x16x32_bf16 v[32:35], v[84:87], a[4:7], 0
    buffer_load_dwordx4 a[48:51], v5, s[4:7], s52 offen offset:0 sc1
    v_mfma_f32_16x16x32_bf16 v[40:43], v[88:91], a[4:7], 0
    ds_read_b128 a[224:227], v172 offset:12288
    ds_read_b128 a[228:231], v172 offset:13312
    v_mfma_f32_16x16x32_bf16 v[36:39], v[88:91], a[0:3], 0
    buffer_load_dwordx4 a[52:55], v5, s[4:7], s52 offen offset:256 sc1
    v_mfma_f32_16x16x32_bf16 v[44:47], v[92:95], a[0:3], 0
    ds_read_b128 v[84:87], v168 offset:7168
    ds_read_b128 v[88:91], v172 offset:11264
    v_mfma_f32_16x16x32_bf16 v[48:51], v[92:95], a[4:7], 0
    s_waitcnt lgkmcnt(8)
    v_mfma_f32_16x16x32_bf16 v[64:67], v[96:99], a[4:7], 0
    ds_read_b128 v[92:95], v169 offset:14336
    v_mfma_f32_16x16x32_bf16 v[60:63], v[96:99], a[0:3], 0
    v_mfma_f32_16x16x32_bf16 v[68:71], v[100:103], a[0:3], 0
    ds_read_b128 v[96:99], v170 offset:14336
    v_mfma_f32_16x16x32_bf16 v[72:75], v[100:103], a[4:7], 0
    s_waitcnt vmcnt(11)
    buffer_load_dwordx4 a[60:63], v5, s[4:7], s52 offen offset:2048 sc1
    v_mfma_f32_16x16x32_bf16 v[24:27], v[104:107], a[4:7], 0
    ds_read_b128 v[100:103], v171 offset:14336
    v_mfma_f32_16x16x32_bf16 v[20:23], v[104:107], a[0:3], 0
    v_mfma_f32_16x16x32_bf16 v[76:79], v[104:107], a[8:11], 0
    s_waitcnt lgkmcnt(8)
    ds_read_b128 v[104:107], v172 offset:19456
    v_mfma_f32_16x16x32_bf16 v[52:55], v[108:111], a[0:3], 0
    buffer_load_dwordx4 a[64:67], v5, s[4:7], s52 offen offset:2304 sc1
    v_mfma_f32_16x16x32_bf16 v[56:59], v[108:111], a[4:7], 0
    s_add_u32 m0, s38, 139264
    s_add_u32 s55, s39, 20480
    v_mfma_f32_16x16x32_bf16 v[80:83], v[108:111], a[8:11], 0
    s_waitcnt vmcnt(11)
    ds_read_b128 v[108:111], v172 offset:20480
    v_mfma_f32_16x16x32_bf16 v[32:35], v[112:115], a[16:19], v[32:35]
    v_mfma_f32_16x16x32_bf16 v[28:31], v[112:115], a[12:15], v[28:31]
    ds_read_b128 v[112:115], v168 offset:14336
    v_mfma_f32_16x16x32_bf16 v[36:39], a[216:219], a[12:15], v[36:39]
    buffer_load_dwordx4 v178, s[4:7], s55 offen sc1 lds
    v_mfma_f32_16x16x32_bf16 v[40:43], a[216:219], a[16:19], v[40:43]
    s_waitcnt lgkmcnt(8)
    ds_read_b128 a[216:219], v172 offset:18432
    s_add_u32 s52, s52, 4096
    v_mfma_f32_16x16x32_bf16 v[48:51], a[220:223], a[16:19], v[48:51]
    v_mfma_f32_16x16x32_bf16 v[44:47], a[220:223], a[12:15], v[44:47]
    v_mfma_f32_16x16x32_bf16 v[60:63], a[224:227], a[12:15], v[60:63]
    ds_read_b128 a[220:223], v169 offset:21504
    v_mfma_f32_16x16x32_bf16 v[64:67], a[224:227], a[16:19], v[64:67]
    buffer_load_dwordx4 a[72:75], v5, s[4:7], s52 offen offset:0 sc1
    v_mfma_f32_16x16x32_bf16 v[72:75], a[228:231], a[16:19], v[72:75]
    ds_read_b128 a[224:227], v170 offset:21504
    v_mfma_f32_16x16x32_bf16 v[68:71], a[228:231], a[12:15], v[68:71]
    s_waitcnt vmcnt(12)
    s_waitcnt lgkmcnt(8)
    v_mfma_f32_16x16x32_bf16 v[20:23], v[84:87], a[12:15], v[20:23]
    ds_read_b128 a[228:231], v171 offset:21504
    v_mfma_f32_16x16x32_bf16 v[24:27], v[84:87], a[16:19], v[24:27]
    v_mfma_f32_16x16x32_bf16 v[76:79], v[84:87], a[20:23], v[76:79]
    ds_read_b128 v[84:87], v172 offset:26624
    v_mfma_f32_16x16x32_bf16 v[56:59], v[88:91], a[16:19], v[56:59]
    buffer_load_dwordx4 a[76:79], v5, s[4:7], s52 offen offset:256 sc1
    v_mfma_f32_16x16x32_bf16 v[52:55], v[88:91], a[12:15], v[52:55]
    s_add_u32 m0, s38, 143360
    s_add_u32 s55, s39, 28672
    v_mfma_f32_16x16x32_bf16 v[80:83], v[88:91], a[20:23], v[80:83]
    s_waitcnt vmcnt(10)
    s_waitcnt vmcnt(9)
    s_barrier
    ds_read_b128 v[88:91], v172 offset:27648
    v_mfma_f32_16x16x32_bf16 v[28:31], v[92:95], a[24:27], v[28:31]
    buffer_load_dwordx4 v178, s[4:7], s55 offen sc1 lds
    v_mfma_f32_16x16x32_bf16 v[32:35], v[92:95], a[28:31], v[32:35]
    s_waitcnt lgkmcnt(8)
    ds_read_b128 v[92:95], v168 offset:21504
    ds_read_b128 a[32:35], v2 offset:0
    v_mfma_f32_16x16x32_bf16 v[40:43], v[96:99], a[28:31], v[40:43]
    buffer_load_dwordx4 a[84:87], v5, s[4:7], s52 offen offset:2048 sc1
    v_mfma_f32_16x16x32_bf16 v[36:39], v[96:99], a[24:27], v[36:39]
    ds_read_b128 v[96:99], v172 offset:25600
    v_mfma_f32_16x16x32_bf16 v[44:47], v[100:103], a[24:27], v[44:47]
    buffer_load_dwordx4 a[88:91], v5, s[4:7], s52 offen offset:2304 sc1
    v_mfma_f32_16x16x32_bf16 v[48:51], v[100:103], a[28:31], v[48:51]
    s_add_u32 s52, s52, 4096
    v_mfma_f32_16x16x32_bf16 v[64:67], v[104:107], a[28:31], v[64:67]
    ds_read_b128 v[100:103], v169 offset:28672
    v_mfma_f32_16x16x32_bf16 v[60:63], v[104:107], a[24:27], v[60:63]
    s_waitcnt lgkmcnt(9)
    buffer_load_dwordx4 a[96:99], v5, s[4:7], s52 offen offset:0 sc1
    v_mfma_f32_16x16x32_bf16 v[68:71], v[108:111], a[24:27], v[68:71]
    ds_read_b128 v[104:107], v170 offset:28672
    v_mfma_f32_16x16x32_bf16 v[72:75], v[108:111], a[28:31], v[72:75]
    buffer_load_dwordx4 a[100:103], v5, s[4:7], s52 offen offset:256 sc1
    v_mfma_f32_16x16x32_bf16 v[24:27], v[112:115], a[28:31], v[24:27]
    s_waitcnt lgkmcnt(3)
    ds_read_b128 v[108:111], v171 offset:28672
    v_mfma_f32_16x16x32_bf16 v[20:23], v[112:115], a[24:27], v[20:23]
    buffer_load_dword v144, v4, s[4:7], s32 offen offset:0 sc1
    v_mfma_f32_16x16x32_bf16 v[76:79], v[112:115], a[32:35], v[76:79]
    ds_read_b128 v[112:115], v172 offset:33792
    v_mfma_f32_16x16x32_bf16 v[52:55], a[216:219], a[24:27], v[52:55]
    buffer_load_dword v145, v4, s[4:7], s32 offen offset:256 sc1
    v_mfma_f32_16x16x32_bf16 v[56:59], a[216:219], a[28:31], v[56:59]
    buffer_load_dword v146, v4, s[4:7], s32 offen offset:512 sc1
    v_mfma_f32_16x16x32_bf16 v[80:83], a[216:219], a[32:35], v[80:83]
    s_waitcnt vmcnt(15)
    ds_read_b128 a[216:219], v172 offset:34816
    v_mfma_f32_16x16x32_bf16 v[32:35], a[220:223], a[40:43], v[32:35]
    buffer_load_dword v147, v4, s[4:7], s32 offen offset:768 sc1
    v_mfma_f32_16x16x32_bf16 v[28:31], a[220:223], a[36:39], v[28:31]
    ds_read_b128 a[220:223], v168 offset:28672
    ds_read_b128 a[44:47], v2 offset:1024
    v_mfma_f32_16x16x32_bf16 v[36:39], a[224:227], a[36:39], v[36:39]
    buffer_load_dword v148, v4, s[4:7], s32 offen offset:1024 sc1
    v_mfma_f32_16x16x32_bf16 v[40:43], a[224:227], a[40:43], v[40:43]
    ds_read_b128 a[224:227], v172 offset:32768
    v_mfma_f32_16x16x32_bf16 v[48:51], a[228:231], a[40:43], v[48:51]
    buffer_load_dword v149, v4, s[4:7], s32 offen offset:1280 sc1
    v_mfma_f32_16x16x32_bf16 v[44:47], a[228:231], a[36:39], v[44:47]
    buffer_load_dword v150, v4, s[4:7], s32 offen offset:1536 sc1
    v_mfma_f32_16x16x32_bf16 v[60:63], v[84:87], a[36:39], v[60:63]
    ds_read_b128 a[228:231], v169 offset:35840
    v_mfma_f32_16x16x32_bf16 v[64:67], v[84:87], a[40:43], v[64:67]
    buffer_load_dword v151, v4, s[4:7], s32 offen offset:1792 sc1
    v_mfma_f32_16x16x32_bf16 v[72:75], v[88:91], a[40:43], v[72:75]
    ds_read_b128 v[84:87], v170 offset:35840
    v_mfma_f32_16x16x32_bf16 v[68:71], v[88:91], a[36:39], v[68:71]
    buffer_load_dword v152, v4, s[4:7], s32 offen offset:2048 sc1
    v_mfma_f32_16x16x32_bf16 v[20:23], v[92:95], a[36:39], v[20:23]
    s_waitcnt lgkmcnt(3)
    ds_read_b128 v[88:91], v171 offset:35840
    v_mfma_f32_16x16x32_bf16 v[24:27], v[92:95], a[40:43], v[24:27]
    buffer_load_dword v153, v4, s[4:7], s32 offen offset:2304 sc1
    v_mfma_f32_16x16x32_bf16 v[76:79], v[92:95], a[44:47], v[76:79]
    ds_read_b128 v[92:95], v172 offset:40960
    v_mfma_f32_16x16x32_bf16 v[56:59], v[96:99], a[40:43], v[56:59]
    buffer_load_dword v154, v4, s[4:7], s32 offen offset:2560 sc1
    v_mfma_f32_16x16x32_bf16 v[52:55], v[96:99], a[36:39], v[52:55]
    buffer_load_dword v155, v4, s[4:7], s32 offen offset:2816 sc1
    v_mfma_f32_16x16x32_bf16 v[80:83], v[96:99], a[44:47], v[80:83]
    s_waitcnt vmcnt(22)
    ds_read_b128 v[96:99], v172 offset:41984
    v_mfma_f32_16x16x32_bf16 v[28:31], v[100:103], a[48:51], v[28:31]
    buffer_load_dword v156, v4, s[4:7], s32 offen offset:3072 sc1
    v_mfma_f32_16x16x32_bf16 v[32:35], v[100:103], a[52:55], v[32:35]
    ds_read_b128 v[100:103], v168 offset:35840
    ds_read_b128 a[56:59], v2 offset:2048
    v_mfma_f32_16x16x32_bf16 v[40:43], v[104:107], a[52:55], v[40:43]
    buffer_load_dword v157, v4, s[4:7], s32 offen offset:3328 sc1
    v_mfma_f32_16x16x32_bf16 v[36:39], v[104:107], a[48:51], v[36:39]
    ds_read_b128 v[104:107], v172 offset:39936
    v_mfma_f32_16x16x32_bf16 v[44:47], v[108:111], a[48:51], v[44:47]
    buffer_load_dword v158, v4, s[4:7], s32 offen offset:3584 sc1
    v_mfma_f32_16x16x32_bf16 v[48:51], v[108:111], a[52:55], v[48:51]
    buffer_load_dword v159, v4, s[4:7], s32 offen offset:3840 sc1
    v_mfma_f32_16x16x32_bf16 v[64:67], v[112:115], a[52:55], v[64:67]
    ds_read_b128 v[108:111], v169 offset:43008
    v_mfma_f32_16x16x32_bf16 v[60:63], v[112:115], a[48:51], v[60:63]
    buffer_load_dword v160, v179, s[4:7], s33 offen offset:0 sc1
    v_mfma_f32_16x16x32_bf16 v[68:71], a[216:219], a[48:51], v[68:71]
    ds_read_b128 v[112:115], v170 offset:43008
    v_mfma_f32_16x16x32_bf16 v[72:75], a[216:219], a[52:55], v[72:75]
    s_waitcnt lgkmcnt(9)
    buffer_load_dword v161, v179, s[4:7], s33 offen offset:256 sc1
    v_mfma_f32_16x16x32_bf16 v[24:27], a[220:223], a[52:55], v[24:27]
    s_waitcnt lgkmcnt(3)
    ds_read_b128 a[216:219], v171 offset:43008
    v_mfma_f32_16x16x32_bf16 v[20:23], a[220:223], a[48:51], v[20:23]
    buffer_load_dword v162, v179, s[4:7], s33 offen offset:512 sc1
    v_mfma_f32_16x16x32_bf16 v[76:79], a[220:223], a[56:59], v[76:79]
    ds_read_b128 a[220:223], v172 offset:48128
    v_mfma_f32_16x16x32_bf16 v[52:55], a[224:227], a[48:51], v[52:55]
    buffer_load_dword v163, v179, s[4:7], s33 offen offset:768 sc1
    v_mfma_f32_16x16x32_bf16 v[56:59], a[224:227], a[52:55], v[56:59]
    buffer_load_dword v164, v179, s[4:7], s33 offen offset:1024 sc1
    v_mfma_f32_16x16x32_bf16 v[80:83], a[224:227], a[56:59], v[80:83]
    s_waitcnt vmcnt(29)
    ds_read_b128 a[224:227], v172 offset:49152
    v_mfma_f32_16x16x32_bf16 v[32:35], a[228:231], a[64:67], v[32:35]
    buffer_load_dword v165, v179, s[4:7], s33 offen offset:1280 sc1
    v_mfma_f32_16x16x32_bf16 v[28:31], a[228:231], a[60:63], v[28:31]
    ds_read_b128 a[228:231], v168 offset:43008
    ds_read_b128 a[68:71], v2 offset:3072
    v_mfma_f32_16x16x32_bf16 v[36:39], v[84:87], a[60:63], v[36:39]
    buffer_load_dword v166, v179, s[4:7], s33 offen offset:1536 sc1
    v_mfma_f32_16x16x32_bf16 v[40:43], v[84:87], a[64:67], v[40:43]
    ds_read_b128 v[84:87], v172 offset:47104
    v_mfma_f32_16x16x32_bf16 v[48:51], v[88:91], a[64:67], v[48:51]
    buffer_load_dword v167, v179, s[4:7], s33 offen offset:1792 sc1
    v_mfma_f32_16x16x32_bf16 v[44:47], v[88:91], a[60:63], v[44:47]
    buffer_load_dwordx4 a[108:111], v5, s[4:7], s52 offen offset:2048 sc1
    v_mfma_f32_16x16x32_bf16 v[60:63], v[92:95], a[60:63], v[60:63]
    ds_read_b128 v[88:91], v169 offset:50176
    v_mfma_f32_16x16x32_bf16 v[64:67], v[92:95], a[64:67], v[64:67]
    s_waitcnt lgkmcnt(9)
    v_mfma_f32_16x16x32_bf16 v[72:75], v[96:99], a[64:67], v[72:75]
    ds_read_b128 v[92:95], v170 offset:50176
    v_mfma_f32_16x16x32_bf16 v[68:71], v[96:99], a[60:63], v[68:71]
    buffer_load_dwordx4 a[112:115], v5, s[4:7], s52 offen offset:2304 sc1
    v_mfma_f32_16x16x32_bf16 v[20:23], v[100:103], a[60:63], v[20:23]
    s_waitcnt lgkmcnt(3)
    ds_read_b128 v[96:99], v171 offset:50176
    s_add_u32 s52, s52, 4096
    v_mfma_f32_16x16x32_bf16 v[24:27], v[100:103], a[64:67], v[24:27]
    v_mfma_f32_16x16x32_bf16 v[76:79], v[100:103], a[68:71], v[76:79]
    ds_read_b128 v[100:103], v172 offset:55296
    v_mfma_f32_16x16x32_bf16 v[56:59], v[104:107], a[64:67], v[56:59]
    v_mfma_f32_16x16x32_bf16 v[52:55], v[104:107], a[60:63], v[52:55]
    buffer_load_dwordx4 a[120:123], v5, s[4:7], s52 offen offset:0 sc1
    v_mfma_f32_16x16x32_bf16 v[80:83], v[104:107], a[68:71], v[80:83]
    s_waitcnt vmcnt(32)
    ds_read_b128 v[104:107], v172 offset:56320
    v_mfma_f32_16x16x32_bf16 v[28:31], v[108:111], a[72:75], v[28:31]
    v_mfma_f32_16x16x32_bf16 v[32:35], v[108:111], a[76:79], v[32:35]
    ds_read_b128 v[108:111], v168 offset:50176
    ds_read_b128 a[80:83], v2 offset:4096
    v_mfma_f32_16x16x32_bf16 v[40:43], v[112:115], a[76:79], v[40:43]
    v_mfma_f32_16x16x32_bf16 v[36:39], v[112:115], a[72:75], v[36:39]
    ds_read_b128 v[112:115], v172 offset:54272
    v_mfma_f32_16x16x32_bf16 v[44:47], a[216:219], a[72:75], v[44:47]
    buffer_load_dwordx4 a[124:127], v5, s[4:7], s52 offen offset:256 sc1
    v_mfma_f32_16x16x32_bf16 v[48:51], a[216:219], a[76:79], v[48:51]
    v_mfma_f32_16x16x32_bf16 v[64:67], a[220:223], a[76:79], v[64:67]
    ds_read_b128 a[216:219], v169 offset:57344
    v_mfma_f32_16x16x32_bf16 v[60:63], a[220:223], a[72:75], v[60:63]
    v_mfma_f32_16x16x32_bf16 v[68:71], a[224:227], a[72:75], v[68:71]
    ds_read_b128 a[220:223], v170 offset:57344
    v_mfma_f32_16x16x32_bf16 v[72:75], a[224:227], a[76:79], v[72:75]
    v_mfma_f32_16x16x32_bf16 v[24:27], a[228:231], a[76:79], v[24:27]
    s_waitcnt lgkmcnt(3)
    ds_read_b128 a[224:227], v171 offset:57344
    v_mfma_f32_16x16x32_bf16 v[20:23], a[228:231], a[72:75], v[20:23]
    buffer_load_dwordx4 a[132:135], v5, s[4:7], s52 offen offset:2048 sc1
    v_mfma_f32_16x16x32_bf16 v[76:79], a[228:231], a[80:83], v[76:79]
    ds_read_b128 a[228:231], v172 offset:62464
    v_mfma_f32_16x16x32_bf16 v[52:55], v[84:87], a[72:75], v[52:55]
    v_mfma_f32_16x16x32_bf16 v[56:59], v[84:87], a[76:79], v[56:59]
    v_mfma_f32_16x16x32_bf16 v[80:83], v[84:87], a[80:83], v[80:83]
    s_waitcnt vmcnt(31)
    ds_read_b128 v[84:87], v172 offset:63488
    v_mfma_f32_16x16x32_bf16 v[32:35], v[88:91], a[88:91], v[32:35]
    buffer_load_dwordx4 a[136:139], v5, s[4:7], s52 offen offset:2304 sc1
    v_mfma_f32_16x16x32_bf16 v[28:31], v[88:91], a[84:87], v[28:31]
    s_add_u32 s52, s52, 4096
    ds_read_b128 v[88:91], v168 offset:57344
    ds_read_b128 a[92:95], v2 offset:5120
    v_mfma_f32_16x16x32_bf16 v[36:39], v[92:95], a[84:87], v[36:39]
    v_mfma_f32_16x16x32_bf16 v[40:43], v[92:95], a[88:91], v[40:43]
    ds_read_b128 v[92:95], v172 offset:61440
    v_mfma_f32_16x16x32_bf16 v[48:51], v[96:99], a[88:91], v[48:51]
    v_mfma_f32_16x16x32_bf16 v[44:47], v[96:99], a[84:87], v[44:47]
    buffer_load_dwordx4 a[144:147], v5, s[4:7], s52 offen offset:0 sc1
    v_mfma_f32_16x16x32_bf16 v[60:63], v[100:103], a[84:87], v[60:63]
    ds_read_b128 v[96:99], v174 offset:0
    v_mfma_f32_16x16x32_bf16 v[64:67], v[100:103], a[88:91], v[64:67]
    v_mfma_f32_16x16x32_bf16 v[72:75], v[104:107], a[88:91], v[72:75]
    ds_read_b128 v[100:103], v175 offset:0
    v_mfma_f32_16x16x32_bf16 v[68:71], v[104:107], a[84:87], v[68:71]
    s_waitcnt lgkmcnt(9)
    v_mfma_f32_16x16x32_bf16 v[20:23], v[108:111], a[84:87], v[20:23]
    s_waitcnt lgkmcnt(3)
    ds_read_b128 v[104:107], v176 offset:0
    v_mfma_f32_16x16x32_bf16 v[24:27], v[108:111], a[88:91], v[24:27]
    buffer_load_dwordx4 a[148:151], v5, s[4:7], s52 offen offset:256 sc1
    v_mfma_f32_16x16x32_bf16 v[76:79], v[108:111], a[92:95], v[76:79]
    ds_read_b128 v[108:111], v1 offset:5120
    v_mfma_f32_16x16x32_bf16 v[56:59], v[112:115], a[88:91], v[56:59]
    v_mfma_f32_16x16x32_bf16 v[52:55], v[112:115], a[84:87], v[52:55]
    v_mfma_f32_16x16x32_bf16 v[80:83], v[112:115], a[92:95], v[80:83]
    s_waitcnt vmcnt(32)
    ds_read_b128 v[112:115], v1 offset:6144
    v_mfma_f32_16x16x32_bf16 v[28:31], a[216:219], a[96:99], v[28:31]
    buffer_load_dwordx4 a[156:159], v5, s[4:7], s52 offen offset:2048 sc1
    v_mfma_f32_16x16x32_bf16 v[32:35], a[216:219], a[100:103], v[32:35]
    ds_read_b128 a[216:219], v173 offset:0
    ds_read_b128 a[104:107], v2 offset:6144
    v_mfma_f32_16x16x32_bf16 v[40:43], a[220:223], a[100:103], v[40:43]
    v_mfma_f32_16x16x32_bf16 v[36:39], a[220:223], a[96:99], v[36:39]
    ds_read_b128 a[220:223], v1 offset:4096
    v_mfma_f32_16x16x32_bf16 v[44:47], a[224:227], a[96:99], v[44:47]
    v_mfma_f32_16x16x32_bf16 v[48:51], a[224:227], a[100:103], v[48:51]
    ds_read_b128 a[224:227], v174 offset:7168
    v_mfma_f32_16x16x32_bf16 v[64:67], a[228:231], a[100:103], v[64:67]
    buffer_load_dwordx4 a[160:163], v5, s[4:7], s52 offen offset:2304 sc1
    v_mfma_f32_16x16x32_bf16 v[60:63], a[228:231], a[96:99], v[60:63]
    s_waitcnt lgkmcnt(9)
    ds_read_b128 a[228:231], v174 offset:14336
    s_add_u32 s52, s52, 4096
    v_mfma_f32_16x16x32_bf16 v[68:71], v[84:87], a[96:99], v[68:71]
    v_mfma_f32_16x16x32_bf16 v[72:75], v[84:87], a[100:103], v[72:75]
    ds_read_b128 v[84:87], v175 offset:7168
    v_mfma_f32_16x16x32_bf16 v[24:27], v[88:91], a[100:103], v[24:27]
    s_waitcnt lgkmcnt(4)
    v_mfma_f32_16x16x32_bf16 v[20:23], v[88:91], a[96:99], v[20:23]
    buffer_load_dwordx4 a[168:171], v5, s[4:7], s52 offen offset:0 sc1
    v_mfma_f32_16x16x32_bf16 v[76:79], v[88:91], a[104:107], v[76:79]
    ds_read_b128 v[88:91], v175 offset:14336
    v_mfma_f32_16x16x32_bf16 v[52:55], v[92:95], a[96:99], v[52:55]
    v_mfma_f32_16x16x32_bf16 v[56:59], v[92:95], a[100:103], v[56:59]
    v_mfma_f32_16x16x32_bf16 v[80:83], v[92:95], a[104:107], v[80:83]
    s_waitcnt vmcnt(9)
    ds_read_b128 v[92:95], v176 offset:7168
    v_mfma_f32_16x16x32_bf16 v[32:35], v[96:99], a[112:115], v[32:35]
    buffer_load_dwordx4 a[172:175], v5, s[4:7], s52 offen offset:256 sc1
    v_mfma_f32_16x16x32_bf16 v[28:31], v[96:99], a[108:111], v[28:31]
    ds_read_b128 v[96:99], v176 offset:14336
    ds_read_b128 a[116:119], v2 offset:7168
    v_mfma_f32_16x16x32_bf16 v[36:39], v[100:103], a[108:111], v[36:39]
    buffer_load_dwordx4 a[180:183], v5, s[4:7], s52 offen offset:2048 sc1
    v_mfma_f32_16x16x32_bf16 v[40:43], v[100:103], a[112:115], v[40:43]
    ds_read_b128 v[100:103], v1 offset:12288
    v_add_f32 v144, v144, v145
    v_mfma_f32_16x16x32_bf16 v[48:51], v[104:107], a[112:115], v[48:51]
    buffer_load_dwordx4 a[184:187], v5, s[4:7], s52 offen offset:2304 sc1
    v_mfma_f32_16x16x32_bf16 v[44:47], v[104:107], a[108:111], v[44:47]
    s_add_u32 s52, s52, 4096
    ds_read_b128 v[104:107], v1 offset:19456
    v_add_f32 v160, v160, v161
    v_mfma_f32_16x16x32_bf16 v[60:63], v[108:111], a[108:111], v[60:63]
    v_add_f32 v144, v144, v146
    v_add_f32 v160, v160, v162
    v_mfma_f32_16x16x32_bf16 v[64:67], v[108:111], a[112:115], v[64:67]
    ds_read_b128 v[108:111], v1 offset:13312
    v_add_f32 v144, v144, v147
    v_mfma_f32_16x16x32_bf16 v[72:75], v[112:115], a[112:115], v[72:75]
    buffer_load_dwordx4 a[192:195], v5, s[4:7], s52 offen offset:0 sc1
    v_mfma_f32_16x16x32_bf16 v[68:71], v[112:115], a[108:111], v[68:71]
    ds_read_b128 v[112:115], v1 offset:20480
    v_add_f32 v160, v160, v163
    v_mfma_f32_16x16x32_bf16 v[20:23], a[216:219], a[108:111], v[20:23]
    s_waitcnt lgkmcnt(4)
    v_add_f32 v144, v144, v148
    v_add_f32 v160, v160, v164
    v_mfma_f32_16x16x32_bf16 v[24:27], a[216:219], a[112:115], v[24:27]
    v_add_f32 v144, v144, v149
    v_add_f32 v160, v160, v165
    v_mfma_f32_16x16x32_bf16 v[76:79], a[216:219], a[116:119], v[76:79]
    ds_read_b128 a[216:219], v173 offset:7168
    v_add_f32 v144, v144, v150
    v_mfma_f32_16x16x32_bf16 v[56:59], a[220:223], a[112:115], v[56:59]
    buffer_load_dwordx4 a[196:199], v5, s[4:7], s52 offen offset:256 sc1
    v_mfma_f32_16x16x32_bf16 v[52:55], a[220:223], a[108:111], v[52:55]
    v_add_f32 v160, v160, v166
    v_add_f32 v144, v144, v151
    v_mfma_f32_16x16x32_bf16 v[80:83], a[220:223], a[116:119], v[80:83]
    s_waitcnt vmcnt(10)
    s_barrier
    ds_read_b128 a[220:223], v173 offset:14336
    v_mfma_f32_16x16x32_bf16 v[28:31], a[224:227], a[120:123], v[28:31]
    buffer_load_dwordx4 a[204:207], v5, s[4:7], s52 offen offset:2048 sc1
    v_mfma_f32_16x16x32_bf16 v[28:31], a[228:231], a[132:135], v[28:31]
    ds_read_b128 a[128:131], v3 offset:8192
    v_add_f32 v160, v160, v167
    v_mfma_f32_16x16x32_bf16 v[32:35], a[228:231], a[136:139], v[32:35]
    buffer_load_dwordx4 a[208:211], v5, s[4:7], s52 offen offset:2304 sc1
    v_mfma_f32_16x16x32_bf16 v[32:35], a[224:227], a[124:127], v[32:35]
    s_add_u32 s54, s54, 9216
    ds_read_b128 a[224:227], v1 offset:11264
    ds_read_b128 a[228:231], v1 offset:18432
    ds_read_b128 a[140:143], v3 offset:9216
    v_mfma_f32_16x16x32_bf16 v[40:43], v[84:87], a[124:127], v[40:43]
    v_add_f32 v144, v144, v152
    v_add_f32 v144, v144, v153
    v_mfma_f32_16x16x32_bf16 v[40:43], v[88:91], a[136:139], v[40:43]
    v_add_f32 v144, v144, v154
    v_add_f32 v144, v144, v155
    v_mfma_f32_16x16x32_bf16 v[36:39], v[88:91], a[132:135], v[36:39]
    buffer_load_dwordx4 a[0:3], v208, s[4:7], s54 offen sc1
    v_mfma_f32_16x16x32_bf16 v[36:39], v[84:87], a[120:123], v[36:39]
    s_waitcnt lgkmcnt(9)
    ds_read_b128 v[84:87], v174 offset:21504
    ds_read_b128 v[88:91], v174 offset:28672
    v_mfma_f32_16x16x32_bf16 v[44:47], v[92:95], a[120:123], v[44:47]
    v_add_f32 v144, v144, v156
    v_add_f32 v144, v144, v157
    v_mfma_f32_16x16x32_bf16 v[44:47], v[96:99], a[132:135], v[44:47]
    v_add_f32 v144, v144, v158
    v_add_f32 v144, v144, v159
    v_mfma_f32_16x16x32_bf16 v[48:51], v[96:99], a[136:139], v[48:51]
    v_mov_b32 v161, v160
    v_mfma_f32_16x16x32_bf16 v[48:51], v[92:95], a[124:127], v[48:51]
    s_waitcnt lgkmcnt(9)
    ds_read_b128 v[92:95], v175 offset:21504
    ds_read_b128 v[96:99], v175 offset:28672
    v_mfma_f32_16x16x32_bf16 v[64:67], v[100:103], a[124:127], v[64:67]
    buffer_load_dwordx4 a[4:7], v208, s[4:7], s54 offen offset:1024 sc1
    v_mfma_f32_16x16x32_bf16 v[64:67], v[104:107], a[136:139], v[64:67]
    v_permlane16_swap_b32 v160, v161
    v_mfma_f32_16x16x32_bf16 v[60:63], v[104:107], a[132:135], v[60:63]
    v_add_f32 v160, v160, v161
    v_mov_b32 v145, v144
    v_mfma_f32_16x16x32_bf16 v[60:63], v[100:103], a[120:123], v[60:63]
    s_waitcnt lgkmcnt(9)
    ds_read_b128 v[100:103], v176 offset:21504
    ds_read_b128 v[104:107], v176 offset:28672
    v_mfma_f32_16x16x32_bf16 v[68:71], v[108:111], a[120:123], v[68:71]
    v_mov_b32 v161, v160
    v_mfma_f32_16x16x32_bf16 v[68:71], v[112:115], a[132:135], v[68:71]
    v_permlane32_swap_b32 v144, v145
    v_mfma_f32_16x16x32_bf16 v[72:75], v[112:115], a[136:139], v[72:75]
    buffer_load_dwordx4 a[8:11], v209, s[4:7], s54 offen sc1
    v_mfma_f32_16x16x32_bf16 v[72:75], v[108:111], a[124:127], v[72:75]
    s_waitcnt lgkmcnt(8)
    ds_read_b128 v[108:111], v1 offset:26624
    ds_read_b128 v[112:115], v1 offset:33792
    v_mfma_f32_16x16x32_bf16 v[24:27], a[216:219], a[124:127], v[24:27]
    s_add_u32 s54, s54, 9216
    v_permlane32_swap_b32 v160, v161
    v_mfma_f32_16x16x32_bf16 v[24:27], a[220:223], a[136:139], v[24:27]
    v_mul_f32 v180, 0x3ae38e39, v144
    v_mul_f32 v184, 0x3ae38e39, v160
    v_mfma_f32_16x16x32_bf16 v[20:23], a[220:223], a[132:135], v[20:23]
    s_waitcnt lgkmcnt(8)
    v_mul_f32 v145, 0x3ae38e39, v145
    v_mul_f32 v161, 0x3ae38e39, v161
    v_mfma_f32_16x16x32_bf16 v[20:23], a[216:219], a[120:123], v[20:23]
    buffer_load_dwordx4 a[12:15], v208, s[4:7], s54 offen sc1
    v_mfma_f32_16x16x32_bf16 v[76:79], a[216:219], a[128:131], v[76:79]
    v_fma_f32 v145, -v180, v180, v145
    v_fma_f32 v161, -v184, v184, v161
    v_mfma_f32_16x16x32_bf16 v[76:79], a[220:223], a[140:143], v[76:79]
    s_waitcnt lgkmcnt(7)
    ds_read_b128 a[216:219], v1 offset:27648
    ds_read_b128 a[220:223], v1 offset:34816
    v_mfma_f32_16x16x32_bf16 v[52:55], a[224:227], a[120:123], v[52:55]
    v_max_f32 v145, 0, v145
    v_max_f32 v161, 0, v161
    v_mfma_f32_16x16x32_bf16 v[52:55], a[228:231], a[132:135], v[52:55]
    v_add_f32 v145, 0x3727c5ac, v145
    v_add_f32 v161, 0x3727c5ac, v161
    v_mfma_f32_16x16x32_bf16 v[56:59], a[228:231], a[136:139], v[56:59]
    v_rsq_f32 v186, v145
    v_mfma_f32_16x16x32_bf16 v[56:59], a[224:227], a[124:127], v[56:59]
    buffer_load_dwordx4 a[16:19], v208, s[4:7], s54 offen offset:1024 sc1
    v_mfma_f32_16x16x32_bf16 v[80:83], a[224:227], a[128:131], v[80:83]
    v_rsq_f32 v188, v161
    v_mfma_f32_16x16x32_bf16 v[80:83], a[228:231], a[140:143], v[80:83]
    s_waitcnt lgkmcnt(7)
    s_waitcnt vmcnt(13)
    ds_read_b128 a[224:227], v173 offset:21504
    ds_read_b128 a[228:231], v173 offset:28672
    v_mfma_f32_16x16x32_bf16 v[32:35], v[84:87], a[148:151], v[32:35]
    v_sub_f32 v180, 0, v180
    v_sub_f32 v184, 0, v184
    v_mfma_f32_16x16x32_bf16 v[32:35], v[88:91], a[160:163], v[32:35]
    ds_read_b128 a[152:155], v3 offset:10240
    v_mov_b32 v182, v180
    v_mfma_f32_16x16x32_bf16 v[28:31], v[88:91], a[156:159], v[28:31]
    buffer_load_dwordx4 a[20:23], v209, s[4:7], s54 offen sc1
    v_mfma_f32_16x16x32_bf16 v[28:31], v[84:87], a[144:147], v[28:31]
    s_waitcnt lgkmcnt(8)
    ds_read_b128 v[84:87], v1 offset:25600
    ds_read_b128 v[88:91], v1 offset:32768
    ds_read_b128 a[164:167], v3 offset:11264
    v_mfma_f32_16x16x32_bf16 v[36:39], v[92:95], a[144:147], v[36:39]
    s_add_u32 s54, s54, 9216
    v_mov_b32 v187, v186
    v_mov_b32 v210, 0
    v_mfma_f32_16x16x32_bf16 v[36:39], v[96:99], a[156:159], v[36:39]
    v_permlane16_swap_b32 v180, v182
    v_mfma_f32_16x16x32_bf16 v[40:43], v[96:99], a[160:163], v[40:43]
    v_permlane16_swap_b32 v186, v187
    v_mfma_f32_16x16x32_bf16 v[40:43], v[92:95], a[148:151], v[40:43]
    s_waitcnt lgkmcnt(9)
    ds_read_b128 v[92:95], v174 offset:35840
    ds_read_b128 v[96:99], v174 offset:43008
    v_mfma_f32_16x16x32_bf16 v[48:51], v[100:103], a[148:151], v[48:51]
    buffer_load_dwordx4 a[24:27], v208, s[4:7], s54 offen sc1
    v_mfma_f32_16x16x32_bf16 v[48:51], v[104:107], a[160:163], v[48:51]
    s_nop 0
    v_fmac_f32 v28, v120, v180
    v_fmac_f32 v29, v121, v180
    v_mfma_f32_16x16x32_bf16 v[44:47], v[104:107], a[156:159], v[44:47]
    v_fmac_f32 v30, v122, v180
    v_fmac_f32 v31, v123, v180
    v_mfma_f32_16x16x32_bf16 v[44:47], v[100:103], a[144:147], v[44:47]
    s_waitcnt lgkmcnt(9)
    ds_read_b128 v[100:103], v174 offset:50176
    ds_read_b128 v[104:107], v174 offset:57344
    v_mfma_f32_16x16x32_bf16 v[60:63], v[108:111], a[144:147], v[60:63]
    v_fmac_f32 v32, v120, v182
    v_fmac_f32 v33, v121, v182
    v_mfma_f32_16x16x32_bf16 v[60:63], v[112:115], a[156:159], v[60:63]
    buffer_load_dwordx4 a[28:31], v208, s[4:7], s54 offen offset:1024 sc1
    v_mfma_f32_16x16x32_bf16 v[64:67], v[112:115], a[160:163], v[64:67]
    v_fmac_f32 v34, v122, v182
    v_fmac_f32 v35, v123, v182
    v_mfma_f32_16x16x32_bf16 v[64:67], v[108:111], a[148:151], v[64:67]
    s_waitcnt lgkmcnt(9)
    ds_read_b128 v[108:111], v175 offset:35840
    ds_read_b128 v[112:115], v175 offset:43008
    v_mfma_f32_16x16x32_bf16 v[72:75], a[216:219], a[148:151], v[72:75]
    v_fmac_f32 v40, v124, v182
    v_fmac_f32 v41, v125, v182
    v_mfma_f32_16x16x32_bf16 v[72:75], a[220:223], a[160:163], v[72:75]
    v_fmac_f32 v42, v126, v182
    v_fmac_f32 v43, v127, v182
    v_mfma_f32_16x16x32_bf16 v[68:71], a[220:223], a[156:159], v[68:71]
    v_fmac_f32 v36, v124, v180
    v_fmac_f32 v37, v125, v180
    v_mfma_f32_16x16x32_bf16 v[68:71], a[216:219], a[144:147], v[68:71]
    s_waitcnt lgkmcnt(8)
    ds_read_b128 a[216:219], v175 offset:50176
    ds_read_b128 a[220:223], v175 offset:57344
    v_mfma_f32_16x16x32_bf16 v[20:23], a[224:227], a[144:147], v[20:23]
    buffer_load_dwordx4 a[32:35], v209, s[4:7], s54 offen sc1
    v_mfma_f32_16x16x32_bf16 v[20:23], a[228:231], a[156:159], v[20:23]
    s_add_u32 s54, s54, 9216
    v_fmac_f32 v38, v126, v180
    v_fmac_f32 v39, v127, v180
    v_mfma_f32_16x16x32_bf16 v[24:27], a[228:231], a[160:163], v[24:27]
    s_waitcnt lgkmcnt(8)
    v_fmac_f32 v44, v128, v180
    v_fmac_f32 v45, v129, v180
    v_mfma_f32_16x16x32_bf16 v[24:27], a[224:227], a[148:151], v[24:27]
    v_fmac_f32 v46, v130, v180
    v_fmac_f32 v47, v131, v180
    v_mfma_f32_16x16x32_bf16 v[76:79], a[224:227], a[152:155], v[76:79]
    v_fmac_f32 v48, v128, v182
    v_fmac_f32 v49, v129, v182
    v_mfma_f32_16x16x32_bf16 v[76:79], a[228:231], a[164:167], v[76:79]
    s_waitcnt lgkmcnt(7)
    ds_read_b128 a[224:227], v176 offset:35840
    ds_read_b128 a[228:231], v176 offset:43008
    v_mfma_f32_16x16x32_bf16 v[56:59], v[84:87], a[148:151], v[56:59]
    buffer_load_dwordx4 a[36:39], v208, s[4:7], s54 offen sc1
    v_mfma_f32_16x16x32_bf16 v[56:59], v[88:91], a[160:163], v[56:59]
    v_fmac_f32 v50, v130, v182
    v_fmac_f32 v51, v131, v182
    v_mfma_f32_16x16x32_bf16 v[52:55], v[88:91], a[156:159], v[52:55]
    v_fmac_f32 v64, v136, v182
    v_fmac_f32 v65, v137, v182
    v_mfma_f32_16x16x32_bf16 v[52:55], v[84:87], a[144:147], v[52:55]
    v_fmac_f32 v66, v138, v182
    v_fmac_f32 v67, v139, v182
    v_mfma_f32_16x16x32_bf16 v[80:83], v[84:87], a[152:155], v[80:83]
    buffer_load_dwordx4 a[40:43], v208, s[4:7], s54 offen offset:1024 sc1
    v_mfma_f32_16x16x32_bf16 v[80:83], v[88:91], a[164:167], v[80:83]
    s_waitcnt lgkmcnt(6)
    s_waitcnt vmcnt(11)
    ds_read_b128 v[84:87], v176 offset:50176
    ds_read_b128 v[88:91], v176 offset:57344
    v_mfma_f32_16x16x32_bf16 v[28:31], v[92:95], a[168:171], v[28:31]
    v_fmac_f32 v60, v136, v180
    v_fmac_f32 v61, v137, v180
    v_mfma_f32_16x16x32_bf16 v[28:31], v[96:99], a[180:183], v[28:31]
    ds_read_b128 a[176:179], v3 offset:12288
    v_fmac_f32 v62, v138, v180
    v_mfma_f32_16x16x32_bf16 v[28:31], v[100:103], a[192:195], v[28:31]
    buffer_load_dwordx4 a[44:47], v209, s[4:7], s54 offen sc1
    v_mfma_f32_16x16x32_bf16 v[28:31], v[104:107], a[204:207], v[28:31]
    s_add_u32 s54, s54, 9216
    ds_read_b128 a[188:191], v3 offset:13312
    v_fmac_f32 v63, v139, v180
    v_mfma_f32_16x16x32_bf16 v[32:35], v[104:107], a[208:211], v[32:35]
    v_fmac_f32 v68, v140, v180
    v_fmac_f32 v69, v141, v180
    v_mfma_f32_16x16x32_bf16 v[32:35], v[100:103], a[196:199], v[32:35]
    ds_read_b128 a[200:203], v3 offset:14336
    v_fmac_f32 v70, v142, v180
    v_mfma_f32_16x16x32_bf16 v[32:35], v[96:99], a[184:187], v[32:35]
    v_fmac_f32 v71, v143, v180
    v_fmac_f32 v72, v140, v182
    v_mfma_f32_16x16x32_bf16 v[32:35], v[92:95], a[172:175], v[32:35]
    s_waitcnt lgkmcnt(7)
    ds_read_b128 v[92:95], v1 offset:40960
    ds_read_b128 v[96:99], v1 offset:48128
    ds_read_b128 a[212:215], v3 offset:15360
    v_mfma_f32_16x16x32_bf16 v[40:43], v[108:111], a[172:175], v[40:43]
    buffer_load_dwordx4 a[48:51], v208, s[4:7], s54 offen sc1
    v_mfma_f32_16x16x32_bf16 v[40:43], v[112:115], a[184:187], v[40:43]
    ds_read_b128 v[100:103], v1 offset:55296
    ds_read_b128 v[104:107], v1 offset:62464
    v_mfma_f32_16x16x32_bf16 v[40:43], a[216:219], a[196:199], v[40:43]
    v_fmac_f32 v73, v141, v182
    v_fmac_f32 v74, v142, v182
    v_mfma_f32_16x16x32_bf16 v[40:43], a[220:223], a[208:211], v[40:43]
    v_fmac_f32 v75, v143, v182
    v_fmac_f32 v24, v116, v182
    v_mfma_f32_16x16x32_bf16 v[36:39], a[220:223], a[204:207], v[36:39]
    buffer_load_dwordx4 a[52:55], v208, s[4:7], s54 offen offset:1024 sc1
    v_mfma_f32_16x16x32_bf16 v[36:39], a[216:219], a[192:195], v[36:39]
    v_fmac_f32 v25, v117, v182
    v_fmac_f32 v26, v118, v182
    v_mfma_f32_16x16x32_bf16 v[36:39], v[112:115], a[180:183], v[36:39]
    v_fmac_f32 v27, v119, v182
    v_fmac_f32 v20, v116, v180
    v_mfma_f32_16x16x32_bf16 v[36:39], v[108:111], a[168:171], v[36:39]
    s_waitcnt lgkmcnt(8)
    ds_read_b128 v[108:111], v1 offset:41984
    ds_read_b128 v[112:115], v1 offset:49152
    v_mfma_f32_16x16x32_bf16 v[44:47], a[224:227], a[168:171], v[44:47]
    v_fmac_f32 v21, v117, v180
    v_fmac_f32 v22, v118, v180
    v_mfma_f32_16x16x32_bf16 v[44:47], a[228:231], a[180:183], v[44:47]
    ds_read_b128 a[216:219], v1 offset:56320
    ds_read_b128 a[220:223], v1 offset:63488
    v_mfma_f32_16x16x32_bf16 v[44:47], v[84:87], a[192:195], v[44:47]
    buffer_load_dwordx4 a[56:59], v209, s[4:7], s54 offen sc1
    v_mfma_f32_16x16x32_bf16 v[44:47], v[88:91], a[204:207], v[44:47]
    s_add_u32 s54, s54, 9216
    v_fmac_f32 v23, v119, v180
    v_fmac_f32 v76, v116, v184
    v_mfma_f32_16x16x32_bf16 v[48:51], v[88:91], a[208:211], v[48:51]
    v_fmac_f32 v77, v117, v184
    v_fmac_f32 v78, v118, v184
    v_mfma_f32_16x16x32_bf16 v[48:51], v[84:87], a[196:199], v[48:51]
    v_fmac_f32 v79, v119, v184
    v_fmac_f32 v52, v132, v180
    v_mfma_f32_16x16x32_bf16 v[48:51], a[228:231], a[184:187], v[48:51]
    v_fmac_f32 v53, v133, v180
    v_fmac_f32 v54, v134, v180
    v_mfma_f32_16x16x32_bf16 v[48:51], a[224:227], a[172:175], v[48:51]
    s_waitcnt lgkmcnt(4)
    ds_read_b128 a[224:227], v173 offset:35840
    ds_read_b128 a[228:231], v173 offset:43008
    v_mfma_f32_16x16x32_bf16 v[64:67], v[92:95], a[172:175], v[64:67]
    buffer_load_dwordx4 a[60:63], v208, s[4:7], s54 offen sc1
    v_mfma_f32_16x16x32_bf16 v[64:67], v[96:99], a[184:187], v[64:67]
    ds_read_b128 v[84:87], v173 offset:50176
    ds_read_b128 v[88:91], v173 offset:57344
    v_mfma_f32_16x16x32_bf16 v[64:67], v[100:103], a[196:199], v[64:67]
    v_fmac_f32 v55, v135, v180
    v_fmac_f32 v56, v132, v182
    v_mfma_f32_16x16x32_bf16 v[64:67], v[104:107], a[208:211], v[64:67]
    v_fmac_f32 v57, v133, v182
    v_fmac_f32 v58, v134, v182
    v_mfma_f32_16x16x32_bf16 v[60:63], v[104:107], a[204:207], v[60:63]
    v_fmac_f32 v59, v135, v182
    v_fmac_f32 v80, v132, v184
    v_mfma_f32_16x16x32_bf16 v[60:63], v[100:103], a[192:195], v[60:63]
    buffer_load_dwordx4 a[64:67], v208, s[4:7], s54 offen offset:1024 sc1
    v_mfma_f32_16x16x32_bf16 v[60:63], v[96:99], a[180:183], v[60:63]
    v_fmac_f32 v81, v133, v184
    v_fmac_f32 v82, v134, v184
    v_mfma_f32_16x16x32_bf16 v[60:63], v[92:95], a[168:171], v[60:63]
    s_waitcnt lgkmcnt(4)
    ds_read_b128 v[92:95], v1 offset:39936
    ds_read_b128 v[96:99], v1 offset:47104
    v_mfma_f32_16x16x32_bf16 v[68:71], v[108:111], a[168:171], v[68:71]
    v_fmac_f32 v83, v135, v184
    v_cvt_pk_bf16_f32 v28, v28, v29
    v_mfma_f32_16x16x32_bf16 v[68:71], v[112:115], a[180:183], v[68:71]
    ds_read_b128 v[100:103], v1 offset:54272
    ds_read_b128 v[104:107], v1 offset:61440
    v_mfma_f32_16x16x32_bf16 v[68:71], a[216:219], a[192:195], v[68:71]
    v_cvt_pk_bf16_f32 v29, v30, v31
    v_cvt_pk_bf16_f32 v32, v32, v33
    v_mfma_f32_16x16x32_bf16 v[68:71], a[220:223], a[204:207], v[68:71]
    buffer_load_dwordx4 a[68:71], v209, s[4:7], s54 offen sc1
    v_mfma_f32_16x16x32_bf16 v[72:75], a[220:223], a[208:211], v[72:75]
    ds_write_b64 v199, v[28:29] offset:0
    s_add_u32 s54, s54, 9216
    v_mfma_f32_16x16x32_bf16 v[72:75], a[216:219], a[196:199], v[72:75]
    v_cvt_pk_bf16_f32 v33, v34, v35
    v_cvt_pk_bf16_f32 v40, v40, v41
    v_mfma_f32_16x16x32_bf16 v[72:75], v[112:115], a[184:187], v[72:75]
    ds_write_b64 v199, v[32:33] offset:3840
    v_cvt_pk_bf16_f32 v41, v42, v43
    v_mfma_f32_16x16x32_bf16 v[72:75], v[108:111], a[172:175], v[72:75]
    s_waitcnt lgkmcnt(6)
    ds_write_b64 v200, v[40:41] offset:3840
    v_cvt_pk_bf16_f32 v36, v36, v37
    v_mfma_f32_16x16x32_bf16 v[24:27], a[224:227], a[172:175], v[24:27]
    buffer_load_dwordx4 a[72:75], v208, s[4:7], s54 offen sc1
    v_mfma_f32_16x16x32_bf16 v[24:27], a[228:231], a[184:187], v[24:27]
    v_cvt_pk_bf16_f32 v37, v38, v39
    v_cvt_pk_bf16_f32 v44, v44, v45
    v_mfma_f32_16x16x32_bf16 v[24:27], v[84:87], a[196:199], v[24:27]
    ds_write_b64 v200, v[36:37] offset:0
    v_cvt_pk_bf16_f32 v45, v46, v47
    v_mfma_f32_16x16x32_bf16 v[24:27], v[88:91], a[208:211], v[24:27]
    ds_write_b64 v201, v[44:45] offset:0
    v_cvt_pk_bf16_f32 v48, v48, v49
    v_mfma_f32_16x16x32_bf16 v[20:23], v[88:91], a[204:207], v[20:23]
    v_cvt_pk_bf16_f32 v49, v50, v51
    v_cvt_pk_bf16_f32 v64, v64, v65
    v_mfma_f32_16x16x32_bf16 v[20:23], v[84:87], a[192:195], v[20:23]
    ds_write_b64 v201, v[48:49] offset:3840
    v_cvt_pk_bf16_f32 v65, v66, v67
    v_mfma_f32_16x16x32_bf16 v[20:23], a[228:231], a[180:183], v[20:23]
    buffer_load_dwordx4 a[76:79], v208, s[4:7], s54 offen offset:1024 sc1
    v_mfma_f32_16x16x32_bf16 v[20:23], a[224:227], a[168:171], v[20:23]
    ds_write_b64 v202, v[64:65] offset:4000
    v_cvt_pk_bf16_f32 v60, v60, v61
    v_mfma_f32_16x16x32_bf16 v[76:79], a[224:227], a[176:179], v[76:79]
    v_cvt_pk_bf16_f32 v61, v62, v63
    v_cvt_pk_bf16_f32 v68, v68, v69
    v_mfma_f32_16x16x32_bf16 v[76:79], a[228:231], a[188:191], v[76:79]
    ds_write_b64 v202, v[60:61] offset:160
    v_cvt_pk_bf16_f32 v69, v70, v71
    v_mfma_f32_16x16x32_bf16 v[76:79], v[84:87], a[200:203], v[76:79]
    ds_write_b64 v202, v[68:69] offset:192
    v_cvt_pk_bf16_f32 v72, v72, v73
    v_mfma_f32_16x16x32_bf16 v[76:79], v[88:91], a[212:215], v[76:79]
    s_waitcnt lgkmcnt(9)
    buffer_load_dwordx4 a[80:83], v209, s[4:7], s54 offen sc1
    v_mfma_f32_16x16x32_bf16 v[52:55], v[92:95], a[168:171], v[52:55]
    s_add_u32 s54, s54, 9216
    v_cvt_pk_bf16_f32 v73, v74, v75
    v_mfma_f32_16x16x32_bf16 v[52:55], v[96:99], a[180:183], v[52:55]
    ds_write_b64 v202, v[72:73] offset:4032
    v_cvt_pk_bf16_f32 v24, v24, v25
    v_mfma_f32_16x16x32_bf16 v[52:55], v[100:103], a[192:195], v[52:55]
    v_cvt_pk_bf16_f32 v25, v26, v27
    v_cvt_pk_bf16_f32 v20, v20, v21
    v_mfma_f32_16x16x32_bf16 v[52:55], v[104:107], a[204:207], v[52:55]
    ds_write_b64 v198, v[24:25] offset:3840
    v_cvt_pk_bf16_f32 v21, v22, v23
    v_mfma_f32_16x16x32_bf16 v[56:59], v[104:107], a[208:211], v[56:59]
    ds_write_b64 v198, v[20:21] offset:0
    v_cvt_pk_bf16_f32 v76, v76, v77
    v_mfma_f32_16x16x32_bf16 v[56:59], v[100:103], a[196:199], v[56:59]
    buffer_load_dwordx4 a[84:87], v208, s[4:7], s54 offen sc1
    v_mfma_f32_16x16x32_bf16 v[56:59], v[96:99], a[184:187], v[56:59]
    v_cvt_pk_bf16_f32 v77, v78, v79
    v_cvt_pk_bf16_f32 v52, v52, v53
    v_mfma_f32_16x16x32_bf16 v[56:59], v[92:95], a[172:175], v[56:59]
    ds_write_b64 v203, v[76:77] offset:0
    v_cvt_pk_bf16_f32 v53, v54, v55
    v_mfma_f32_16x16x32_bf16 v[80:83], v[92:95], a[176:179], v[80:83]
    v_cndmask_b32 v53, v53, v186, vcc
    v_mfma_f32_16x16x32_bf16 v[80:83], v[96:99], a[188:191], v[80:83]
    ds_write_b64 v202, v[52:53] offset:128
    v_mfma_f32_16x16x32_bf16 v[80:83], v[100:103], a[200:203], v[80:83]
    buffer_load_dwordx4 a[88:91], v208, s[4:7], s54 offen offset:1024 sc1
    v_mfma_f32_16x16x32_bf16 v[80:83], v[104:107], a[212:215], v[80:83]
    v_cvt_pk_bf16_f32 v56, v56, v57
    v_cvt_pk_bf16_f32 v57, v58, v59
    v_cndmask_b32 v57, v57, v187, vcc
    s_nop 4
    v_cvt_pk_bf16_f32 v80, v80, v81
    v_cvt_pk_bf16_f32 v81, v82, v83
    v_cndmask_b32 v81, v81, v188, vcc
    ds_write_b64 v202, v[56:57] offset:3968
    ds_write_b64 v204, v[80:81] offset:128
    buffer_load_dwordx4 a[92:95], v209, s[4:7], s54 offen sc1
    s_add_u32 s54, s54, 9216
    buffer_load_dwordx4 a[96:99], v208, s[4:7], s54 offen sc1
    buffer_load_dwordx4 a[100:103], v208, s[4:7], s54 offen offset:1024 sc1
    s_waitcnt lgkmcnt(0)
    s_barrier
    ds_read_b128 v[20:23], v206 offset:3520
    ds_read_b128 v[24:27], v206 offset:3536
    ds_read_b128 v[28:31], v207 offset:3488
    ds_read_b128 v[60:63], v206 offset:3360
    ds_read_b128 v[64:67], v206 offset:3376
    ds_read_b128 v[32:35], v207 offset:3008
    ds_read_b128 v[68:71], v206 offset:2880
    ds_read_b128 v[72:75], v206 offset:2896
    ds_read_b128 v[36:39], v207 offset:2528
    ds_read_b128 v[76:79], v206 offset:2400
    ds_read_b128 v[80:83], v206 offset:2416
    ds_read_b128 v[40:43], v207 offset:2048
    ds_read_b128 v[84:87], v206 offset:1920
    ds_read_b128 v[88:91], v206 offset:1936
    buffer_load_dwordx4 a[104:107], v209, s[4:7], s54 offen sc1
    s_add_u32 s54, s54, 9216
    buffer_load_dwordx4 a[108:111], v208, s[4:7], s54 offen sc1
    buffer_load_dwordx4 a[112:115], v208, s[4:7], s54 offen offset:1024 sc1
    v_mov_b32 v214, 0
    v_mov_b32 v215, 0
    v_mov_b32 v216, 0
    v_mov_b32 v217, 0
    v_mov_b32 v218, 0
    v_mov_b32 v219, 0
    v_mov_b32 v220, 0
    v_mov_b32 v221, 0
    v_mov_b32 v238, 0
    v_mov_b32 v239, 0
    v_mov_b32 v240, 0
    v_mov_b32 v241, 0
    v_mov_b32 v242, 0
    v_mov_b32 v243, 0
    v_mov_b32 v244, 0
    v_mov_b32 v245, 0
    v_mov_b32 v246, 0
    v_mov_b32 v247, 0
    v_mov_b32 v248, 0
    v_mov_b32 v249, 0
    v_mov_b32 v250, 0
    v_mov_b32 v251, 0
    v_mov_b32 v252, 0
    v_mov_b32 v253, 0
    v_mov_b32 v254, 0
    v_mov_b32 v255, 0
    s_waitcnt lgkmcnt(9)
    ds_read_b128 v[44:47], v207 offset:1568
    ds_read_b128 v[92:95], v206 offset:1440
    ds_read_b128 v[96:99], v206 offset:1456
    buffer_load_dwordx4 a[116:119], v209, s[4:7], s54 offen sc1
    v_dot2c_f32_bf16 v214, v20, v60
    v_dot2c_f32_bf16 v214, v21, v61
    v_dot2c_f32_bf16 v214, v22, v62
    v_dot2c_f32_bf16 v214, v23, v63
    v_dot2c_f32_bf16 v214, v24, v64
    v_dot2c_f32_bf16 v214, v25, v65
    v_dot2c_f32_bf16 v214, v26, v66
    v_dot2c_f32_bf16 v214, v27, v67
    v_dot2c_f32_bf16 v214, v30, v28
    s_waitcnt lgkmcnt(9)
    ds_read_b128 v[48:51], v207 offset:1088
    ds_read_b128 v[100:103], v206 offset:960
    ds_read_b128 v[104:107], v206 offset:976
    s_add_u32 s54, s54, 9216
    buffer_load_dwordx4 a[120:123], v208, s[4:7], s54 offen sc1
    v_dot2c_f32_bf16 v215, v20, v68
    v_dot2c_f32_bf16 v215, v21, v69
    v_dot2c_f32_bf16 v215, v22, v70
    v_dot2c_f32_bf16 v215, v23, v71
    v_dot2c_f32_bf16 v215, v24, v72
    v_dot2c_f32_bf16 v215, v25, v73
    v_dot2c_f32_bf16 v215, v26, v74
    v_dot2c_f32_bf16 v215, v27, v75
    v_dot2c_f32_bf16 v215, v30, v32
    s_waitcnt lgkmcnt(9)
    ds_read_b128 v[52:55], v207 offset:608
    ds_read_b128 v[108:111], v206 offset:480
    ds_read_b128 v[112:115], v206 offset:496
    buffer_load_dwordx4 a[124:127], v208, s[4:7], s54 offen offset:1024 sc1
    v_dot2c_f32_bf16 v216, v20, v76
    v_dot2c_f32_bf16 v216, v21, v77
    v_dot2c_f32_bf16 v216, v22, v78
    v_dot2c_f32_bf16 v216, v23, v79
    v_dot2c_f32_bf16 v216, v24, v80
    v_dot2c_f32_bf16 v216, v25, v81
    v_dot2c_f32_bf16 v216, v26, v82
    v_dot2c_f32_bf16 v216, v27, v83
    v_dot2c_f32_bf16 v216, v30, v36
    s_waitcnt lgkmcnt(9)
    ds_read_b128 v[56:59], v207 offset:128
    ds_read_b128 v[116:119], v206 offset:0
    ds_read_b128 v[120:123], v206 offset:16
    buffer_load_dwordx4 a[128:131], v209, s[4:7], s54 offen sc1
    v_dot2c_f32_bf16 v217, v20, v84
    v_dot2c_f32_bf16 v217, v21, v85
    v_dot2c_f32_bf16 v217, v22, v86
    v_dot2c_f32_bf16 v217, v23, v87
    v_dot2c_f32_bf16 v217, v24, v88
    v_dot2c_f32_bf16 v217, v25, v89
    v_dot2c_f32_bf16 v217, v26, v90
    v_dot2c_f32_bf16 v217, v27, v91
    v_dot2c_f32_bf16 v217, v30, v40
    s_waitcnt lgkmcnt(9)
    ds_read_b128 v[124:127], v206 offset:3424
    ds_read_b128 v[128:131], v206 offset:3440
    s_add_u32 s54, s54, 9216
    buffer_load_dwordx4 a[132:135], v208, s[4:7], s54 offen sc1
    v_dot2c_f32_bf16 v218, v20, v92
    v_dot2c_f32_bf16 v218, v21, v93
    v_dot2c_f32_bf16 v218, v22, v94
    v_dot2c_f32_bf16 v218, v23, v95
    v_dot2c_f32_bf16 v218, v24, v96
    v_dot2c_f32_bf16 v218, v25, v97
    v_dot2c_f32_bf16 v218, v26, v98
    v_dot2c_f32_bf16 v218, v27, v99
    v_dot2c_f32_bf16 v218, v30, v44
    s_waitcnt lgkmcnt(8)
    ds_read_b128 v[132:135], v206 offset:2944
    ds_read_b128 v[136:139], v206 offset:2960
    buffer_load_dwordx4 a[136:139], v208, s[4:7], s54 offen offset:1024 sc1
    v_dot2c_f32_bf16 v219, v20, v100
    v_dot2c_f32_bf16 v219, v21, v101
    v_dot2c_f32_bf16 v219, v22, v102
    v_dot2c_f32_bf16 v219, v23, v103
    v_dot2c_f32_bf16 v219, v24, v104
    v_dot2c_f32_bf16 v219, v25, v105
    v_dot2c_f32_bf16 v219, v26, v106
    v_dot2c_f32_bf16 v219, v27, v107
    v_dot2c_f32_bf16 v219, v30, v48
    s_waitcnt lgkmcnt(7)
    ds_read_b128 v[140:143], v206 offset:2464
    ds_read_b128 v[144:147], v206 offset:2480
    buffer_load_dwordx4 a[140:143], v209, s[4:7], s54 offen sc1
    v_dot2c_f32_bf16 v220, v20, v108
    v_dot2c_f32_bf16 v220, v21, v109
    v_dot2c_f32_bf16 v220, v22, v110
    v_dot2c_f32_bf16 v220, v23, v111
    v_dot2c_f32_bf16 v220, v24, v112
    v_dot2c_f32_bf16 v220, v25, v113
    v_dot2c_f32_bf16 v220, v26, v114
    v_dot2c_f32_bf16 v220, v27, v115
    v_dot2c_f32_bf16 v220, v30, v52
    s_waitcnt lgkmcnt(6)
    ds_read_b128 v[148:151], v206 offset:1984
    ds_read_b128 v[152:155], v206 offset:2000
    s_add_u32 s54, s54, 9216
    buffer_load_dwordx4 a[144:147], v208, s[4:7], s54 offen sc1
    v_dot2c_f32_bf16 v221, v20, v116
    v_dot2c_f32_bf16 v221, v21, v117
    v_dot2c_f32_bf16 v221, v22, v118
    v_dot2c_f32_bf16 v221, v23, v119
    v_dot2c_f32_bf16 v221, v24, v120
    v_dot2c_f32_bf16 v221, v25, v121
    v_dot2c_f32_bf16 v221, v26, v122
    v_dot2c_f32_bf16 v221, v27, v123
    v_dot2c_f32_bf16 v221, v30, v56
    ds_read_b128 v[156:159], v206 offset:1504
    ds_read_b128 v[160:163], v206 offset:1520
    buffer_load_dwordx4 a[148:151], v208, s[4:7], s54 offen offset:1024 sc1
    v_mul_f32 v197, 0x3eae1a93, v31
    v_mul_f32 v214, v214, v31
    v_mul_f32 v215, v215, v35
    v_mul_f32 v216, v216, v39
    v_mul_f32 v217, v217, v43
    v_mul_f32 v218, v218, v47
    v_mul_f32 v219, v219, v51
    v_mul_f32 v220, v220, v55
    v_mul_f32 v221, v221, v59
    v_mul_f32 v214, v214, v197
    v_fmac_f32 v190, v215, v197
    v_fmac_f32 v191, v216, v197
    v_fmac_f32 v192, v217, v197
    v_fmac_f32 v193, v218, v197
    v_fmac_f32 v194, v219, v197
    v_fmac_f32 v195, v220, v197
    v_fmac_f32 v196, v221, v197
    ds_read_b128 v[164:167], v206 offset:1024
    ds_read_b128 v[168:171], v206 offset:1040
    buffer_load_dwordx4 a[152:155], v209, s[4:7], s54 offen sc1
    v_max3_f32 v210, v214, v190, v191
    v_max3_f32 v211, v192, v193, v194
    v_max3_f32 v210, v210, v195, v196
    v_max_f32 v210, v210, v211
    v_sub_f32 v214, v214, v210
    v_sub_f32 v215, v190, v210
    v_sub_f32 v216, v191, v210
    v_sub_f32 v217, v192, v210
    v_sub_f32 v218, v193, v210
    v_sub_f32 v219, v194, v210
    v_sub_f32 v220, v195, v210
    v_sub_f32 v221, v196, v210
    ds_read_b128 v[172:175], v206 offset:544
    ds_read_b128 v[176:179], v206 offset:560
    s_add_u32 s54, s54, 9216
    buffer_load_dwordx4 a[156:159], v208, s[4:7], s54 offen sc1
    v_exp_f32 v214, v214
    v_exp_f32 v215, v215
    v_exp_f32 v216, v216
    v_exp_f32 v217, v217
    v_exp_f32 v218, v218
    v_exp_f32 v219, v219
    v_exp_f32 v220, v220
    v_exp_f32 v221, v221
    ds_read_b128 v[180:183], v206 offset:64
    ds_read_b128 v[184:187], v206 offset:80
    buffer_load_dwordx4 a[160:163], v208, s[4:7], s54 offen offset:1024 sc1
    v_mul_f32 v230, v214, v31
    v_mul_f32 v231, v215, v35
    v_mul_f32 v232, v216, v39
    v_mul_f32 v233, v217, v43
    v_mul_f32 v234, v218, v47
    v_mul_f32 v235, v219, v51
    v_mul_f32 v236, v220, v55
    v_mul_f32 v237, v221, v59
    v_pk_add_f32 v[214:215], v[214:215], v[216:217]
    v_pk_add_f32 v[218:219], v[218:219], v[220:221]
    v_cvt_pk_bf16_f32 v222, v230, 0
    v_lshlrev_b32 v230, 16, v222
    v_cvt_pk_bf16_f32 v223, v231, 0
    v_lshlrev_b32 v231, 16, v223
    v_cvt_pk_bf16_f32 v224, v232, 0
    v_lshlrev_b32 v232, 16, v224
    v_cvt_pk_bf16_f32 v225, v233, 0
    v_lshlrev_b32 v233, 16, v225
    v_cvt_pk_bf16_f32 v226, v234, 0
    v_lshlrev_b32 v234, 16, v226
    v_cvt_pk_bf16_f32 v227, v235, 0
    v_lshlrev_b32 v235, 16, v227
    v_cvt_pk_bf16_f32 v228, v236, 0
    v_lshlrev_b32 v236, 16, v228
    v_cvt_pk_bf16_f32 v229, v237, 0
    v_lshlrev_b32 v237, 16, v229
    v_pk_add_f32 v[214:215], v[214:215], v[218:219]
    v_add_f32 v214, v214, v215
    v_rcp_f32 v214, v214
    s_waitcnt lgkmcnt(0)
    buffer_load_dwordx4 a[164:167], v209, s[4:7], s54 offen sc1
    s_add_u32 s54, s54, 9216
    buffer_load_dwordx4 a[168:171], v208, s[4:7], s54 offen sc1
    v_dot2c_f32_bf16 v238, v124, v222
    v_dot2c_f32_bf16 v239, v124, v230
    v_dot2c_f32_bf16 v240, v125, v222
    v_dot2c_f32_bf16 v241, v125, v230
    v_dot2c_f32_bf16 v242, v126, v222
    v_dot2c_f32_bf16 v243, v126, v230
    v_dot2c_f32_bf16 v244, v127, v222
    v_dot2c_f32_bf16 v245, v127, v230
    v_dot2c_f32_bf16 v246, v128, v222
    v_dot2c_f32_bf16 v247, v128, v230
    v_dot2c_f32_bf16 v248, v129, v222
    v_dot2c_f32_bf16 v249, v129, v230
    v_dot2c_f32_bf16 v250, v130, v222
    v_dot2c_f32_bf16 v251, v130, v230
    v_dot2c_f32_bf16 v252, v131, v222
    v_dot2c_f32_bf16 v253, v131, v230
    v_dot2c_f32_bf16 v254, v29, v222
    v_dot2c_f32_bf16 v255, v29, v230
    v_dot2c_f32_bf16 v238, v132, v223
    v_dot2c_f32_bf16 v239, v132, v231
    v_dot2c_f32_bf16 v240, v133, v223
    v_dot2c_f32_bf16 v241, v133, v231
    v_dot2c_f32_bf16 v242, v134, v223
    v_dot2c_f32_bf16 v243, v134, v231
    v_dot2c_f32_bf16 v244, v135, v223
    v_dot2c_f32_bf16 v245, v135, v231
    v_dot2c_f32_bf16 v246, v136, v223
    v_dot2c_f32_bf16 v247, v136, v231
    v_dot2c_f32_bf16 v248, v137, v223
    v_dot2c_f32_bf16 v249, v137, v231
    v_dot2c_f32_bf16 v250, v138, v223
    v_dot2c_f32_bf16 v251, v138, v231
    v_dot2c_f32_bf16 v252, v139, v223
    v_dot2c_f32_bf16 v253, v139, v231
    v_dot2c_f32_bf16 v254, v33, v223
    v_dot2c_f32_bf16 v255, v33, v231
    buffer_load_dwordx4 a[172:175], v208, s[4:7], s54 offen offset:1024 sc1
    buffer_load_dwordx4 a[176:179], v209, s[4:7], s54 offen sc1
    v_dot2c_f32_bf16 v238, v140, v224
    v_dot2c_f32_bf16 v239, v140, v232
    v_dot2c_f32_bf16 v240, v141, v224
    v_dot2c_f32_bf16 v241, v141, v232
    v_dot2c_f32_bf16 v242, v142, v224
    v_dot2c_f32_bf16 v243, v142, v232
    v_dot2c_f32_bf16 v244, v143, v224
    v_dot2c_f32_bf16 v245, v143, v232
    v_dot2c_f32_bf16 v246, v144, v224
    v_dot2c_f32_bf16 v247, v144, v232
    v_dot2c_f32_bf16 v248, v145, v224
    v_dot2c_f32_bf16 v249, v145, v232
    v_dot2c_f32_bf16 v250, v146, v224
    v_dot2c_f32_bf16 v251, v146, v232
    v_dot2c_f32_bf16 v252, v147, v224
    v_dot2c_f32_bf16 v253, v147, v232
    v_dot2c_f32_bf16 v254, v37, v224
    v_dot2c_f32_bf16 v255, v37, v232
    v_dot2c_f32_bf16 v238, v148, v225
    v_dot2c_f32_bf16 v239, v148, v233
    v_dot2c_f32_bf16 v240, v149, v225
    v_dot2c_f32_bf16 v241, v149, v233
    v_dot2c_f32_bf16 v242, v150, v225
    v_dot2c_f32_bf16 v243, v150, v233
    v_dot2c_f32_bf16 v244, v151, v225
    v_dot2c_f32_bf16 v245, v151, v233
    v_dot2c_f32_bf16 v246, v152, v225
    v_dot2c_f32_bf16 v247, v152, v233
    v_dot2c_f32_bf16 v248, v153, v225
    v_dot2c_f32_bf16 v249, v153, v233
    v_dot2c_f32_bf16 v250, v154, v225
    v_dot2c_f32_bf16 v251, v154, v233
    v_dot2c_f32_bf16 v252, v155, v225
    v_dot2c_f32_bf16 v253, v155, v233
    v_dot2c_f32_bf16 v254, v41, v225
    v_dot2c_f32_bf16 v255, v41, v233
    s_add_u32 s54, s54, 9216
    buffer_load_dwordx4 a[180:183], v208, s[4:7], s54 offen sc1
    buffer_load_dwordx4 a[184:187], v208, s[4:7], s54 offen offset:1024 sc1
    v_dot2c_f32_bf16 v238, v156, v226
    v_dot2c_f32_bf16 v239, v156, v234
    v_dot2c_f32_bf16 v240, v157, v226
    v_dot2c_f32_bf16 v241, v157, v234
    v_dot2c_f32_bf16 v242, v158, v226
    v_dot2c_f32_bf16 v243, v158, v234
    v_dot2c_f32_bf16 v244, v159, v226
    v_dot2c_f32_bf16 v245, v159, v234
    v_dot2c_f32_bf16 v246, v160, v226
    v_dot2c_f32_bf16 v247, v160, v234
    v_dot2c_f32_bf16 v248, v161, v226
    v_dot2c_f32_bf16 v249, v161, v234
    v_dot2c_f32_bf16 v250, v162, v226
    v_dot2c_f32_bf16 v251, v162, v234
    v_dot2c_f32_bf16 v252, v163, v226
    v_dot2c_f32_bf16 v253, v163, v234
    v_dot2c_f32_bf16 v254, v45, v226
    v_dot2c_f32_bf16 v255, v45, v234
    v_dot2c_f32_bf16 v238, v164, v227
    v_dot2c_f32_bf16 v239, v164, v235
    v_dot2c_f32_bf16 v240, v165, v227
    v_dot2c_f32_bf16 v241, v165, v235
    v_dot2c_f32_bf16 v242, v166, v227
    v_dot2c_f32_bf16 v243, v166, v235
    v_dot2c_f32_bf16 v244, v167, v227
    v_dot2c_f32_bf16 v245, v167, v235
    v_dot2c_f32_bf16 v246, v168, v227
    v_dot2c_f32_bf16 v247, v168, v235
    v_dot2c_f32_bf16 v248, v169, v227
    v_dot2c_f32_bf16 v249, v169, v235
    v_dot2c_f32_bf16 v250, v170, v227
    v_dot2c_f32_bf16 v251, v170, v235
    v_dot2c_f32_bf16 v252, v171, v227
    v_dot2c_f32_bf16 v253, v171, v235
    v_dot2c_f32_bf16 v254, v49, v227
    v_dot2c_f32_bf16 v255, v49, v235
    v_dot2c_f32_bf16 v238, v172, v228
    v_dot2c_f32_bf16 v239, v172, v236
    v_dot2c_f32_bf16 v240, v173, v228
    v_dot2c_f32_bf16 v241, v173, v236
    v_dot2c_f32_bf16 v242, v174, v228
    v_dot2c_f32_bf16 v243, v174, v236
    v_dot2c_f32_bf16 v244, v175, v228
    v_dot2c_f32_bf16 v245, v175, v236
    v_dot2c_f32_bf16 v246, v176, v228
    v_dot2c_f32_bf16 v247, v176, v236
    v_dot2c_f32_bf16 v248, v177, v228
    v_dot2c_f32_bf16 v249, v177, v236
    v_dot2c_f32_bf16 v250, v178, v228
    v_dot2c_f32_bf16 v251, v178, v236
    v_dot2c_f32_bf16 v252, v179, v228
    v_dot2c_f32_bf16 v253, v179, v236
    v_dot2c_f32_bf16 v254, v53, v228
    v_dot2c_f32_bf16 v255, v53, v236
    v_dot2c_f32_bf16 v238, v180, v229
    v_dot2c_f32_bf16 v239, v180, v237
    v_dot2c_f32_bf16 v240, v181, v229
    v_dot2c_f32_bf16 v241, v181, v237
    v_dot2c_f32_bf16 v242, v182, v229
    v_dot2c_f32_bf16 v243, v182, v237
    v_dot2c_f32_bf16 v244, v183, v229
    v_dot2c_f32_bf16 v245, v183, v237
    v_dot2c_f32_bf16 v246, v184, v229
    v_dot2c_f32_bf16 v247, v184, v237
    v_dot2c_f32_bf16 v248, v185, v229
    v_dot2c_f32_bf16 v249, v185, v237
    v_dot2c_f32_bf16 v250, v186, v229
    v_dot2c_f32_bf16 v251, v186, v237
    v_dot2c_f32_bf16 v252, v187, v229
    v_dot2c_f32_bf16 v253, v187, v237
    v_dot2c_f32_bf16 v254, v57, v229
    v_dot2c_f32_bf16 v255, v57, v237
.p2align 3
    v_pk_mul_f32 v[238:239], v[238:239], v[214:215] op_sel_hi:[1,0]
    v_pk_mul_f32 v[240:241], v[240:241], v[214:215] op_sel_hi:[1,0]
    v_pk_mul_f32 v[242:243], v[242:243], v[214:215] op_sel_hi:[1,0]
    v_pk_mul_f32 v[244:245], v[244:245], v[214:215] op_sel_hi:[1,0]
    v_pk_mul_f32 v[246:247], v[246:247], v[214:215] op_sel_hi:[1,0]
    v_pk_mul_f32 v[248:249], v[248:249], v[214:215] op_sel_hi:[1,0]
    v_pk_mul_f32 v[250:251], v[250:251], v[214:215] op_sel_hi:[1,0]
    v_pk_mul_f32 v[252:253], v[252:253], v[214:215] op_sel_hi:[1,0]
    v_pk_mul_f32 v[254:255], v[254:255], v[214:215] op_sel_hi:[1,0]
    v_cvt_pk_bf16_f32 v20, v238, v239
    v_cvt_pk_bf16_f32 v21, v240, v241
    v_cvt_pk_bf16_f32 v22, v242, v243
    v_cvt_pk_bf16_f32 v23, v244, v245
    v_cvt_pk_bf16_f32 v24, v246, v247
    v_cvt_pk_bf16_f32 v25, v248, v249
    v_cvt_pk_bf16_f32 v26, v250, v251
    v_cvt_pk_bf16_f32 v27, v252, v253
    v_cvt_pk_bf16_f32 v28, v254, v255
    buffer_store_dwordx4 v[20:23], v189, s[4:7], s48 offen sc1
    buffer_store_dwordx4 v[24:27], v189, s[4:7], s48 offen offset:512 sc1
    buffer_store_dword v28, v205, s[4:7], s49 offen sc1
    s_waitcnt vmcnt(0)
    s_barrier
    buffer_atomic_add v10, v6, s[4:7], s28 offen offset:0 sc1
    buffer_load_dwordx4 a[188:191], v209, s[4:7], s54 offen sc1
    s_add_u32 s54, s54, 9216
    buffer_load_dwordx4 a[192:195], v208, s[4:7], s54 offen sc1
    buffer_load_dwordx4 a[196:199], v208, s[4:7], s54 offen offset:1024 sc1
    buffer_load_dwordx4 a[200:203], v209, s[4:7], s54 offen sc1
    s_add_u32 s54, s54, 9216
    buffer_load_dwordx4 a[204:207], v208, s[4:7], s54 offen sc1
    buffer_load_dwordx4 a[208:211], v208, s[4:7], s54 offen offset:1024 sc1
    buffer_load_dwordx4 a[212:215], v209, s[4:7], s54 offen sc1
L_main_p2:
    s_lshl_b32 s30, s16, 2
    s_add_u32 s30, s30, s18
    s_mul_i32 s52, s30, 36864
    s_add_u32 s52, s52, s21
    s_lshl_b32 s31, s19, 13
    s_add_u32 s53, s52, s31
    s_add_u32 s32, s53, 15859712
    s_lshl_b32 s33, s20, 11
    s_add_u32 s33, s33, s32
    s_and_b32 s34, s20, 1
    s_lshl_b32 s35, s34, 8
    v_and_b32 v121, 15, v0
    v_lshrrev_b32 v122, 5, v0
    v_lshlrev_b32 v112, 9, v122
    v_lshl_add_u32 v112, v121, 4, v112
    v_bfe_u32 v122, v0, 4, 1
    v_lshl_add_u32 v112, v122, 3, v112
    s_cmp_lt_u32 s20, 2
    s_cselect_b32 s31, 0, 2147483648
    s_or_b32 s31, s31, s15
    s_or_b32 s31, s31, s35
    v_or_b32 v114, s31, v112
    v_add_u32 v112, s35, v5
    v_xor_b32 v113, 256, v112
    buffer_load_dwordx4 v[40:43], v112, s[4:7], s33 offen sc1
    buffer_load_dwordx4 v[44:47], v113, s[4:7], s33 offen sc1
    buffer_load_dwordx2 v[48:49], v114, s[4:7], s32 offen sc1
    s_add_u32 s48, s32, 4980736
    s_add_u32 s49, s33, 4980736
    s_lshl_b32 s50, s19, 2
    s_add_u32 s50, s50, s20
    s_lshl_b32 s50, s50, 8
    s_lshl_b32 s30, s30, 12
    s_add_u32 s50, s50, s30
    s_add_u32 s50, s50, s21
    s_add_u32 s50, s50, 23199744
    s_mul_i32 s41, s17, 331776
    s_add_u32 s41, s41, s42
    s_add_u32 s41, s41, 5242880
    v_add_u32 v115, 110592, v112
    v_xor_b32 v116, 256, v115
    v_lshrrev_b32 v122, 4, v0
    v_lshlrev_b32 v117, 9, v122
    v_lshl_add_u32 v117, v121, 3, v117
    s_lshl_b32 s31, s34, 7
    s_add_u32 s31, s31, 143360
    v_add_u32 v117, s31, v117
    v_xor_b32 v118, 128, v117
    v_xor_b32 v119, s35, v1
    v_lshrrev_b32 v120, 2, v119
    s_mul_i32 s31, s20, 3072
    s_add_u32 s54, s52, s31
    s_add_u32 s54, s54, 18481152
    s_add_u32 s55, s31, 110592
    s_or_b32 s31, s20, s22
    s_cbranch_scc1 L_inte_eo_20
L_inte_poll_21:
    s_load_dword s57, s[12:13], 0 glc
    s_load_dword s3, s[12:13], 132 glc
    s_waitcnt lgkmcnt(0)
    s_cmp_ge_u32 s3, 16
    s_cselect_b32 s57, s57, 0
    s_cmp_ge_u32 s57, 16
    s_cbranch_scc1 L_inte_poll_21_x
    s_sub_u32 s27, s27, 1
    s_cmp_gt_i32 s27, 0
    s_cbranch_scc1 L_inte_poll_21
L_inte_poll_21_x:
    s_branch L_inte_eo_20_x
L_inte_eo_20:
    s_cmp_lg_u32 s20, 0
    s_cbranch_scc1 L_inte_eo_20_x
L_inte_poll_22:
    s_load_dword s57, s[12:13], 0 glc
    s_waitcnt lgkmcnt(0)
    s_cmp_ge_u32 s57, 16
    s_cbranch_scc1 L_inte_poll_22_x
    s_sub_u32 s27, s27, 1
    s_cmp_gt_i32 s27, 0
    s_cbranch_scc1 L_inte_poll_22
L_inte_poll_22_x:
L_inte_eo_20_x:
    s_barrier
    s_add_u32 m0, s55, 0
    s_add_u32 s31, s54, 0
    buffer_load_dwordx4 v1, s[4:7], s31 offen offset:0 sc1 lds
    buffer_load_dwordx4 v1, s[4:7], s31 offen offset:1024 sc1 lds
    buffer_load_dwordx4 v1, s[4:7], s31 offen offset:2048 sc1 lds
    s_add_u32 m0, s55, 12288
    s_add_u32 s31, s54, 12288
    buffer_load_dwordx4 v1, s[4:7], s31 offen offset:0 sc1 lds
    buffer_load_dwordx4 v1, s[4:7], s31 offen offset:1024 sc1 lds
    buffer_load_dwordx4 v1, s[4:7], s31 offen offset:2048 sc1 lds
    s_add_u32 m0, s55, 24576
    s_add_u32 s31, s54, 24576
    buffer_load_dwordx4 v1, s[4:7], s31 offen offset:0 sc1 lds
    buffer_load_dwordx4 v1, s[4:7], s31 offen offset:1024 sc1 lds
    buffer_load_dwordx4 v1, s[4:7], s31 offen offset:2048 sc1 lds
    s_waitcnt vmcnt(9)
    v_lshlrev_b32 v38, 16, v49
    v_and_b32 v39, 0xffff0000, v49
    v_lshlrev_b32 v20, 16, v40
    v_and_b32 v21, 0xffff0000, v40
    v_lshlrev_b32 v22, 16, v41
    v_and_b32 v23, 0xffff0000, v41
    v_lshlrev_b32 v28, 16, v42
    v_and_b32 v29, 0xffff0000, v42
    v_lshlrev_b32 v30, 16, v43
    v_and_b32 v31, 0xffff0000, v43
    v_lshlrev_b32 v24, 16, v44
    v_and_b32 v25, 0xffff0000, v44
    v_lshlrev_b32 v26, 16, v45
    v_and_b32 v27, 0xffff0000, v45
    v_lshlrev_b32 v32, 16, v46
    v_and_b32 v33, 0xffff0000, v46
    v_lshlrev_b32 v34, 16, v47
    v_and_b32 v35, 0xffff0000, v47
    v_lshlrev_b32 v36, 16, v48
    v_and_b32 v37, 0xffff0000, v48
    v_add_u32 v121, 2048, v117
    v_add_u32 v122, 2048, v118
    s_waitcnt vmcnt(6)
    s_barrier
    ds_read_b128 v[52:55], v115 offset:0
    ds_read_b128 v[56:59], v116 offset:0
    ds_read_b128 v[60:63], v115 offset:2048
    ds_read_b128 v[64:67], v116 offset:2048
    ds_read_b128 v[68:71], v115 offset:4096
    ds_read_b128 v[72:75], v116 offset:4096
    s_waitcnt lgkmcnt(4)
    v_mfma_f32_16x16x32_bf16 v[20:23], a[0:3], v[52:55], v[20:23]
    s_add_u32 m0, s42, 0
    ds_read_b128 v[76:79], v115 offset:6144
    ds_read_b128 v[84:87], v115 offset:8192
    v_mfma_f32_16x16x32_bf16 v[28:31], a[4:7], v[52:55], v[28:31]
    buffer_load_dwordx4 v1, s[4:7], s41 offen offset:0 sc1 lds
    v_mfma_f32_16x16x32_bf16 v[36:39], a[8:11], v[52:55], v[36:39]
    ds_read_b128 v[92:95], v115 offset:10240
    ds_read_b128 v[80:83], v116 offset:6144
    v_mfma_f32_16x16x32_bf16 v[32:35], a[4:7], v[56:59], v[32:35]
    buffer_load_dwordx4 v1, s[4:7], s41 offen offset:1024 sc1 lds
    v_mfma_f32_16x16x32_bf16 v[24:27], a[0:3], v[56:59], v[24:27]
    s_waitcnt lgkmcnt(4)
    ds_read_b128 v[88:91], v116 offset:8192
    ds_read_b128 v[96:99], v116 offset:10240
    v_mfma_f32_16x16x32_bf16 v[20:23], a[12:15], v[60:63], v[20:23]
    buffer_load_dwordx4 v1, s[4:7], s41 offen offset:2048 sc1 lds
    v_mfma_f32_16x16x32_bf16 v[28:31], a[16:19], v[60:63], v[28:31]
    buffer_load_dwordx4 v1, s[4:7], s41 offen offset:3072 sc1 lds
    v_mfma_f32_16x16x32_bf16 v[36:39], a[20:23], v[60:63], v[36:39]
    s_add_u32 m0, s42, 4096
    v_mfma_f32_16x16x32_bf16 v[32:35], a[16:19], v[64:67], v[32:35]
    buffer_load_dwordx4 v12, s[4:7], s41 offen offset:0 sc1 lds
    v_mfma_f32_16x16x32_bf16 v[24:27], a[12:15], v[64:67], v[24:27]
    buffer_load_dwordx4 v12, s[4:7], s41 offen offset:1024 sc1 lds
    v_mfma_f32_16x16x32_bf16 v[20:23], a[24:27], v[68:71], v[20:23]
    buffer_load_dwordx4 v12, s[4:7], s41 offen offset:2048 sc1 lds
    v_mfma_f32_16x16x32_bf16 v[28:31], a[28:31], v[68:71], v[28:31]
    buffer_load_dwordx4 v12, s[4:7], s41 offen offset:3072 sc1 lds
    v_mfma_f32_16x16x32_bf16 v[36:39], a[32:35], v[68:71], v[36:39]
    s_add_u32 m0, s42, 8192
    v_mfma_f32_16x16x32_bf16 v[32:35], a[28:31], v[72:75], v[32:35]
    buffer_load_dwordx4 v13, s[4:7], s41 offen offset:0 sc1 lds
    v_mfma_f32_16x16x32_bf16 v[24:27], a[24:27], v[72:75], v[24:27]
    s_waitcnt lgkmcnt(0)
    s_waitcnt vmcnt(12)
    s_barrier
    v_mfma_f32_16x16x32_bf16 v[20:23], a[36:39], v[76:79], v[20:23]
    s_add_u32 m0, s42, 36864
    ds_read_b128 v[132:135], v115 offset:12288
    ds_read_b128 v[140:143], v115 offset:14336
    v_mfma_f32_16x16x32_bf16 v[20:23], a[48:51], v[84:87], v[20:23]
    s_add_u32 s41, s41, 36864
    v_mfma_f32_16x16x32_bf16 v[20:23], a[60:63], v[92:95], v[20:23]
    ds_read_b128 v[148:151], v115 offset:16384
    ds_read_b128 v[156:159], v115 offset:18432
    v_mfma_f32_16x16x32_bf16 v[28:31], a[64:67], v[92:95], v[28:31]
    buffer_load_dwordx4 v1, s[4:7], s41 offen offset:0 sc1 lds
    v_mfma_f32_16x16x32_bf16 v[28:31], a[52:55], v[84:87], v[28:31]
    ds_read_b128 v[164:167], v115 offset:20480
    ds_read_b128 v[172:175], v115 offset:22528
    v_mfma_f32_16x16x32_bf16 v[28:31], a[40:43], v[76:79], v[28:31]
    buffer_load_dwordx4 v1, s[4:7], s41 offen offset:1024 sc1 lds
    v_mfma_f32_16x16x32_bf16 v[36:39], a[44:47], v[76:79], v[36:39]
    v_mfma_f32_16x16x32_bf16 v[36:39], a[56:59], v[84:87], v[36:39]
    v_mfma_f32_16x16x32_bf16 v[36:39], a[68:71], v[92:95], v[36:39]
    v_mfma_f32_16x16x32_bf16 v[32:35], a[40:43], v[80:83], v[32:35]
    buffer_load_dwordx4 v1, s[4:7], s41 offen offset:2048 sc1 lds
    v_mfma_f32_16x16x32_bf16 v[32:35], a[52:55], v[88:91], v[32:35]
    v_mfma_f32_16x16x32_bf16 v[32:35], a[64:67], v[96:99], v[32:35]
    v_mfma_f32_16x16x32_bf16 v[24:27], a[36:39], v[80:83], v[24:27]
    v_mfma_f32_16x16x32_bf16 v[24:27], a[48:51], v[88:91], v[24:27]
    v_mfma_f32_16x16x32_bf16 v[24:27], a[60:63], v[96:99], v[24:27]
    s_waitcnt lgkmcnt(0)
    buffer_load_dwordx4 v1, s[4:7], s41 offen offset:3072 sc1 lds
    v_mfma_f32_16x16x32_bf16 v[20:23], a[72:75], v[132:135], v[20:23]
    s_add_u32 m0, s42, 40960
    v_mfma_f32_16x16x32_bf16 v[20:23], a[84:87], v[140:143], v[20:23]
    v_mfma_f32_16x16x32_bf16 v[20:23], a[96:99], v[148:151], v[20:23]
    v_mfma_f32_16x16x32_bf16 v[20:23], a[108:111], v[156:159], v[20:23]
    buffer_load_dwordx4 v12, s[4:7], s41 offen offset:0 sc1 lds
    v_mfma_f32_16x16x32_bf16 v[20:23], a[120:123], v[164:167], v[20:23]
    s_waitcnt vmcnt(14)
    s_barrier
    v_mfma_f32_16x16x32_bf16 v[20:23], a[132:135], v[172:175], v[20:23]
    ds_read_b128 v[180:183], v115 offset:24576
    ds_read_b128 v[188:191], v115 offset:26624
    v_mfma_f32_16x16x32_bf16 v[28:31], a[136:139], v[172:175], v[28:31]
    v_mfma_f32_16x16x32_bf16 v[28:31], a[124:127], v[164:167], v[28:31]
    ds_read_b128 v[196:199], v115 offset:28672
    ds_read_b128 v[204:207], v115 offset:30720
    v_mfma_f32_16x16x32_bf16 v[28:31], a[112:115], v[156:159], v[28:31]
    buffer_load_dwordx4 v12, s[4:7], s41 offen offset:1024 sc1 lds
    v_mfma_f32_16x16x32_bf16 v[28:31], a[100:103], v[148:151], v[28:31]
    ds_read2_b64 v[212:215], v117 offset0:0 offset1:32
    ds_read2_b64 a[220:223], v121 offset0:0 offset1:32
    v_mfma_f32_16x16x32_bf16 v[28:31], a[88:91], v[140:143], v[28:31]
    v_mfma_f32_16x16x32_bf16 v[28:31], a[76:79], v[132:135], v[28:31]
    ds_read_b128 v[136:139], v116 offset:12288
    ds_read_b128 v[144:147], v116 offset:14336
    v_mfma_f32_16x16x32_bf16 v[36:39], a[80:83], v[132:135], v[36:39]
    v_mfma_f32_16x16x32_bf16 v[36:39], a[92:95], v[140:143], v[36:39]
    ds_read_b128 v[152:155], v116 offset:16384
    ds_read_b128 v[160:163], v116 offset:18432
    v_mfma_f32_16x16x32_bf16 v[36:39], a[104:107], v[148:151], v[36:39]
    buffer_load_dwordx4 v12, s[4:7], s41 offen offset:2048 sc1 lds
    v_mfma_f32_16x16x32_bf16 v[36:39], a[116:119], v[156:159], v[36:39]
    ds_read_b128 v[168:171], v116 offset:20480
    ds_read_b128 v[176:179], v116 offset:22528
    v_mfma_f32_16x16x32_bf16 v[36:39], a[128:131], v[164:167], v[36:39]
    v_mfma_f32_16x16x32_bf16 v[36:39], a[140:143], v[172:175], v[36:39]
    s_waitcnt lgkmcnt(6)
    ds_read_b128 v[184:187], v116 offset:24576
    ds_read_b128 v[192:195], v116 offset:26624
    v_mfma_f32_16x16x32_bf16 v[20:23], a[144:147], v[180:183], v[20:23]
    buffer_load_dwordx4 v12, s[4:7], s41 offen offset:3072 sc1 lds
    v_mfma_f32_16x16x32_bf16 v[20:23], a[156:159], v[188:191], v[20:23]
    s_add_u32 m0, s42, 45056
    ds_read_b128 v[200:203], v116 offset:28672
    ds_read_b128 v[208:211], v116 offset:30720
    v_mfma_f32_16x16x32_bf16 v[20:23], a[168:171], v[196:199], v[20:23]
    v_mfma_f32_16x16x32_bf16 v[20:23], a[180:183], v[204:207], v[20:23]
    ds_read2_b64 a[216:219], v118 offset0:0 offset1:32
    ds_read2_b64 a[224:227], v122 offset0:0 offset1:32
    v_mfma_f32_16x16x32_bf16 v[20:23], a[192:195], v[212:215], v[20:23]
    buffer_load_dwordx4 v13, s[4:7], s41 offen offset:0 sc1 lds
    v_mfma_f32_16x16x32_bf16 v[20:23], a[204:207], a[220:223], v[20:23]
    s_cmp_eq_u32 s22, 0
    s_cbranch_scc1 L_inte_side_23
L_inte_side_23_back:
    v_mfma_f32_16x16x32_bf16 v[28:31], a[208:211], a[220:223], v[28:31]
    v_mfma_f32_16x16x32_bf16 v[28:31], a[196:199], v[212:215], v[28:31]
    v_mfma_f32_16x16x32_bf16 v[28:31], a[184:187], v[204:207], v[28:31]
    v_mfma_f32_16x16x32_bf16 v[28:31], a[172:175], v[196:199], v[28:31]
    v_mfma_f32_16x16x32_bf16 v[28:31], a[160:163], v[188:191], v[28:31]
    v_mfma_f32_16x16x32_bf16 v[28:31], a[148:151], v[180:183], v[28:31]
    v_cvt_pk_bf16_f32 v100, v20, v21
    v_cvt_pk_bf16_f32 v101, v22, v23
    v_mfma_f32_16x16x32_bf16 v[36:39], a[152:155], v[180:183], v[36:39]
    v_mul_f32 v128, v20, v20
    v_add_f32 v124, v20, v21
    v_mfma_f32_16x16x32_bf16 v[36:39], a[164:167], v[188:191], v[36:39]
    v_fmac_f32 v128, v21, v21
    v_add_f32 v124, v124, v22
    v_mfma_f32_16x16x32_bf16 v[36:39], a[176:179], v[196:199], v[36:39]
    v_fmac_f32 v128, v22, v22
    v_add_f32 v124, v124, v23
    v_mfma_f32_16x16x32_bf16 v[36:39], a[188:191], v[204:207], v[36:39]
    v_fmac_f32 v128, v23, v23
    v_cvt_pk_bf16_f32 v102, v28, v29
    v_mfma_f32_16x16x32_bf16 v[36:39], a[200:203], v[212:215], v[36:39]
    v_cvt_pk_bf16_f32 v103, v30, v31
    v_add_f32 v124, v124, v28
    v_mfma_f32_16x16x32_bf16 v[36:39], a[212:215], a[220:223], v[36:39]
    s_waitcnt lgkmcnt(0)
    buffer_store_dwordx4 v[100:103], v112, s[4:7], s49 offen sc1
    v_mfma_f32_16x16x32_bf16 v[32:35], a[76:79], v[136:139], v[32:35]
    v_fmac_f32 v128, v28, v28
    v_add_f32 v124, v124, v29
    v_mfma_f32_16x16x32_bf16 v[32:35], a[88:91], v[144:147], v[32:35]
    v_fmac_f32 v128, v29, v29
    v_add_f32 v124, v124, v30
    v_mfma_f32_16x16x32_bf16 v[32:35], a[100:103], v[152:155], v[32:35]
    v_fmac_f32 v128, v30, v30
    v_add_f32 v124, v124, v31
    v_mfma_f32_16x16x32_bf16 v[32:35], a[112:115], v[160:163], v[32:35]
    v_fmac_f32 v128, v31, v31
    v_cvt_pk_bf16_f32 v108, v36, v37
    v_mfma_f32_16x16x32_bf16 v[32:35], a[124:127], v[168:171], v[32:35]
    v_cvt_pk_bf16_f32 v109, v38, v39
    v_add_f32 v124, v124, v36
    v_mfma_f32_16x16x32_bf16 v[32:35], a[136:139], v[176:179], v[32:35]
    buffer_store_dwordx2 v[108:109], v114, s[4:7], s48 offen sc1
    v_mfma_f32_16x16x32_bf16 v[32:35], a[148:151], v[184:187], v[32:35]
    v_fmac_f32 v128, v36, v36
    v_add_f32 v124, v124, v37
    v_mfma_f32_16x16x32_bf16 v[32:35], a[160:163], v[192:195], v[32:35]
    v_fmac_f32 v128, v37, v37
    v_add_f32 v124, v124, v38
    v_mfma_f32_16x16x32_bf16 v[32:35], a[172:175], v[200:203], v[32:35]
    v_fmac_f32 v128, v38, v38
    v_add_f32 v124, v124, v39
    v_mfma_f32_16x16x32_bf16 v[32:35], a[184:187], v[208:211], v[32:35]
    v_fmac_f32 v128, v39, v39
    v_mfma_f32_16x16x32_bf16 v[32:35], a[196:199], a[216:219], v[32:35]
    v_mfma_f32_16x16x32_bf16 v[32:35], a[208:211], a[224:227], v[32:35]
    v_mfma_f32_16x16x32_bf16 v[24:27], a[204:207], a[224:227], v[24:27]
    v_mfma_f32_16x16x32_bf16 v[24:27], a[192:195], a[216:219], v[24:27]
    v_mfma_f32_16x16x32_bf16 v[24:27], a[180:183], v[208:211], v[24:27]
    v_mfma_f32_16x16x32_bf16 v[24:27], a[168:171], v[200:203], v[24:27]
    v_mfma_f32_16x16x32_bf16 v[24:27], a[156:159], v[192:195], v[24:27]
    v_mfma_f32_16x16x32_bf16 v[24:27], a[144:147], v[184:187], v[24:27]
    v_mfma_f32_16x16x32_bf16 v[24:27], a[132:135], v[176:179], v[24:27]
    v_mfma_f32_16x16x32_bf16 v[24:27], a[120:123], v[168:171], v[24:27]
    v_cvt_pk_bf16_f32 v106, v32, v33
    v_cvt_pk_bf16_f32 v107, v34, v35
    v_mfma_f32_16x16x32_bf16 v[24:27], a[108:111], v[160:163], v[24:27]
    v_mul_f32 v130, v32, v32
    v_add_f32 v126, v32, v33
    v_mfma_f32_16x16x32_bf16 v[24:27], a[96:99], v[152:155], v[24:27]
    v_fmac_f32 v130, v33, v33
    v_add_f32 v126, v126, v34
    v_mfma_f32_16x16x32_bf16 v[24:27], a[84:87], v[144:147], v[24:27]
    v_fmac_f32 v130, v34, v34
    v_add_f32 v126, v126, v35
    v_mfma_f32_16x16x32_bf16 v[24:27], a[72:75], v[136:139], v[24:27]
    v_fmac_f32 v130, v35, v35
    s_nop 6
    v_cvt_pk_bf16_f32 v104, v24, v25
    v_cvt_pk_bf16_f32 v105, v26, v27
    buffer_store_dwordx4 v[104:107], v113, s[4:7], s49 offen sc1
    v_add_f32 v126, v126, v24
    v_fmac_f32 v130, v24, v24
    v_add_f32 v126, v126, v25
    v_fmac_f32 v130, v25, v25
    v_add_f32 v126, v126, v26
    v_fmac_f32 v130, v26, v26
    v_add_f32 v126, v126, v27
    v_fmac_f32 v130, v27, v27
    s_nop 0
    v_permlane16_swap_b32 v124, v126
    v_permlane16_swap_b32 v128, v130
    v_add_f32 v124, v124, v126
    v_add_f32 v128, v128, v130
    s_nop 1
    v_permlane32_swap_b32 v124, v128
    v_add_f32 v124, v124, v128
    buffer_store_dword v124, v120, s[4:7], s50 offen sc1
    s_add_u32 m0, s42, 73728
    s_add_u32 s41, s41, 36864
    buffer_load_dwordx4 v1, s[4:7], s41 offen offset:0 sc1 lds
    buffer_load_dwordx4 v1, s[4:7], s41 offen offset:1024 sc1 lds
    buffer_load_dwordx4 v1, s[4:7], s41 offen offset:2048 sc1 lds
    buffer_load_dwordx4 v1, s[4:7], s41 offen offset:3072 sc1 lds
    s_add_u32 m0, s42, 77824
    s_nop 0
    buffer_load_dwordx4 v12, s[4:7], s41 offen offset:0 sc1 lds
    buffer_load_dwordx4 v12, s[4:7], s41 offen offset:1024 sc1 lds
    buffer_load_dwordx4 v12, s[4:7], s41 offen offset:2048 sc1 lds
    buffer_load_dwordx4 v12, s[4:7], s41 offen offset:3072 sc1 lds
    s_add_u32 m0, s42, 81920
    s_nop 0
    buffer_load_dwordx4 v13, s[4:7], s41 offen offset:0 sc1 lds
    s_waitcnt vmcnt(9)
    s_barrier
    buffer_atomic_add v10, v6, s[4:7], s28 offen offset:4 sc1
    buffer_load_dword v15, v4, s[80:83], s79 offen offset:0
    buffer_load_dword v15, v4, s[80:83], s79 offen offset:256
    s_cmp_eq_u32 s22, 0
    s_cbranch_scc1 L_inte_side_24
L_inte_side_24_back:
    s_mul_i32 s52, s23, 36864
    s_add_u32 s52, s52, s21
    s_add_u32 s52, s52, 20840448
    s_lshl_b32 s31, s19, 13
    s_add_u32 s53, s52, s31
    s_lshl_b32 s31, s18, 11
    s_add_u32 s54, s53, s31
    s_lshl_b32 s32, s23, 12
    s_add_u32 s32, s32, s21
    s_add_u32 s32, s32, 23199744
    s_mul_i32 s33, s23, 294912
    s_add_u32 s33, s33, s21
    s_add_u32 s33, s33, 23461888
    s_add_u32 s34, s19, 0
    s_and_b32 s34, s34, 3
    s_lshl_b32 s35, s18, 2
    s_add_u32 s34, s34, s35
    s_mul_i32 s34, s34, 18432
    s_add_u32 s44, s33, s34
    s_add_u32 s48, s44, 12288
    s_add_u32 s34, s19, 1
    s_and_b32 s34, s34, 3
    s_lshl_b32 s35, s18, 2
    s_add_u32 s34, s34, s35
    s_mul_i32 s34, s34, 18432
    s_add_u32 s45, s33, s34
    s_add_u32 s49, s45, 12288
    s_add_u32 s34, s19, 2
    s_and_b32 s34, s34, 3
    s_lshl_b32 s35, s18, 2
    s_add_u32 s34, s34, s35
    s_mul_i32 s34, s34, 18432
    s_add_u32 s46, s33, s34
    s_add_u32 s50, s46, 12288
    s_add_u32 s34, s19, 3
    s_and_b32 s34, s34, 3
    s_lshl_b32 s35, s18, 2
    s_add_u32 s34, s34, s35
    s_mul_i32 s34, s34, 18432
    s_add_u32 s47, s33, s34
    s_add_u32 s51, s47, 12288
    v_and_b32 v182, 15, v0
    v_lshrrev_b32 v183, 5, v0
    v_lshlrev_b32 v16, 9, v183
    v_lshl_add_u32 v16, v182, 4, v16
    v_bfe_u32 v183, v0, 4, 1
    v_lshl_add_u32 v16, v183, 3, v16
    s_cmp_eq_u32 s20, s18
    s_cselect_b32 s35, 0, 2147483648
    s_or_b32 s34, s35, s15
    v_or_b32 v17, s34, v16
    v_or_b32 v19, s35, v1
    v_xor_b32 v18, 2147483648, v19
    s_lshl_b32 s36, s22, 31
    v_or_b32 v183, s36, v1
    ds_read_b128 v[140:143], v1 offset:0
    ds_read_b128 v[144:147], v1 offset:36864
    ds_read_b128 v[148:151], v1 offset:1024
    ds_read_b128 v[152:155], v1 offset:37888
    ds_read_b128 v[156:159], v1 offset:2048
    ds_read_b128 v[160:163], v1 offset:38912
    ds_read_b128 a[224:227], v1 offset:3072
    ds_read_b128 a[228:231], v1 offset:39936
    ds_read_b128 a[232:235], v1 offset:4096
    ds_read_b128 a[236:239], v1 offset:40960
    ds_read_b128 a[240:243], v1 offset:5120
    ds_read_b128 a[244:247], v1 offset:41984
    ds_read_b128 a[248:251], v1 offset:6144
    ds_read_b128 a[252:255], v1 offset:43008
    s_waitcnt vmcnt(3)
    s_cmp_lg_u32 s20, 0
    s_cbranch_scc1 L_inte_np_26
L_inte_poll_27:
    s_load_dword s57, s[12:13], 4 glc
    s_waitcnt lgkmcnt(0)
    s_cmp_ge_u32 s57, 16
    s_cbranch_scc1 L_inte_poll_27_x
    s_sub_u32 s27, s27, 1
    s_cmp_gt_i32 s27, 0
    s_cbranch_scc1 L_inte_poll_27
L_inte_poll_27_x:
L_inte_np_26:
    s_barrier
    buffer_load_dwordx4 a[0:3], v1, s[4:7], s52 offen offset:0 sc1
    buffer_load_dwordx4 a[4:7], v1, s[4:7], s52 offen offset:1024 sc1
    buffer_load_dwordx4 a[8:11], v1, s[4:7], s52 offen offset:2048 sc1
    buffer_load_dwordx4 a[12:15], v1, s[4:7], s52 offen offset:3072 sc1
    buffer_load_dwordx4 a[16:19], v12, s[4:7], s52 offen offset:0 sc1
    buffer_load_dwordx4 a[20:23], v12, s[4:7], s52 offen offset:1024 sc1
    buffer_load_dwordx4 a[24:27], v12, s[4:7], s52 offen offset:2048 sc1
    buffer_load_dwordx4 a[28:31], v12, s[4:7], s52 offen offset:3072 sc1
    s_waitcnt lgkmcnt(7)
    s_waitcnt vmcnt(6)
    v_mfma_f32_32x32x16_bf16 v[92:107], v[140:143], a[0:3], 0
    buffer_load_dwordx4 a[32:35], v13, s[4:7], s52 offen offset:0 sc1
    buffer_load_dwordx4 a[36:39], v13, s[4:7], s52 offen offset:1024 sc1
    ds_read_b128 v[140:143], v1 offset:7168
    v_mfma_f32_32x32x16_bf16 v[108:123], v[144:147], a[0:3], 0
    buffer_load_dwordx4 a[40:43], v13, s[4:7], s52 offen offset:2048 sc1
    buffer_load_dwordx4 a[44:47], v13, s[4:7], s52 offen offset:3072 sc1
    ds_read_b128 v[144:147], v1 offset:44032
    s_add_u32 s52, s52, 12288
    v_mfma_f32_32x32x16_bf16 v[92:107], v[148:151], a[4:7], v[92:107]
    ds_read_b128 v[148:151], v1 offset:8192
    v_mfma_f32_32x32x16_bf16 v[108:123], v[152:155], a[4:7], v[108:123]
    s_waitcnt vmcnt(8)
    buffer_load_dwordx4 a[48:51], v1, s[4:7], s52 offen offset:0 sc1
    ds_read_b128 v[152:155], v1 offset:45056
    v_mfma_f32_32x32x16_bf16 v[92:107], v[156:159], a[8:11], v[92:107]
    buffer_load_dwordx4 a[52:55], v1, s[4:7], s52 offen offset:1024 sc1
    ds_read_b128 v[156:159], v1 offset:9216
    v_mfma_f32_32x32x16_bf16 v[108:123], v[160:163], a[8:11], v[108:123]
    ds_read_b128 v[160:163], v1 offset:46080
    v_mfma_f32_32x32x16_bf16 v[92:107], a[224:227], a[12:15], v[92:107]
    s_waitcnt lgkmcnt(6)
    buffer_load_dwordx4 a[56:59], v1, s[4:7], s52 offen offset:2048 sc1
    ds_read_b128 a[224:227], v1 offset:10240
    v_mfma_f32_32x32x16_bf16 v[108:123], a[228:231], a[12:15], v[108:123]
    s_waitcnt vmcnt(9)
    ds_read_b128 a[228:231], v1 offset:47104
    v_mfma_f32_32x32x16_bf16 v[92:107], a[232:235], a[16:19], v[92:107]
    buffer_load_dwordx4 a[60:63], v1, s[4:7], s52 offen offset:3072 sc1
    ds_read_b128 a[232:235], v1 offset:11264
    v_mfma_f32_32x32x16_bf16 v[108:123], a[236:239], a[16:19], v[108:123]
    ds_read_b128 a[236:239], v1 offset:48128
    v_mfma_f32_32x32x16_bf16 v[92:107], a[240:243], a[20:23], v[92:107]
    buffer_load_dwordx4 a[64:67], v12, s[4:7], s52 offen offset:0 sc1
    ds_read_b128 a[240:243], v1 offset:12288
    v_mfma_f32_32x32x16_bf16 v[108:123], a[244:247], a[20:23], v[108:123]
    s_waitcnt vmcnt(9)
    ds_read_b128 a[244:247], v1 offset:49152
    v_mfma_f32_32x32x16_bf16 v[92:107], a[248:251], a[24:27], v[92:107]
    buffer_load_dwordx4 a[68:71], v12, s[4:7], s52 offen offset:1024 sc1
    ds_read_b128 a[248:251], v1 offset:13312
    v_mfma_f32_32x32x16_bf16 v[108:123], a[252:255], a[24:27], v[108:123]
    s_waitcnt lgkmcnt(6)
    ds_read_b128 a[252:255], v1 offset:50176
    v_mfma_f32_32x32x16_bf16 v[92:107], v[140:143], a[28:31], v[92:107]
    buffer_load_dwordx4 a[72:75], v12, s[4:7], s52 offen offset:2048 sc1
    ds_read_b128 v[140:143], v1 offset:14336
    v_mfma_f32_32x32x16_bf16 v[108:123], v[144:147], a[28:31], v[108:123]
    s_waitcnt vmcnt(9)
    ds_read_b128 v[144:147], v1 offset:51200
    v_mfma_f32_32x32x16_bf16 v[92:107], v[148:151], a[32:35], v[92:107]
    buffer_load_dwordx4 a[76:79], v12, s[4:7], s52 offen offset:3072 sc1
    buffer_load_dword v20, v4, s[4:7], s32 offen offset:0 sc1
    ds_read_b128 v[148:151], v1 offset:15360
    v_mfma_f32_32x32x16_bf16 v[108:123], v[152:155], a[32:35], v[108:123]
    buffer_load_dword v21, v4, s[4:7], s32 offen offset:256 sc1
    buffer_load_dword v22, v4, s[4:7], s32 offen offset:512 sc1
    ds_read_b128 v[152:155], v1 offset:52224
    v_mfma_f32_32x32x16_bf16 v[92:107], v[156:159], a[36:39], v[92:107]
    buffer_load_dword v23, v4, s[4:7], s32 offen offset:768 sc1
    buffer_load_dword v24, v4, s[4:7], s32 offen offset:1024 sc1
    ds_read_b128 v[156:159], v1 offset:16384
    v_mfma_f32_32x32x16_bf16 v[108:123], v[160:163], a[36:39], v[108:123]
    s_waitcnt vmcnt(13)
    buffer_load_dword v25, v4, s[4:7], s32 offen offset:1280 sc1
    buffer_load_dword v26, v4, s[4:7], s32 offen offset:1536 sc1
    ds_read_b128 v[160:163], v1 offset:53248
    v_mfma_f32_32x32x16_bf16 v[92:107], a[224:227], a[40:43], v[92:107]
    s_waitcnt lgkmcnt(6)
    buffer_load_dword v27, v4, s[4:7], s32 offen offset:1792 sc1
    buffer_load_dword v28, v4, s[4:7], s32 offen offset:2048 sc1
    ds_read_b128 a[224:227], v1 offset:17408
    v_mfma_f32_32x32x16_bf16 v[108:123], a[228:231], a[40:43], v[108:123]
    buffer_load_dword v29, v4, s[4:7], s32 offen offset:2304 sc1
    buffer_load_dword v30, v4, s[4:7], s32 offen offset:2560 sc1
    ds_read_b128 a[228:231], v1 offset:54272
    v_mfma_f32_32x32x16_bf16 v[92:107], a[232:235], a[44:47], v[92:107]
    buffer_load_dword v31, v4, s[4:7], s32 offen offset:2816 sc1
    buffer_load_dword v32, v4, s[4:7], s32 offen offset:3072 sc1
    ds_read_b128 a[232:235], v1 offset:18432
    v_mfma_f32_32x32x16_bf16 v[108:123], a[236:239], a[44:47], v[108:123]
    s_waitcnt vmcnt(19)
    buffer_load_dword v33, v4, s[4:7], s32 offen offset:3328 sc1
    buffer_load_dword v34, v4, s[4:7], s32 offen offset:3584 sc1
    ds_read_b128 a[236:239], v1 offset:55296
    v_mfma_f32_32x32x16_bf16 v[92:107], a[240:243], a[48:51], v[92:107]
    buffer_load_dword v35, v4, s[4:7], s32 offen offset:3840 sc1
    buffer_load_dwordx4 a[80:83], v13, s[4:7], s52 offen offset:0 sc1
    ds_read_b128 a[240:243], v1 offset:19456
    v_mfma_f32_32x32x16_bf16 v[108:123], a[244:247], a[48:51], v[108:123]
    buffer_load_dwordx4 a[84:87], v13, s[4:7], s52 offen offset:1024 sc1
    ds_read_b128 a[244:247], v1 offset:56320
    v_mfma_f32_32x32x16_bf16 v[92:107], a[248:251], a[52:55], v[92:107]
    buffer_load_dwordx4 a[88:91], v13, s[4:7], s52 offen offset:2048 sc1
    ds_read_b128 a[248:251], v1 offset:20480
    v_mfma_f32_32x32x16_bf16 v[108:123], a[252:255], a[52:55], v[108:123]
    s_waitcnt lgkmcnt(6)
    s_waitcnt vmcnt(23)
    ds_read_b128 a[252:255], v1 offset:57344
    v_mfma_f32_32x32x16_bf16 v[92:107], v[140:143], a[56:59], v[92:107]
    buffer_load_dwordx4 a[92:95], v13, s[4:7], s52 offen offset:3072 sc1
    ds_read_b128 v[140:143], v1 offset:21504
    s_add_u32 s52, s52, 12288
    v_mfma_f32_32x32x16_bf16 v[108:123], v[144:147], a[56:59], v[108:123]
    ds_read_b128 v[144:147], v1 offset:58368
    v_mfma_f32_32x32x16_bf16 v[92:107], v[148:151], a[60:63], v[92:107]
    buffer_load_dwordx4 a[96:99], v1, s[4:7], s52 offen offset:0 sc1
    ds_read_b128 v[148:151], v1 offset:22528
    v_mfma_f32_32x32x16_bf16 v[108:123], v[152:155], a[60:63], v[108:123]
    s_waitcnt vmcnt(23)
    ds_read_b128 v[152:155], v1 offset:59392
    v_mfma_f32_32x32x16_bf16 v[92:107], v[156:159], a[64:67], v[92:107]
    buffer_load_dwordx4 a[100:103], v1, s[4:7], s52 offen offset:1024 sc1
    ds_read_b128 v[156:159], v1 offset:23552
    v_mfma_f32_32x32x16_bf16 v[108:123], v[160:163], a[64:67], v[108:123]
    ds_read_b128 v[160:163], v1 offset:60416
    v_mfma_f32_32x32x16_bf16 v[92:107], a[224:227], a[68:71], v[92:107]
    s_waitcnt lgkmcnt(6)
    buffer_load_dwordx4 a[104:107], v1, s[4:7], s52 offen offset:2048 sc1
    ds_read_b128 a[224:227], v1 offset:24576
    v_mfma_f32_32x32x16_bf16 v[108:123], a[228:231], a[68:71], v[108:123]
    s_waitcnt vmcnt(23)
    ds_read_b128 a[228:231], v1 offset:61440
    v_mfma_f32_32x32x16_bf16 v[92:107], a[232:235], a[72:75], v[92:107]
    buffer_load_dwordx4 a[108:111], v1, s[4:7], s52 offen offset:3072 sc1
    buffer_load_dwordx4 a[112:115], v12, s[4:7], s52 offen offset:0 sc1
    ds_read_b128 a[232:235], v1 offset:25600
    v_mfma_f32_32x32x16_bf16 v[108:123], a[236:239], a[72:75], v[108:123]
    ds_read_b128 a[236:239], v1 offset:62464
    v_mfma_f32_32x32x16_bf16 v[92:107], a[240:243], a[76:79], v[92:107]
    ds_read_b128 a[240:243], v1 offset:26624
    v_mfma_f32_32x32x16_bf16 v[108:123], a[244:247], a[76:79], v[108:123]
    s_waitcnt vmcnt(7)
    buffer_load_dwordx4 a[116:119], v12, s[4:7], s52 offen offset:1024 sc1
    ds_read_b128 a[244:247], v1 offset:63488
    v_mfma_f32_32x32x16_bf16 v[92:107], a[248:251], a[80:83], v[92:107]
    buffer_load_dwordx4 a[120:123], v12, s[4:7], s52 offen offset:2048 sc1
    buffer_load_dwordx4 a[124:127], v12, s[4:7], s52 offen offset:3072 sc1
    ds_read_b128 a[248:251], v1 offset:27648
    v_add_f32 v20, v20, v22
    v_mfma_f32_32x32x16_bf16 v[108:123], a[252:255], a[80:83], v[108:123]
    s_waitcnt lgkmcnt(6)
    buffer_load_dwordx4 a[128:131], v13, s[4:7], s52 offen offset:0 sc1
    buffer_load_dwordx4 a[132:135], v13, s[4:7], s52 offen offset:1024 sc1
    ds_read_b128 a[252:255], v1 offset:64512
    v_mfma_f32_32x32x16_bf16 v[92:107], v[140:143], a[84:87], v[92:107]
    ds_read_b128 v[140:143], v1 offset:28672
    v_add_f32 v21, v21, v23
    v_add_f32 v20, v20, v24
    v_add_f32 v21, v21, v25
    v_add_f32 v20, v20, v26
    v_add_f32 v21, v21, v27
    v_mfma_f32_32x32x16_bf16 v[108:123], v[144:147], a[84:87], v[108:123]
    s_waitcnt vmcnt(10)
    buffer_load_dwordx4 a[136:139], v13, s[4:7], s52 offen offset:2048 sc1
    ds_read_b128 v[144:147], v2 offset:0
    v_add_f32 v20, v20, v28
    v_add_f32 v21, v21, v29
    v_mfma_f32_32x32x16_bf16 v[92:107], v[148:151], a[88:91], v[92:107]
    buffer_load_dwordx4 a[140:143], v13, s[4:7], s52 offen offset:3072 sc1
    ds_read_b128 v[148:151], v1 offset:29696
    s_add_u32 m0, s42, 110592
    s_add_u32 s41, s41, 36864
    v_add_f32 v20, v20, v30
    v_mfma_f32_32x32x16_bf16 v[108:123], v[152:155], a[88:91], v[108:123]
    ds_read_b128 v[152:155], v2 offset:1024
    v_add_f32 v21, v21, v31
    v_add_f32 v20, v20, v32
    v_add_f32 v21, v21, v33
    v_add_f32 v20, v20, v34
    v_add_f32 v21, v21, v35
    v_mfma_f32_32x32x16_bf16 v[92:107], v[156:159], a[92:95], v[92:107]
    ds_read_b128 v[156:159], v1 offset:30720
    v_add_f32 v20, v20, v21
    v_mov_b32 v21, v20
    v_mfma_f32_32x32x16_bf16 v[108:123], v[160:163], a[92:95], v[108:123]
    s_waitcnt vmcnt(10)
    buffer_load_dwordx4 v1, s[4:7], s41 offen offset:0 sc1 lds
    ds_read_b128 v[160:163], v2 offset:2048
    v_permlane32_swap_b32 v20, v21
    v_mfma_f32_32x32x16_bf16 v[92:107], a[224:227], a[96:99], v[92:107]
    s_waitcnt lgkmcnt(6)
    buffer_load_dwordx4 v1, s[4:7], s41 offen offset:1024 sc1 lds
    ds_read_b128 a[224:227], v1 offset:31744
    v_mul_f32 v22, 0x3ae38e39, v20
    v_mul_f32 v21, 0x3ae38e39, v21
    v_mfma_f32_32x32x16_bf16 v[108:123], a[228:231], a[96:99], v[108:123]
    ds_read_b128 a[228:231], v2 offset:3072
    v_fma_f32 v21, -v22, v22, v21
    v_max_f32 v21, 0, v21
    v_add_f32 v21, 0x3727c5ac, v21
    v_rsq_f32 v176, v21
    v_mfma_f32_32x32x16_bf16 v[92:107], a[232:235], a[100:103], v[92:107]
    ds_read_b128 a[232:235], v1 offset:32768
    v_mul_f32 v21, v21, v176
    v_mul_f32 v176, 0x3fb8aa3b, v176
    v_cvt_pk_bf16_f32 v173, -v22, v21
    v_lshlrev_b32 v24, 16, v173
    v_and_b32 v25, 0xffff0000, v173
    v_mfma_f32_32x32x16_bf16 v[108:123], a[236:239], a[100:103], v[108:123]
    s_waitcnt vmcnt(10)
    buffer_load_dwordx4 v1, s[4:7], s41 offen offset:2048 sc1 lds
    ds_read_b128 a[236:239], v2 offset:4096
    v_sub_f32 v26, -v22, v24
    v_sub_f32 v27, v21, v25
    v_mfma_f32_32x32x16_bf16 v[92:107], a[240:243], a[104:107], v[92:107]
    buffer_load_dwordx4 v1, s[4:7], s41 offen offset:3072 sc1 lds
    ds_read_b128 a[240:243], v1 offset:33792
    s_add_u32 m0, s42, 114688
    v_cvt_pk_bf16_f32 v172, v24, v26
    v_cvt_pk_bf16_f32 v174, v24, v26
    v_mfma_f32_32x32x16_bf16 v[108:123], a[244:247], a[104:107], v[108:123]
    ds_read_b128 a[244:247], v2 offset:5120
    v_cvt_pk_bf16_f32 v175, v24, v27
    v_mfma_f32_32x32x16_bf16 v[92:107], a[248:251], a[108:111], v[92:107]
    ds_read_b128 a[248:251], v1 offset:34816
    v_mfma_f32_32x32x16_bf16 v[108:123], a[252:255], a[108:111], v[108:123]
    s_waitcnt lgkmcnt(6)
    s_waitcnt vmcnt(10)
    buffer_load_dwordx4 v12, s[4:7], s41 offen offset:0 sc1 lds
    ds_read_b128 a[252:255], v2 offset:6144
    v_mfma_f32_32x32x16_bf16 v[92:107], v[140:143], a[112:115], v[92:107]
    buffer_load_dwordx4 v12, s[4:7], s41 offen offset:1024 sc1 lds
    ds_read_b128 v[140:143], v1 offset:35840
    v_mfma_f32_32x32x16_bf16 v[108:123], v[144:147], a[112:115], v[108:123]
    ds_read_b128 v[144:147], v2 offset:7168
    v_mfma_f32_32x32x16_bf16 v[92:107], v[148:151], a[116:119], v[92:107]
    ds_read_b128 v[148:151], v3 offset:16384
    v_mfma_f32_32x32x16_bf16 v[108:123], v[152:155], a[116:119], v[108:123]
    s_waitcnt vmcnt(10)
    buffer_load_dwordx4 v12, s[4:7], s41 offen offset:2048 sc1 lds
    ds_read_b128 v[152:155], v3 offset:17408
    v_mfma_f32_32x32x16_bf16 v[92:107], v[156:159], a[120:123], v[92:107]
    buffer_load_dwordx4 v12, s[4:7], s41 offen offset:3072 sc1 lds
    ds_read_b128 v[156:159], v3 offset:18432
    s_add_u32 m0, s42, 118784
    v_mfma_f32_32x32x16_bf16 v[108:123], v[160:163], a[120:123], v[108:123]
    buffer_load_dwordx4 v13, s[4:7], s41 offen offset:0 sc1 lds
    ds_read_b128 v[160:163], v2 offset:8192
    v_mfma_f32_32x32x16_bf16 v[92:107], a[224:227], a[124:127], v[92:107]
    s_waitcnt lgkmcnt(6)
    ds_read_b128 a[224:227], v2 offset:9216
    v_mfma_f32_32x32x16_bf16 v[108:123], a[228:231], a[124:127], v[108:123]
    s_waitcnt vmcnt(11)
    ds_read_b128 a[228:231], v2 offset:10240
    v_mfma_f32_32x32x16_bf16 v[92:107], a[232:235], a[128:131], v[92:107]
    ds_read_b128 a[232:235], v2 offset:11264
    v_mfma_f32_32x32x16_bf16 v[108:123], a[236:239], a[128:131], v[108:123]
    ds_read_b128 a[236:239], v2 offset:12288
    v_mfma_f32_32x32x16_bf16 v[92:107], a[240:243], a[132:135], v[92:107]
    ds_read_b128 a[240:243], v2 offset:13312
    v_mfma_f32_32x32x16_bf16 v[108:123], a[244:247], a[132:135], v[108:123]
    s_waitcnt vmcnt(9)
    ds_read_b128 a[244:247], v2 offset:14336
    v_mfma_f32_32x32x16_bf16 v[92:107], a[248:251], a[136:139], v[92:107]
    ds_read_b128 a[248:251], v2 offset:15360
    v_mfma_f32_32x32x16_bf16 v[108:123], a[252:255], a[136:139], v[108:123]
    s_waitcnt lgkmcnt(6)
    ds_read_b128 a[252:255], v2 offset:16384
    v_mfma_f32_32x32x16_bf16 v[92:107], v[140:143], a[140:143], v[92:107]
    ds_read_b128 v[140:143], v2 offset:17408
    v_mfma_f32_32x32x16_bf16 v[108:123], v[144:147], a[140:143], v[108:123]
    s_barrier
    ds_read_b128 v[144:147], v2 offset:18432
    s_add_u32 m0, s42, 0
    s_add_u32 s41, s41, 36864
    v_mfma_f32_32x32x16_bf16 v[92:107], v[148:151], v[172:175], v[92:107]
    s_cmp_eq_u32 s22, 0
    s_cbranch_scc1 L_inte_side_34
L_inte_side_34_back:
    ds_read_b128 v[148:151], v2 offset:19456
    v_mfma_f32_32x32x16_bf16 v[108:123], v[152:155], v[172:175], v[108:123]
    buffer_load_dwordx4 v1, s[4:7], s41 offen offset:0 sc1 lds
    buffer_load_dwordx4 v1, s[4:7], s41 offen offset:1024 sc1 lds
    ds_read_b128 v[152:155], v2 offset:20480
    v_mfma_f32_32x32x16_bf16 v[124:139], v[156:159], v[172:175], 0
    ds_read_b128 v[156:159], v2 offset:21504
    v_mfma_f32_32x32x16_bf16 v[124:139], v[160:163], a[0:3], v[124:139]
    buffer_load_dwordx4 v1, s[4:7], s41 offen offset:2048 sc1 lds
    ds_read_b128 v[160:163], v2 offset:22528
    v_mul_f32 v92, v92, v176
    v_mul_f32 v93, v93, v176
    v_mul_f32 v94, v94, v176
    v_mfma_f32_32x32x16_bf16 v[124:139], a[224:227], a[4:7], v[124:139]
    s_waitcnt lgkmcnt(6)
    ds_read_b128 a[224:227], v2 offset:23552
    v_exp_f32 v178, v92
    v_exp_f32 v179, v93
    v_mul_f32 v95, v95, v176
    v_mfma_f32_32x32x16_bf16 v[124:139], a[228:231], a[8:11], v[124:139]
    ds_read_b128 a[228:231], v2 offset:24576
    v_fma_f32 v180, v178, 0.5, 1.0
    v_fma_f32 v181, v179, 0.5, 1.0
    v_fma_f32 v180, v178, v180, 1.0
    v_fma_f32 v181, v179, v181, 1.0
    v_rcp_f32 v180, v180
    v_mfma_f32_32x32x16_bf16 v[124:139], a[232:235], a[12:15], v[124:139]
    buffer_load_dwordx4 v1, s[4:7], s41 offen offset:3072 sc1 lds
    ds_read_b128 a[232:235], v2 offset:25600
    s_add_u32 m0, s42, 4096
    v_rcp_f32 v181, v181
    v_fma_f32 v92, -v92, v180, v92
    v_mfma_f32_32x32x16_bf16 v[124:139], a[236:239], a[16:19], v[124:139]
    ds_read_b128 a[236:239], v2 offset:26624
    v_fma_f32 v93, -v93, v181, v93
    v_exp_f32 v164, v94
    v_cvt_pk_bf16_f32 v20, v92, v93
    v_exp_f32 v165, v95
    v_mfma_f32_32x32x16_bf16 v[124:139], a[240:243], a[20:23], v[124:139]
    ds_read_b128 a[240:243], v2 offset:27648
    v_fma_f32 v166, v164, 0.5, 1.0
    v_fma_f32 v167, v165, 0.5, 1.0
    v_fma_f32 v166, v164, v166, 1.0
    v_fma_f32 v167, v165, v167, 1.0
    v_mul_f32 v96, v96, v176
    v_mfma_f32_32x32x16_bf16 v[124:139], a[244:247], a[24:27], v[124:139]
    buffer_load_dwordx4 v12, s[4:7], s41 offen offset:0 sc1 lds
    ds_read_b128 a[244:247], v2 offset:28672
    v_rcp_f32 v166, v166
    v_rcp_f32 v167, v167
    v_mfma_f32_32x32x16_bf16 v[124:139], a[248:251], a[28:31], v[124:139]
    ds_read_b128 a[248:251], v2 offset:29696
    v_fma_f32 v94, -v94, v166, v94
    v_fma_f32 v95, -v95, v167, v95
    v_mul_f32 v97, v97, v176
    v_cvt_pk_bf16_f32 v21, v94, v95
    v_exp_f32 v168, v96
    v_mfma_f32_32x32x16_bf16 v[124:139], a[252:255], a[32:35], v[124:139]
    s_waitcnt lgkmcnt(6)
    buffer_load_dwordx4 v12, s[4:7], s41 offen offset:1024 sc1 lds
    ds_read_b128 a[252:255], v2 offset:30720
    v_exp_f32 v169, v97
    v_mfma_f32_32x32x16_bf16 v[124:139], v[140:143], a[36:39], v[124:139]
    ds_read_b128 v[140:143], v2 offset:31744
    v_fma_f32 v170, v168, 0.5, 1.0
    v_fma_f32 v171, v169, 0.5, 1.0
    v_fma_f32 v170, v168, v170, 1.0
    v_fma_f32 v171, v169, v171, 1.0
    v_rcp_f32 v170, v170
    v_mfma_f32_32x32x16_bf16 v[124:139], v[144:147], a[40:43], v[124:139]
    ds_read_b128 v[144:147], v2 offset:32768
    v_rcp_f32 v171, v171
    v_fma_f32 v96, -v96, v170, v96
    v_mul_f32 v98, v98, v176
    v_fma_f32 v97, -v97, v171, v97
    v_mul_f32 v99, v99, v176
    v_mfma_f32_32x32x16_bf16 v[124:139], v[148:151], a[44:47], v[124:139]
    buffer_load_dwordx4 v12, s[4:7], s41 offen offset:2048 sc1 lds
    ds_read_b128 v[148:151], v2 offset:33792
    v_cvt_pk_bf16_f32 v22, v96, v97
    v_exp_f32 v178, v98
    v_mul_f32 v100, v100, v176
    v_mfma_f32_32x32x16_bf16 v[124:139], v[152:155], a[48:51], v[124:139]
    ds_read_b128 v[152:155], v2 offset:34816
    v_exp_f32 v179, v99
    v_fma_f32 v180, v178, 0.5, 1.0
    v_mul_f32 v101, v101, v176
    v_fma_f32 v181, v179, 0.5, 1.0
    v_mfma_f32_32x32x16_bf16 v[124:139], v[156:159], a[52:55], v[124:139]
    buffer_load_dwordx4 v12, s[4:7], s41 offen offset:3072 sc1 lds
    ds_read_b128 v[156:159], v2 offset:35840
    s_add_u32 m0, s42, 8192
    v_fma_f32 v180, v178, v180, 1.0
    v_fma_f32 v181, v179, v181, 1.0
    v_mul_f32 v102, v102, v176
    v_mfma_f32_32x32x16_bf16 v[124:139], v[160:163], a[56:59], v[124:139]
    ds_read_b128 v[160:163], v2 offset:36864
    v_rcp_f32 v180, v180
    v_rcp_f32 v181, v181
    v_exp_f32 v164, v100
    v_mfma_f32_32x32x16_bf16 v[124:139], a[224:227], a[60:63], v[124:139]
    s_waitcnt lgkmcnt(6)
    ds_read_b128 a[224:227], v2 offset:37888
    v_fma_f32 v98, -v98, v180, v98
    v_fma_f32 v99, -v99, v181, v99
    v_exp_f32 v165, v101
    v_cvt_pk_bf16_f32 v23, v98, v99
    v_mfma_f32_32x32x16_bf16 v[124:139], a[228:231], a[64:67], v[124:139]
    buffer_load_dwordx4 v13, s[4:7], s41 offen offset:0 sc1 lds
    ds_read_b128 a[228:231], v2 offset:38912
    s_add_u32 m0, s42, 36864
    s_add_u32 s41, s41, 36864
    v_fma_f32 v166, v164, 0.5, 1.0
    v_fma_f32 v167, v165, 0.5, 1.0
    v_mfma_f32_32x32x16_bf16 v[124:139], a[232:235], a[68:71], v[124:139]
    ds_read_b128 a[232:235], v2 offset:39936
    v_fma_f32 v166, v164, v166, 1.0
    v_fma_f32 v167, v165, v167, 1.0
    v_rcp_f32 v166, v166
    v_rcp_f32 v167, v167
    v_mfma_f32_32x32x16_bf16 v[124:139], a[236:239], a[72:75], v[124:139]
    buffer_load_dwordx4 v1, s[4:7], s41 offen offset:0 sc1 lds
    ds_read_b128 a[236:239], v2 offset:40960
    v_fma_f32 v100, -v100, v166, v100
    v_fma_f32 v101, -v101, v167, v101
    v_mul_f32 v103, v103, v176
    v_mfma_f32_32x32x16_bf16 v[124:139], a[240:243], a[76:79], v[124:139]
    ds_read_b128 a[240:243], v2 offset:41984
    v_cvt_pk_bf16_f32 v24, v100, v101
    v_exp_f32 v168, v102
    v_exp_f32 v169, v103
    v_mul_f32 v104, v104, v176
    v_mfma_f32_32x32x16_bf16 v[124:139], a[244:247], a[80:83], v[124:139]
    ds_read_b128 a[244:247], v2 offset:43008
    v_fma_f32 v170, v168, 0.5, 1.0
    v_fma_f32 v171, v169, 0.5, 1.0
    v_fma_f32 v170, v168, v170, 1.0
    v_fma_f32 v171, v169, v171, 1.0
    v_rcp_f32 v170, v170
    v_mfma_f32_32x32x16_bf16 v[124:139], a[248:251], a[84:87], v[124:139]
    buffer_load_dwordx4 v1, s[4:7], s41 offen offset:1024 sc1 lds
    ds_read_b128 a[248:251], v2 offset:44032
    v_rcp_f32 v171, v171
    v_fma_f32 v102, -v102, v170, v102
    v_mul_f32 v105, v105, v176
    v_mfma_f32_32x32x16_bf16 v[124:139], a[252:255], a[88:91], v[124:139]
    s_waitcnt lgkmcnt(6)
    ds_read_b128 a[252:255], v3 offset:19456
    v_fma_f32 v103, -v103, v171, v103
    v_exp_f32 v178, v104
    v_cvt_pk_bf16_f32 v25, v102, v103
    v_mul_f32 v106, v106, v176
    v_mfma_f32_32x32x16_bf16 v[124:139], v[140:143], a[92:95], v[124:139]
    s_waitcnt vmcnt(11)
    s_barrier
    ds_read_b128 v[140:143], v2 offset:45056
    v_exp_f32 v179, v105
    v_fma_f32 v180, v178, 0.5, 1.0
    v_mul_f32 v107, v107, v176
    v_mfma_f32_32x32x16_bf16 v[124:139], v[144:147], a[96:99], v[124:139]
    buffer_load_dwordx4 v1, s[4:7], s41 offen offset:2048 sc1 lds
    ds_read_b128 v[144:147], v2 offset:46080
    v_fma_f32 v181, v179, 0.5, 1.0
    v_fma_f32 v180, v178, v180, 1.0
    v_fma_f32 v181, v179, v181, 1.0
    v_mul_f32 v108, v108, v176
    v_mfma_f32_32x32x16_bf16 v[124:139], v[148:151], a[100:103], v[124:139]
    ds_read_b128 v[148:151], v2 offset:47104
    v_rcp_f32 v180, v180
    v_rcp_f32 v181, v181
    v_mul_f32 v109, v109, v176
    v_mfma_f32_32x32x16_bf16 v[124:139], v[152:155], a[104:107], v[124:139]
    buffer_load_dwordx4 v1, s[4:7], s41 offen offset:3072 sc1 lds
    ds_read_b128 v[152:155], v2 offset:48128
    s_add_u32 m0, s42, 40960
    v_fma_f32 v104, -v104, v180, v104
    v_fma_f32 v105, -v105, v181, v105
    v_cvt_pk_bf16_f32 v26, v104, v105
    v_mfma_f32_32x32x16_bf16 v[124:139], v[156:159], a[108:111], v[124:139]
    ds_read_b128 v[156:159], v2 offset:49152
    v_exp_f32 v164, v106
    v_exp_f32 v165, v107
    v_permlane16_swap_b32 v20, v24
    v_mfma_f32_32x32x16_bf16 v[124:139], v[160:163], a[112:115], v[124:139]
    ds_read_b128 v[160:163], v2 offset:50176
    v_fma_f32 v166, v164, 0.5, 1.0
    v_fma_f32 v167, v165, 0.5, 1.0
    v_fma_f32 v166, v164, v166, 1.0
    v_fma_f32 v167, v165, v167, 1.0
    v_mul_f32 v110, v110, v176
    v_mfma_f32_32x32x16_bf16 v[124:139], a[224:227], a[116:119], v[124:139]
    s_waitcnt lgkmcnt(6)
    buffer_load_dwordx4 v12, s[4:7], s41 offen offset:0 sc1 lds
    ds_read_b128 a[224:227], v2 offset:51200
    v_rcp_f32 v166, v166
    v_mul_f32 v111, v111, v176
    v_mfma_f32_32x32x16_bf16 v[124:139], a[228:231], a[120:123], v[124:139]
    ds_read_b128 a[228:231], v2 offset:52224
    v_rcp_f32 v167, v167
    v_fma_f32 v106, -v106, v166, v106
    v_permlane16_swap_b32 v21, v25
    v_fma_f32 v107, -v107, v167, v107
    v_mfma_f32_32x32x16_bf16 v[124:139], a[232:235], a[124:127], v[124:139]
    buffer_load_dwordx4 v12, s[4:7], s41 offen offset:1024 sc1 lds
    ds_read_b128 a[232:235], v2 offset:53248
    v_cvt_pk_bf16_f32 v27, v106, v107
    v_permlane16_swap_b32 v22, v26
    v_mfma_f32_32x32x16_bf16 v[124:139], a[236:239], a[128:131], v[124:139]
    ds_read_b128 a[236:239], v2 offset:54272
    v_permlane16_swap_b32 v23, v27
    v_exp_f32 v168, v108
    v_mul_f32 v112, v112, v176
    v_mfma_f32_32x32x16_bf16 v[124:139], a[240:243], a[132:135], v[124:139]
    buffer_store_dwordx4 v[20:23], v1, s[4:7], s44 offen offset:0 sc1
    ds_read_b128 a[240:243], v2 offset:55296
    v_mfma_f32_32x32x16_bf16 v[124:139], a[244:247], a[136:139], v[124:139]
    buffer_store_dwordx4 v[24:27], v1, s[4:7], s44 offen offset:1024 sc1
    ds_read_b128 a[244:247], v2 offset:56320
    v_mfma_f32_32x32x16_bf16 v[124:139], a[248:251], a[140:143], v[124:139]
    s_barrier
    ds_read_b128 a[248:251], v2 offset:57344
    v_exp_f32 v169, v109
    v_fma_f32 v170, v168, 0.5, 1.0
    v_mfma_f32_32x32x16_bf16 v[240:255], a[252:255], v[172:175], 0
    s_waitcnt lgkmcnt(6)
    buffer_load_dwordx4 v12, s[4:7], s41 offen offset:2048 sc1 lds
    ds_read_b128 a[252:255], v2 offset:58368
    v_fma_f32 v171, v169, 0.5, 1.0
    v_fma_f32 v170, v168, v170, 1.0
    v_fma_f32 v171, v169, v171, 1.0
    v_mfma_f32_32x32x16_bf16 v[240:255], v[140:143], a[0:3], v[240:255]
    ds_read_b128 v[140:143], v2 offset:59392
    v_rcp_f32 v170, v170
    v_rcp_f32 v171, v171
    v_exp_f32 v178, v110
    v_mfma_f32_32x32x16_bf16 v[240:255], v[144:147], a[4:7], v[240:255]
    ds_read_b128 v[144:147], v2 offset:60416
    v_fma_f32 v108, -v108, v170, v108
    v_fma_f32 v109, -v109, v171, v109
    v_exp_f32 v179, v111
    v_cvt_pk_bf16_f32 v28, v108, v109
    v_fma_f32 v180, v178, 0.5, 1.0
    v_mfma_f32_32x32x16_bf16 v[240:255], v[148:151], a[8:11], v[240:255]
    buffer_load_dwordx4 v12, s[4:7], s41 offen offset:3072 sc1 lds
    ds_read_b128 v[148:151], v2 offset:61440
    s_add_u32 m0, s42, 45056
    v_fma_f32 v181, v179, 0.5, 1.0
    v_fma_f32 v180, v178, v180, 1.0
    v_mfma_f32_32x32x16_bf16 v[240:255], v[152:155], a[12:15], v[240:255]
    ds_read_b128 v[152:155], v2 offset:62464
    v_fma_f32 v181, v179, v181, 1.0
    v_rcp_f32 v180, v180
    v_rcp_f32 v181, v181
    v_mul_f32 v113, v113, v176
    v_mfma_f32_32x32x16_bf16 v[240:255], v[156:159], a[16:19], v[240:255]
    buffer_load_dwordx4 v13, s[4:7], s41 offen offset:0 sc1 lds
    ds_read_b128 v[156:159], v2 offset:63488
    s_add_u32 m0, s42, 73728
    s_add_u32 s41, s41, 36864
    v_fma_f32 v110, -v110, v180, v110
    v_fma_f32 v111, -v111, v181, v111
    v_mfma_f32_32x32x16_bf16 v[240:255], v[160:163], a[20:23], v[240:255]
    ds_read_b128 v[160:163], v2 offset:64512
    v_cvt_pk_bf16_f32 v29, v110, v111
    v_exp_f32 v164, v112
    v_exp_f32 v165, v113
    v_mfma_f32_32x32x16_bf16 v[240:255], a[224:227], a[24:27], v[240:255]
    s_waitcnt lgkmcnt(6)
    ds_read_b128 a[224:227], v3 offset:0
    v_fma_f32 v166, v164, 0.5, 1.0
    v_fma_f32 v167, v165, 0.5, 1.0
    v_fma_f32 v166, v164, v166, 1.0
    v_fma_f32 v167, v165, v167, 1.0
    v_rcp_f32 v166, v166
    v_mfma_f32_32x32x16_bf16 v[240:255], a[228:231], a[28:31], v[240:255]
    buffer_load_dwordx4 v1, s[4:7], s41 offen offset:0 sc1 lds
    ds_read_b128 a[228:231], v3 offset:1024
    v_rcp_f32 v167, v167
    v_fma_f32 v112, -v112, v166, v112
    v_mul_f32 v114, v114, v176
    v_mfma_f32_32x32x16_bf16 v[240:255], a[232:235], a[32:35], v[240:255]
    ds_read_b128 a[232:235], v3 offset:2048
    v_fma_f32 v113, -v113, v167, v113
    v_mul_f32 v115, v115, v176
    v_cvt_pk_bf16_f32 v30, v112, v113
    v_exp_f32 v168, v114
    v_mfma_f32_32x32x16_bf16 v[240:255], a[236:239], a[36:39], v[240:255]
    buffer_load_dwordx4 v1, s[4:7], s41 offen offset:1024 sc1 lds
    ds_read_b128 a[236:239], v3 offset:3072
    v_exp_f32 v169, v115
    v_fma_f32 v170, v168, 0.5, 1.0
    v_mul_f32 v116, v116, v176
    v_mfma_f32_32x32x16_bf16 v[240:255], a[240:243], a[40:43], v[240:255]
    ds_read_b128 a[240:243], v3 offset:4096
    v_fma_f32 v171, v169, 0.5, 1.0
    v_fma_f32 v170, v168, v170, 1.0
    v_fma_f32 v171, v169, v171, 1.0
    v_rcp_f32 v170, v170
    v_mul_f32 v117, v117, v176
    v_mfma_f32_32x32x16_bf16 v[240:255], a[244:247], a[44:47], v[240:255]
    ds_read_b128 a[244:247], v3 offset:5120
    v_rcp_f32 v171, v171
    v_fma_f32 v114, -v114, v170, v114
    v_exp_f32 v178, v116
    v_fma_f32 v115, -v115, v171, v115
    v_mfma_f32_32x32x16_bf16 v[240:255], a[248:251], a[48:51], v[240:255]
    buffer_load_dwordx4 v1, s[4:7], s41 offen offset:2048 sc1 lds
    ds_read_b128 a[248:251], v3 offset:6144
    v_cvt_pk_bf16_f32 v31, v114, v115
    v_exp_f32 v179, v117
    v_mfma_f32_32x32x16_bf16 v[240:255], a[252:255], a[52:55], v[240:255]
    s_waitcnt lgkmcnt(6)
    ds_read_b128 a[252:255], v3 offset:7168
    v_fma_f32 v180, v178, 0.5, 1.0
    v_fma_f32 v181, v179, 0.5, 1.0
    v_fma_f32 v180, v178, v180, 1.0
    v_fma_f32 v181, v179, v181, 1.0
    v_rcp_f32 v180, v180
    v_mfma_f32_32x32x16_bf16 v[240:255], v[140:143], a[56:59], v[240:255]
    ds_read_b128 v[140:143], v3 offset:8192
    v_rcp_f32 v181, v181
    v_fma_f32 v116, -v116, v180, v116
    v_mul_f32 v118, v118, v176
    v_fma_f32 v117, -v117, v181, v117
    v_mul_f32 v119, v119, v176
    v_mfma_f32_32x32x16_bf16 v[240:255], v[144:147], a[60:63], v[240:255]
    buffer_load_dwordx4 v1, s[4:7], s41 offen offset:3072 sc1 lds
    ds_read_b128 v[144:147], v3 offset:9216
    s_add_u32 m0, s42, 77824
    v_cvt_pk_bf16_f32 v32, v116, v117
    v_mul_f32 v120, v120, v176
    v_mfma_f32_32x32x16_bf16 v[240:255], v[148:151], a[64:67], v[240:255]
    ds_read_b128 v[148:151], v3 offset:10240
    v_exp_f32 v164, v118
    v_exp_f32 v165, v119
    v_mul_f32 v121, v121, v176
    v_fma_f32 v166, v164, 0.5, 1.0
    v_mfma_f32_32x32x16_bf16 v[240:255], v[152:155], a[68:71], v[240:255]
    buffer_load_dwordx4 v12, s[4:7], s41 offen offset:0 sc1 lds
    ds_read_b128 v[152:155], v3 offset:11264
    v_fma_f32 v167, v165, 0.5, 1.0
    v_fma_f32 v166, v164, v166, 1.0
    v_fma_f32 v167, v165, v167, 1.0
    v_mul_f32 v122, v122, v176
    v_mfma_f32_32x32x16_bf16 v[240:255], v[156:159], a[72:75], v[240:255]
    ds_read_b128 v[156:159], v3 offset:12288
    v_rcp_f32 v166, v166
    v_rcp_f32 v167, v167
    v_mul_f32 v123, v123, v176
    v_mfma_f32_32x32x16_bf16 v[240:255], v[160:163], a[76:79], v[240:255]
    ds_read_b128 v[160:163], v3 offset:13312
    v_fma_f32 v118, -v118, v166, v118
    v_fma_f32 v119, -v119, v167, v119
    v_exp_f32 v168, v120
    v_cvt_pk_bf16_f32 v33, v118, v119
    v_fma_f32 v170, v168, 0.5, 1.0
    v_mfma_f32_32x32x16_bf16 v[240:255], a[224:227], a[80:83], v[240:255]
    s_waitcnt lgkmcnt(6)
    buffer_load_dwordx4 v12, s[4:7], s41 offen offset:1024 sc1 lds
    ds_read_b128 a[224:227], v3 offset:14336
    v_exp_f32 v169, v121
    v_fma_f32 v170, v168, v170, 1.0
    v_mfma_f32_32x32x16_bf16 v[240:255], a[228:231], a[84:87], v[240:255]
    ds_read_b128 a[228:231], v3 offset:15360
    v_fma_f32 v171, v169, 0.5, 1.0
    v_rcp_f32 v170, v170
    v_fma_f32 v171, v169, v171, 1.0
    v_exp_f32 v178, v122
    v_mfma_f32_32x32x16_bf16 v[240:255], a[232:235], a[88:91], v[240:255]
    buffer_load_dwordx4 v12, s[4:7], s41 offen offset:2048 sc1 lds
    ds_read_b128 a[232:235], v3 offset:20480
    v_rcp_f32 v171, v171
    v_fma_f32 v120, -v120, v170, v120
    v_mfma_f32_32x32x16_bf16 v[240:255], a[236:239], a[92:95], v[240:255]
    s_waitcnt vmcnt(18)
    s_barrier
    ds_read_b128 a[236:239], v1 offset:0
    v_fma_f32 v121, -v121, v171, v121
    v_exp_f32 v179, v123
    v_cvt_pk_bf16_f32 v34, v120, v121
    v_mfma_f32_32x32x16_bf16 v[240:255], a[240:243], a[96:99], v[240:255]
    ds_read_b128 a[240:243], v1 offset:1024
    v_fma_f32 v180, v178, 0.5, 1.0
    v_fma_f32 v181, v179, 0.5, 1.0
    v_fma_f32 v180, v178, v180, 1.0
    v_fma_f32 v181, v179, v181, 1.0
    v_rcp_f32 v180, v180
    v_mfma_f32_32x32x16_bf16 v[240:255], a[244:247], a[100:103], v[240:255]
    buffer_load_dwordx4 v12, s[4:7], s41 offen offset:3072 sc1 lds
    ds_read_b128 a[244:247], v1 offset:2048
    s_add_u32 m0, s42, 81920
    v_rcp_f32 v181, v181
    v_mfma_f32_32x32x16_bf16 v[240:255], a[248:251], a[104:107], v[240:255]
    ds_read_b128 a[248:251], v1 offset:3072
    v_fma_f32 v122, -v122, v180, v122
    v_fma_f32 v123, -v123, v181, v123
    v_permlane16_swap_b32 v28, v32
    v_cvt_pk_bf16_f32 v35, v122, v123
    v_mul_f32 v124, v124, v176
    v_mfma_f32_32x32x16_bf16 v[240:255], a[252:255], a[108:111], v[240:255]
    s_waitcnt lgkmcnt(6)
    buffer_load_dwordx4 v13, s[4:7], s41 offen offset:0 sc1 lds
    ds_read_b128 a[252:255], v1 offset:4096
    v_permlane16_swap_b32 v29, v33
    v_mul_f32 v125, v125, v176
    v_mfma_f32_32x32x16_bf16 v[240:255], v[140:143], a[112:115], v[240:255]
    ds_read_b128 v[140:143], v1 offset:5120
    v_permlane16_swap_b32 v30, v34
    v_permlane16_swap_b32 v31, v35
    v_mul_f32 v126, v126, v176
    v_mfma_f32_32x32x16_bf16 v[240:255], v[144:147], a[116:119], v[240:255]
    buffer_store_dwordx4 v[28:31], v1, s[4:7], s44 offen offset:2048 sc1
    ds_read_b128 v[144:147], v1 offset:6144
    v_mfma_f32_32x32x16_bf16 v[240:255], v[148:151], a[120:123], v[240:255]
    buffer_store_dwordx4 v[32:35], v1, s[4:7], s44 offen offset:3072 sc1
    ds_read_b128 v[148:151], v1 offset:7168
    v_mfma_f32_32x32x16_bf16 v[240:255], v[152:155], a[124:127], v[240:255]
    ds_read_b128 v[152:155], v1 offset:8192
    v_exp_f32 v164, v124
    v_exp_f32 v165, v125
    v_mul_f32 v127, v127, v176
    v_fma_f32 v166, v164, 0.5, 1.0
    v_mfma_f32_32x32x16_bf16 v[240:255], v[156:159], a[128:131], v[240:255]
    ds_read_b128 v[156:159], v1 offset:9216
    v_fma_f32 v167, v165, 0.5, 1.0
    v_fma_f32 v166, v164, v166, 1.0
    v_fma_f32 v167, v165, v167, 1.0
    v_rcp_f32 v166, v166
    v_mfma_f32_32x32x16_bf16 v[240:255], v[160:163], a[132:135], v[240:255]
    ds_read_b128 v[160:163], v1 offset:10240
    v_rcp_f32 v167, v167
    v_fma_f32 v124, -v124, v166, v124
    v_exp_f32 v168, v126
    v_fma_f32 v125, -v125, v167, v125
    v_mfma_f32_32x32x16_bf16 v[240:255], a[224:227], a[136:139], v[240:255]
    s_waitcnt lgkmcnt(6)
    ds_read_b128 a[224:227], v1 offset:11264
    v_cvt_pk_bf16_f32 v36, v124, v125
    v_exp_f32 v169, v127
    v_fma_f32 v170, v168, 0.5, 1.0
    v_mul_f32 v128, v128, v176
    v_fma_f32 v171, v169, 0.5, 1.0
    v_mfma_f32_32x32x16_bf16 v[240:255], a[228:231], a[140:143], v[240:255]
    s_waitcnt vmcnt(11)
    s_barrier
    ds_read_b128 a[228:231], v1 offset:12288
    s_add_u32 m0, s42, 110592
    s_add_u32 s41, s41, 36864
    v_fma_f32 v170, v168, v170, 1.0
    v_mfma_f32_32x32x16_bf16 v[92:107], a[232:235], v[172:175], 0
    buffer_load_dwordx4 v1, s[4:7], s41 offen offset:0 sc1 lds
    buffer_load_dwordx4 v1, s[4:7], s41 offen offset:1024 sc1 lds
    ds_read_b128 a[232:235], v1 offset:13312
    v_fma_f32 v171, v169, v171, 1.0
    v_mul_f32 v129, v129, v176
    v_mfma_f32_32x32x16_bf16 v[92:107], a[236:239], a[0:3], v[92:107]
    ds_read_b128 a[236:239], v1 offset:14336
    v_rcp_f32 v170, v170
    v_rcp_f32 v171, v171
    v_exp_f32 v178, v128
    v_mfma_f32_32x32x16_bf16 v[92:107], a[240:243], a[4:7], v[92:107]
    ds_read_b128 a[240:243], v1 offset:15360
    v_fma_f32 v126, -v126, v170, v126
    v_fma_f32 v127, -v127, v171, v127
    v_exp_f32 v179, v129
    v_cvt_pk_bf16_f32 v37, v126, v127
    v_fma_f32 v180, v178, 0.5, 1.0
    v_mfma_f32_32x32x16_bf16 v[92:107], a[244:247], a[8:11], v[92:107]
    buffer_load_dwordx4 v1, s[4:7], s41 offen offset:2048 sc1 lds
    ds_read_b128 a[244:247], v1 offset:16384
    v_fma_f32 v181, v179, 0.5, 1.0
    v_fma_f32 v180, v178, v180, 1.0
    v_fma_f32 v181, v179, v181, 1.0
    v_mfma_f32_32x32x16_bf16 v[92:107], a[248:251], a[12:15], v[92:107]
    ds_read_b128 a[248:251], v1 offset:17408
    v_rcp_f32 v180, v180
    v_rcp_f32 v181, v181
    v_mul_f32 v130, v130, v176
    v_fma_f32 v128, -v128, v180, v128
    v_mfma_f32_32x32x16_bf16 v[92:107], a[252:255], a[16:19], v[92:107]
    s_waitcnt lgkmcnt(6)
    ds_read_b128 a[252:255], v1 offset:18432
    v_fma_f32 v129, -v129, v181, v129
    v_mul_f32 v131, v131, v176
    v_cvt_pk_bf16_f32 v38, v128, v129
    v_exp_f32 v164, v130
    v_mul_f32 v132, v132, v176
    v_mfma_f32_32x32x16_bf16 v[92:107], v[140:143], a[20:23], v[92:107]
    buffer_load_dwordx4 v1, s[4:7], s41 offen offset:3072 sc1 lds
    ds_read_b128 v[140:143], v1 offset:19456
    s_add_u32 m0, s42, 114688
    v_exp_f32 v165, v131
    v_mfma_f32_32x32x16_bf16 v[92:107], v[144:147], a[24:27], v[92:107]
    ds_read_b128 v[144:147], v1 offset:20480
    v_fma_f32 v166, v164, 0.5, 1.0
    v_fma_f32 v167, v165, 0.5, 1.0
    v_fma_f32 v166, v164, v166, 1.0
    v_fma_f32 v167, v165, v167, 1.0
    v_rcp_f32 v166, v166
    v_mfma_f32_32x32x16_bf16 v[92:107], v[148:151], a[28:31], v[92:107]
    buffer_load_dwordx4 v12, s[4:7], s41 offen offset:0 sc1 lds
    ds_read_b128 v[148:151], v1 offset:21504
    v_rcp_f32 v167, v167
    v_fma_f32 v130, -v130, v166, v130
    v_mul_f32 v133, v133, v176
    v_mfma_f32_32x32x16_bf16 v[92:107], v[152:155], a[32:35], v[92:107]
    ds_read_b128 v[152:155], v1 offset:22528
    v_fma_f32 v131, -v131, v167, v131
    v_exp_f32 v168, v132
    v_cvt_pk_bf16_f32 v39, v130, v131
    v_mul_f32 v134, v134, v176
    v_mfma_f32_32x32x16_bf16 v[92:107], v[156:159], a[36:39], v[92:107]
    ds_read_b128 v[156:159], v1 offset:23552
    v_exp_f32 v169, v133
    v_fma_f32 v170, v168, 0.5, 1.0
    v_mul_f32 v135, v135, v176
    v_fma_f32 v171, v169, 0.5, 1.0
    v_fma_f32 v170, v168, v170, 1.0
    v_mfma_f32_32x32x16_bf16 v[92:107], v[160:163], a[40:43], v[92:107]
    buffer_load_dwordx4 v12, s[4:7], s41 offen offset:1024 sc1 lds
    ds_read_b128 v[160:163], v1 offset:24576
    v_fma_f32 v171, v169, v171, 1.0
    v_rcp_f32 v170, v170
    v_mul_f32 v136, v136, v176
    v_mfma_f32_32x32x16_bf16 v[92:107], a[224:227], a[44:47], v[92:107]
    s_waitcnt lgkmcnt(6)
    ds_read_b128 a[224:227], v1 offset:25600
    v_rcp_f32 v171, v171
    v_fma_f32 v132, -v132, v170, v132
    v_exp_f32 v178, v134
    v_fma_f32 v133, -v133, v171, v133
    v_mfma_f32_32x32x16_bf16 v[92:107], a[228:231], a[48:51], v[92:107]
    buffer_load_dwordx4 v12, s[4:7], s41 offen offset:2048 sc1 lds
    ds_read_b128 a[228:231], v1 offset:26624
    v_cvt_pk_bf16_f32 v40, v132, v133
    v_exp_f32 v179, v135
    v_mfma_f32_32x32x16_bf16 v[92:107], a[232:235], a[52:55], v[92:107]
    ds_read_b128 a[232:235], v1 offset:27648
    v_fma_f32 v180, v178, 0.5, 1.0
    v_fma_f32 v181, v179, 0.5, 1.0
    v_fma_f32 v180, v178, v180, 1.0
    v_fma_f32 v181, v179, v181, 1.0
    v_rcp_f32 v180, v180
    v_mfma_f32_32x32x16_bf16 v[92:107], a[236:239], a[56:59], v[92:107]
    ds_read_b128 a[236:239], v1 offset:28672
    v_rcp_f32 v181, v181
    v_fma_f32 v134, -v134, v180, v134
    v_mul_f32 v137, v137, v176
    v_fma_f32 v135, -v135, v181, v135
    v_mul_f32 v138, v138, v176
    v_mfma_f32_32x32x16_bf16 v[92:107], a[240:243], a[60:63], v[92:107]
    buffer_load_dwordx4 v12, s[4:7], s41 offen offset:3072 sc1 lds
    ds_read_b128 a[240:243], v1 offset:29696
    s_add_u32 m0, s42, 118784
    v_cvt_pk_bf16_f32 v41, v134, v135
    v_mul_f32 v139, v139, v176
    v_mfma_f32_32x32x16_bf16 v[92:107], a[244:247], a[64:67], v[92:107]
    ds_read_b128 a[244:247], v1 offset:30720
    v_exp_f32 v164, v136
    v_exp_f32 v165, v137
    v_exp_f32 v168, v138
    v_mfma_f32_32x32x16_bf16 v[92:107], a[248:251], a[68:71], v[92:107]
    ds_read_b128 a[248:251], v1 offset:31744
    v_fma_f32 v166, v164, 0.5, 1.0
    v_fma_f32 v167, v165, 0.5, 1.0
    v_fma_f32 v166, v164, v166, 1.0
    v_fma_f32 v167, v165, v167, 1.0
    v_rcp_f32 v166, v166
    v_mfma_f32_32x32x16_bf16 v[92:107], a[252:255], a[72:75], v[92:107]
    s_waitcnt lgkmcnt(6)
    buffer_load_dwordx4 v13, s[4:7], s41 offen offset:0 sc1 lds
    ds_read_b128 a[252:255], v1 offset:32768
    v_rcp_f32 v167, v167
    v_mfma_f32_32x32x16_bf16 v[92:107], v[140:143], a[76:79], v[92:107]
    ds_read_b128 v[140:143], v1 offset:33792
    v_fma_f32 v136, -v136, v166, v136
    v_fma_f32 v137, -v137, v167, v137
    v_exp_f32 v169, v139
    v_cvt_pk_bf16_f32 v42, v136, v137
    v_fma_f32 v170, v168, 0.5, 1.0
    v_mfma_f32_32x32x16_bf16 v[92:107], v[144:147], a[80:83], v[92:107]
    ds_read_b128 v[144:147], v1 offset:34816
    v_fma_f32 v171, v169, 0.5, 1.0
    v_fma_f32 v170, v168, v170, 1.0
    v_fma_f32 v171, v169, v171, 1.0
    v_rcp_f32 v170, v170
    v_mul_f32 v240, v240, v176
    v_mfma_f32_32x32x16_bf16 v[92:107], v[148:151], a[84:87], v[92:107]
    ds_read_b128 v[148:151], v1 offset:35840
    v_rcp_f32 v171, v171
    v_fma_f32 v138, -v138, v170, v138
    v_permlane16_swap_b32 v36, v40
    v_fma_f32 v139, -v139, v171, v139
    v_mfma_f32_32x32x16_bf16 v[92:107], v[152:155], a[88:91], v[92:107]
    ds_read_b128 v[152:155], v3 offset:21504
    v_cvt_pk_bf16_f32 v43, v138, v139
    v_permlane16_swap_b32 v37, v41
    v_permlane16_swap_b32 v38, v42
    v_mfma_f32_32x32x16_bf16 v[92:107], v[156:159], a[92:95], v[92:107]
    ds_read_b128 v[156:159], v1 offset:36864
    v_permlane16_swap_b32 v39, v43
    v_mul_f32 v241, v241, v176
    v_exp_f32 v178, v240
    v_mul_f32 v242, v242, v176
    v_mfma_f32_32x32x16_bf16 v[92:107], v[160:163], a[96:99], v[92:107]
    buffer_store_dwordx4 v[36:39], v12, s[4:7], s44 offen offset:0 sc1
    ds_read_b128 v[160:163], v1 offset:37888
    v_mfma_f32_32x32x16_bf16 v[92:107], a[224:227], a[100:103], v[92:107]
    s_waitcnt lgkmcnt(6)
    buffer_store_dwordx4 v[40:43], v12, s[4:7], s44 offen offset:1024 sc1
    ds_read_b128 a[224:227], v1 offset:38912
    v_mfma_f32_32x32x16_bf16 v[92:107], a[228:231], a[104:107], v[92:107]
    ds_read_b128 a[228:231], v1 offset:39936
    v_exp_f32 v179, v241
    v_fma_f32 v180, v178, 0.5, 1.0
    v_mul_f32 v243, v243, v176
    v_fma_f32 v181, v179, 0.5, 1.0
    v_fma_f32 v180, v178, v180, 1.0
    v_mfma_f32_32x32x16_bf16 v[92:107], a[232:235], a[108:111], v[92:107]
    ds_read_b128 a[232:235], v1 offset:40960
    v_fma_f32 v181, v179, v181, 1.0
    v_rcp_f32 v180, v180
    v_rcp_f32 v181, v181
    v_mul_f32 v244, v244, v176
    v_mfma_f32_32x32x16_bf16 v[92:107], a[236:239], a[112:115], v[92:107]
    ds_read_b128 a[236:239], v1 offset:41984
    v_fma_f32 v240, -v240, v180, v240
    v_fma_f32 v241, -v241, v181, v241
    v_exp_f32 v164, v242
    v_cvt_pk_bf16_f32 v44, v240, v241
    v_mul_f32 v245, v245, v176
    v_mfma_f32_32x32x16_bf16 v[92:107], a[240:243], a[116:119], v[92:107]
    ds_read_b128 a[240:243], v1 offset:43008
    v_exp_f32 v165, v243
    v_fma_f32 v166, v164, 0.5, 1.0
    v_exp_f32 v168, v244
    v_mfma_f32_32x32x16_bf16 v[92:107], a[244:247], a[120:123], v[92:107]
    ds_read_b128 a[244:247], v1 offset:44032
    v_fma_f32 v167, v165, 0.5, 1.0
    v_fma_f32 v166, v164, v166, 1.0
    v_fma_f32 v167, v165, v167, 1.0
    v_rcp_f32 v166, v166
    v_fma_f32 v170, v168, 0.5, 1.0
    v_mfma_f32_32x32x16_bf16 v[92:107], a[248:251], a[124:127], v[92:107]
    ds_read_b128 a[248:251], v1 offset:45056
    v_rcp_f32 v167, v167
    v_fma_f32 v242, -v242, v166, v242
    v_exp_f32 v169, v245
    v_fma_f32 v243, -v243, v167, v243
    v_mfma_f32_32x32x16_bf16 v[92:107], a[252:255], a[128:131], v[92:107]
    s_waitcnt lgkmcnt(6)
    ds_read_b128 a[252:255], v1 offset:46080
    v_cvt_pk_bf16_f32 v45, v242, v243
    v_fma_f32 v171, v169, 0.5, 1.0
    v_fma_f32 v170, v168, v170, 1.0
    v_fma_f32 v171, v169, v171, 1.0
    v_mfma_f32_32x32x16_bf16 v[92:107], v[140:143], a[132:135], v[92:107]
    ds_read_b128 v[140:143], v1 offset:47104
    v_rcp_f32 v170, v170
    v_rcp_f32 v171, v171
    v_mul_f32 v246, v246, v176
    v_fma_f32 v244, -v244, v170, v244
    v_mfma_f32_32x32x16_bf16 v[92:107], v[144:147], a[136:139], v[92:107]
    ds_read_b128 v[144:147], v1 offset:48128
    v_fma_f32 v245, -v245, v171, v245
    v_mul_f32 v247, v247, v176
    v_cvt_pk_bf16_f32 v46, v244, v245
    v_exp_f32 v178, v246
    v_mul_f32 v248, v248, v176
    v_mfma_f32_32x32x16_bf16 v[92:107], v[148:151], a[140:143], v[92:107]
    s_waitcnt vmcnt(13)
    s_barrier
    ds_read_b128 v[148:151], v1 offset:49152
    s_add_u32 m0, s42, 0
    s_add_u32 s41, s41, 36864
    v_fma_f32 v180, v178, 0.5, 1.0
    v_mfma_f32_32x32x16_bf16 v[108:123], v[152:155], v[172:175], 0
    buffer_load_dwordx4 v1, s[4:7], s41 offen offset:0 sc1 lds
    buffer_load_dwordx4 v1, s[4:7], s41 offen offset:1024 sc1 lds
    ds_read_b128 v[152:155], v1 offset:50176
    v_exp_f32 v179, v247
    v_mfma_f32_32x32x16_bf16 v[108:123], v[156:159], a[0:3], v[108:123]
    ds_read_b128 v[156:159], v1 offset:51200
    v_fma_f32 v181, v179, 0.5, 1.0
    v_fma_f32 v180, v178, v180, 1.0
    v_fma_f32 v181, v179, v181, 1.0
    v_rcp_f32 v180, v180
    v_mul_f32 v249, v249, v176
    v_mfma_f32_32x32x16_bf16 v[108:123], v[160:163], a[4:7], v[108:123]
    ds_read_b128 v[160:163], v1 offset:52224
    v_rcp_f32 v181, v181
    v_fma_f32 v246, -v246, v180, v246
    v_exp_f32 v164, v248
    v_fma_f32 v247, -v247, v181, v247
    v_mfma_f32_32x32x16_bf16 v[108:123], a[224:227], a[8:11], v[108:123]
    s_waitcnt lgkmcnt(6)
    buffer_load_dwordx4 v1, s[4:7], s41 offen offset:2048 sc1 lds
    ds_read_b128 a[224:227], v1 offset:53248
    v_cvt_pk_bf16_f32 v47, v246, v247
    v_fma_f32 v166, v164, 0.5, 1.0
    v_mfma_f32_32x32x16_bf16 v[108:123], a[228:231], a[12:15], v[108:123]
    ds_read_b128 a[228:231], v1 offset:54272
    v_exp_f32 v165, v249
    v_fma_f32 v166, v164, v166, 1.0
    v_mul_f32 v250, v250, v176
    v_fma_f32 v167, v165, 0.5, 1.0
    v_mul_f32 v251, v251, v176
    v_mfma_f32_32x32x16_bf16 v[108:123], a[232:235], a[16:19], v[108:123]
    ds_read_b128 a[232:235], v1 offset:55296
    v_fma_f32 v167, v165, v167, 1.0
    v_rcp_f32 v166, v166
    v_rcp_f32 v167, v167
    v_mul_f32 v252, v252, v176
    v_mfma_f32_32x32x16_bf16 v[108:123], a[236:239], a[20:23], v[108:123]
    buffer_load_dwordx4 v1, s[4:7], s41 offen offset:3072 sc1 lds
    ds_read_b128 a[236:239], v1 offset:56320
    s_add_u32 m0, s42, 4096
    v_fma_f32 v248, -v248, v166, v248
    v_fma_f32 v249, -v249, v167, v249
    v_mfma_f32_32x32x16_bf16 v[108:123], a[240:243], a[24:27], v[108:123]
    ds_read_b128 a[240:243], v1 offset:57344
    v_cvt_pk_bf16_f32 v48, v248, v249
    v_exp_f32 v168, v250
    v_exp_f32 v169, v251
    v_mul_f32 v253, v253, v176
    v_mfma_f32_32x32x16_bf16 v[108:123], a[244:247], a[28:31], v[108:123]
    buffer_load_dwordx4 v12, s[4:7], s41 offen offset:0 sc1 lds
    ds_read_b128 a[244:247], v1 offset:58368
    v_fma_f32 v170, v168, 0.5, 1.0
    v_fma_f32 v171, v169, 0.5, 1.0
    v_fma_f32 v170, v168, v170, 1.0
    v_fma_f32 v171, v169, v171, 1.0
    v_mfma_f32_32x32x16_bf16 v[108:123], a[248:251], a[32:35], v[108:123]
    ds_read_b128 a[248:251], v1 offset:59392
    v_rcp_f32 v170, v170
    v_rcp_f32 v171, v171
    v_mul_f32 v254, v254, v176
    v_mfma_f32_32x32x16_bf16 v[108:123], a[252:255], a[36:39], v[108:123]
    s_waitcnt lgkmcnt(6)
    ds_read_b128 a[252:255], v1 offset:60416
    v_fma_f32 v250, -v250, v170, v250
    v_fma_f32 v251, -v251, v171, v251
    v_exp_f32 v178, v252
    v_cvt_pk_bf16_f32 v49, v250, v251
    v_mul_f32 v255, v255, v176
    v_mfma_f32_32x32x16_bf16 v[108:123], v[140:143], a[40:43], v[108:123]
    buffer_load_dwordx4 v12, s[4:7], s41 offen offset:1024 sc1 lds
    ds_read_b128 v[140:143], v1 offset:61440
    v_exp_f32 v179, v253
    v_fma_f32 v180, v178, 0.5, 1.0
    v_fma_f32 v181, v179, 0.5, 1.0
    v_mfma_f32_32x32x16_bf16 v[108:123], v[144:147], a[44:47], v[108:123]
    s_cmp_eq_u32 s22, 0
    s_cbranch_scc1 L_inte_side_35
L_inte_side_35_back:
    ds_read_b128 v[144:147], v1 offset:62464
    v_fma_f32 v180, v178, v180, 1.0
    v_fma_f32 v181, v179, v181, 1.0
    v_mfma_f32_32x32x16_bf16 v[108:123], v[148:151], a[48:51], v[108:123]
    buffer_load_dwordx4 v12, s[4:7], s41 offen offset:2048 sc1 lds
    ds_read_b128 v[148:151], v1 offset:63488
    v_rcp_f32 v180, v180
    v_mul_f32 v92, v92, v176
    v_mfma_f32_32x32x16_bf16 v[108:123], v[152:155], a[52:55], v[108:123]
    ds_read_b128 v[152:155], v1 offset:64512
    v_rcp_f32 v181, v181
    v_fma_f32 v252, -v252, v180, v252
    v_exp_f32 v164, v254
    v_fma_f32 v253, -v253, v181, v253
    v_mfma_f32_32x32x16_bf16 v[108:123], v[156:159], a[56:59], v[108:123]
    s_waitcnt vmcnt(7)
    ds_read_b128 v[156:159], v2 offset:0
    v_cvt_pk_bf16_f32 v50, v252, v253
    v_exp_f32 v165, v255
    v_fma_f32 v166, v164, 0.5, 1.0
    v_permlane16_swap_b32 v44, v48
    v_mfma_f32_32x32x16_bf16 v[108:123], v[160:163], a[60:63], v[108:123]
    buffer_atomic_add v10, v8, s[4:7], s28 offen offset:20 sc1
    buffer_load_dwordx4 v12, s[4:7], s41 offen offset:3072 sc1 lds
    ds_read_b128 v[160:163], v2 offset:1024
    v_mfma_f32_32x32x16_bf16 v[108:123], a[224:227], a[64:67], v[108:123]
    s_waitcnt lgkmcnt(6)
    ds_read_b128 a[224:227], v2 offset:2048
    s_add_u32 m0, s42, 8192
    v_fma_f32 v167, v165, 0.5, 1.0
    v_fma_f32 v166, v164, v166, 1.0
    v_fma_f32 v167, v165, v167, 1.0
    v_rcp_f32 v166, v166
    v_mfma_f32_32x32x16_bf16 v[108:123], a[228:231], a[68:71], v[108:123]
    ds_read_b128 a[228:231], v2 offset:3072
    v_rcp_f32 v167, v167
    v_fma_f32 v254, -v254, v166, v254
    v_permlane16_swap_b32 v45, v49
    v_fma_f32 v255, -v255, v167, v255
    v_mfma_f32_32x32x16_bf16 v[108:123], a[232:235], a[72:75], v[108:123]
    buffer_load_dwordx4 v13, s[4:7], s41 offen offset:0 sc1 lds
    ds_read_b128 a[232:235], v2 offset:4096
    v_cvt_pk_bf16_f32 v51, v254, v255
    v_permlane16_swap_b32 v46, v50
    v_mfma_f32_32x32x16_bf16 v[108:123], a[236:239], a[76:79], v[108:123]
    ds_read_b128 a[236:239], v2 offset:5120
    v_permlane16_swap_b32 v47, v51
    v_mul_f32 v93, v93, v176
    v_exp_f32 v168, v92
    v_mul_f32 v94, v94, v176
    v_mfma_f32_32x32x16_bf16 v[108:123], a[240:243], a[80:83], v[108:123]
    buffer_store_dwordx4 v[44:47], v12, s[4:7], s44 offen offset:2048 sc1
    ds_read_b128 a[240:243], v2 offset:6144
    v_mfma_f32_32x32x16_bf16 v[108:123], a[244:247], a[84:87], v[108:123]
    buffer_store_dwordx4 v[48:51], v12, s[4:7], s44 offen offset:3072 sc1
    ds_read_b128 a[244:247], v2 offset:7168
    v_mfma_f32_32x32x16_bf16 v[108:123], a[248:251], a[88:91], v[108:123]
    ds_read_b128 a[248:251], v3 offset:22528
    v_exp_f32 v169, v93
    v_fma_f32 v170, v168, 0.5, 1.0
    v_mul_f32 v95, v95, v176
    v_fma_f32 v171, v169, 0.5, 1.0
    v_mfma_f32_32x32x16_bf16 v[108:123], a[252:255], a[92:95], v[108:123]
    s_waitcnt lgkmcnt(6)
    ds_read_b128 a[252:255], v2 offset:8192
    v_fma_f32 v170, v168, v170, 1.0
    v_fma_f32 v171, v169, v171, 1.0
    v_rcp_f32 v170, v170
    v_rcp_f32 v171, v171
    v_mfma_f32_32x32x16_bf16 v[108:123], v[140:143], a[96:99], v[108:123]
    ds_read_b128 v[140:143], v2 offset:9216
    v_fma_f32 v92, -v92, v170, v92
    v_fma_f32 v93, -v93, v171, v93
    v_exp_f32 v178, v94
    v_cvt_pk_bf16_f32 v52, v92, v93
    v_mul_f32 v96, v96, v176
    v_mfma_f32_32x32x16_bf16 v[108:123], v[144:147], a[100:103], v[108:123]
    ds_read_b128 v[144:147], v2 offset:10240
    v_exp_f32 v179, v95
    v_fma_f32 v180, v178, 0.5, 1.0
    v_mul_f32 v97, v97, v176
    v_fma_f32 v181, v179, 0.5, 1.0
    v_mfma_f32_32x32x16_bf16 v[108:123], v[148:151], a[104:107], v[108:123]
    ds_read_b128 v[148:151], v2 offset:11264
    v_fma_f32 v180, v178, v180, 1.0
    v_fma_f32 v181, v179, v181, 1.0
    v_rcp_f32 v180, v180
    v_rcp_f32 v181, v181
    v_mfma_f32_32x32x16_bf16 v[108:123], v[152:155], a[108:111], v[108:123]
    ds_read_b128 v[152:155], v2 offset:12288
    v_fma_f32 v94, -v94, v180, v94
    v_fma_f32 v95, -v95, v181, v95
    v_exp_f32 v164, v96
    v_cvt_pk_bf16_f32 v53, v94, v95
    v_mul_f32 v98, v98, v176
    v_mfma_f32_32x32x16_bf16 v[108:123], v[156:159], a[112:115], v[108:123]
    ds_read_b128 v[156:159], v2 offset:13312
    v_exp_f32 v165, v97
    v_fma_f32 v166, v164, 0.5, 1.0
    v_mul_f32 v99, v99, v176
    v_fma_f32 v167, v165, 0.5, 1.0
    v_fma_f32 v166, v164, v166, 1.0
    v_mfma_f32_32x32x16_bf16 v[108:123], v[160:163], a[116:119], v[108:123]
    ds_read_b128 v[160:163], v2 offset:14336
    v_fma_f32 v167, v165, v167, 1.0
    v_rcp_f32 v166, v166
    v_rcp_f32 v167, v167
    v_mfma_f32_32x32x16_bf16 v[108:123], a[224:227], a[120:123], v[108:123]
    s_waitcnt lgkmcnt(6)
    ds_read_b128 a[224:227], v2 offset:15360
    v_fma_f32 v96, -v96, v166, v96
    v_fma_f32 v97, -v97, v167, v97
    v_exp_f32 v168, v98
    v_cvt_pk_bf16_f32 v54, v96, v97
    v_mul_f32 v100, v100, v176
    v_mfma_f32_32x32x16_bf16 v[108:123], a[228:231], a[124:127], v[108:123]
    ds_read_b128 a[228:231], v2 offset:16384
    v_exp_f32 v169, v99
    v_fma_f32 v170, v168, 0.5, 1.0
    v_mul_f32 v101, v101, v176
    v_fma_f32 v171, v169, 0.5, 1.0
    v_fma_f32 v170, v168, v170, 1.0
    v_mfma_f32_32x32x16_bf16 v[108:123], a[232:235], a[128:131], v[108:123]
    ds_read_b128 a[232:235], v2 offset:17408
    v_fma_f32 v171, v169, v171, 1.0
    v_rcp_f32 v170, v170
    v_rcp_f32 v171, v171
    v_mfma_f32_32x32x16_bf16 v[108:123], a[236:239], a[132:135], v[108:123]
    ds_read_b128 a[236:239], v2 offset:18432
    s_cmp_eq_u32 s22, 0
    s_cbranch_scc1 L_inte_side_36
L_inte_side_36_back:
    v_fma_f32 v98, -v98, v170, v98
    v_fma_f32 v99, -v99, v171, v99
    v_mfma_f32_32x32x16_bf16 v[108:123], a[240:243], a[136:139], v[108:123]
    ds_read_b128 a[240:243], v2 offset:19456
    v_cvt_pk_bf16_f32 v55, v98, v99
    v_exp_f32 v178, v100
    v_exp_f32 v179, v101
    v_mul_f32 v102, v102, v176
    v_mfma_f32_32x32x16_bf16 v[108:123], a[244:247], a[140:143], v[108:123]
    s_barrier
    ds_read_b128 a[244:247], v2 offset:20480
    s_load_dword s3, s[12:13], 20 glc
    s_add_u32 m0, s42, 36864
    s_add_u32 s41, s41, 5013504
    v_mfma_f32_32x32x16_bf16 v[124:139], a[248:251], v[172:175], 0
    buffer_load_dwordx4 v1, s[4:7], s41 offen offset:0 sc1 lds
    buffer_load_dwordx4 v1, s[4:7], s41 offen offset:1024 sc1 lds
    ds_read_b128 a[248:251], v2 offset:21504
    v_fma_f32 v180, v178, 0.5, 1.0
    v_fma_f32 v181, v179, 0.5, 1.0
    v_mfma_f32_32x32x16_bf16 v[124:139], a[252:255], a[0:3], v[124:139]
    s_waitcnt lgkmcnt(6)
    ds_read_b128 a[252:255], v2 offset:22528
    v_fma_f32 v180, v178, v180, 1.0
    v_fma_f32 v181, v179, v181, 1.0
    v_rcp_f32 v180, v180
    v_rcp_f32 v181, v181
    v_mfma_f32_32x32x16_bf16 v[124:139], v[140:143], a[4:7], v[124:139]
    ds_read_b128 v[140:143], v2 offset:23552
    v_fma_f32 v100, -v100, v180, v100
    v_fma_f32 v101, -v101, v181, v101
    v_mul_f32 v103, v103, v176
    v_cvt_pk_bf16_f32 v56, v100, v101
    v_exp_f32 v164, v102
    v_mfma_f32_32x32x16_bf16 v[124:139], v[144:147], a[8:11], v[124:139]
    buffer_load_dwordx4 v1, s[4:7], s41 offen offset:2048 sc1 lds
    ds_read_b128 v[144:147], v2 offset:24576
    v_exp_f32 v165, v103
    v_fma_f32 v166, v164, 0.5, 1.0
    v_mfma_f32_32x32x16_bf16 v[124:139], v[148:151], a[12:15], v[124:139]
    ds_read_b128 v[148:151], v2 offset:25600
    v_fma_f32 v167, v165, 0.5, 1.0
    v_fma_f32 v166, v164, v166, 1.0
    v_fma_f32 v167, v165, v167, 1.0
    v_rcp_f32 v166, v166
    v_mul_f32 v104, v104, v176
    v_mfma_f32_32x32x16_bf16 v[124:139], v[152:155], a[16:19], v[124:139]
    ds_read_b128 v[152:155], v2 offset:26624
    v_rcp_f32 v167, v167
    v_fma_f32 v102, -v102, v166, v102
    v_mul_f32 v105, v105, v176
    v_fma_f32 v103, -v103, v167, v103
    v_mul_f32 v106, v106, v176
    v_mfma_f32_32x32x16_bf16 v[124:139], v[156:159], a[20:23], v[124:139]
    buffer_load_dwordx4 v1, s[4:7], s41 offen offset:3072 sc1 lds
    ds_read_b128 v[156:159], v2 offset:27648
    s_add_u32 m0, s42, 40960
    v_cvt_pk_bf16_f32 v57, v102, v103
    v_mul_f32 v107, v107, v176
    v_mfma_f32_32x32x16_bf16 v[124:139], v[160:163], a[24:27], v[124:139]
    ds_read_b128 v[160:163], v2 offset:28672
    v_exp_f32 v168, v104
    v_exp_f32 v169, v105
    v_exp_f32 v178, v106
    v_mfma_f32_32x32x16_bf16 v[124:139], a[224:227], a[28:31], v[124:139]
    s_waitcnt lgkmcnt(6)
    buffer_load_dwordx4 v12, s[4:7], s41 offen offset:0 sc1 lds
    ds_read_b128 a[224:227], v2 offset:29696
    v_fma_f32 v170, v168, 0.5, 1.0
    v_fma_f32 v171, v169, 0.5, 1.0
    v_fma_f32 v170, v168, v170, 1.0
    v_mfma_f32_32x32x16_bf16 v[124:139], a[228:231], a[32:35], v[124:139]
    ds_read_b128 a[228:231], v2 offset:30720
    v_fma_f32 v171, v169, v171, 1.0
    v_rcp_f32 v170, v170
    v_rcp_f32 v171, v171
    v_mfma_f32_32x32x16_bf16 v[124:139], a[232:235], a[36:39], v[124:139]
    ds_read_b128 a[232:235], v2 offset:31744
    v_fma_f32 v104, -v104, v170, v104
    v_fma_f32 v105, -v105, v171, v105
    v_exp_f32 v179, v107
    v_cvt_pk_bf16_f32 v58, v104, v105
    v_fma_f32 v180, v178, 0.5, 1.0
    v_mfma_f32_32x32x16_bf16 v[124:139], a[236:239], a[40:43], v[124:139]
    buffer_load_dwordx4 v12, s[4:7], s41 offen offset:1024 sc1 lds
    ds_read_b128 a[236:239], v2 offset:32768
    v_fma_f32 v181, v179, 0.5, 1.0
    v_fma_f32 v180, v178, v180, 1.0
    v_fma_f32 v181, v179, v181, 1.0
    v_mul_f32 v108, v108, v176
    v_mfma_f32_32x32x16_bf16 v[124:139], a[240:243], a[44:47], v[124:139]
    ds_read_b128 a[240:243], v2 offset:33792
    v_rcp_f32 v180, v180
    v_rcp_f32 v181, v181
    v_permlane16_swap_b32 v52, v56
    v_mfma_f32_32x32x16_bf16 v[124:139], a[244:247], a[48:51], v[124:139]
    buffer_load_dwordx4 v12, s[4:7], s41 offen offset:2048 sc1 lds
    ds_read_b128 a[244:247], v2 offset:34816
    v_fma_f32 v106, -v106, v180, v106
    v_fma_f32 v107, -v107, v181, v107
    v_mul_f32 v109, v109, v176
    v_mfma_f32_32x32x16_bf16 v[124:139], a[248:251], a[52:55], v[124:139]
    ds_read_b128 a[248:251], v2 offset:35840
    v_cvt_pk_bf16_f32 v59, v106, v107
    v_permlane16_swap_b32 v53, v57
    v_permlane16_swap_b32 v54, v58
    v_mul_f32 v110, v110, v176
    v_mfma_f32_32x32x16_bf16 v[124:139], a[252:255], a[56:59], v[124:139]
    s_waitcnt lgkmcnt(6)
    ds_read_b128 a[252:255], v2 offset:36864
    v_permlane16_swap_b32 v55, v59
    v_exp_f32 v164, v108
    v_exp_f32 v165, v109
    v_mfma_f32_32x32x16_bf16 v[124:139], v[140:143], a[60:63], v[124:139]
    buffer_load_dwordx4 v12, s[4:7], s41 offen offset:3072 sc1 lds
    ds_read_b128 v[140:143], v2 offset:37888
    s_add_u32 m0, s42, 45056
    v_fma_f32 v166, v164, 0.5, 1.0
    v_fma_f32 v167, v165, 0.5, 1.0
    v_mfma_f32_32x32x16_bf16 v[124:139], v[144:147], a[64:67], v[124:139]
    s_waitcnt lgkmcnt(0)
    s_cmp_lt_u32 s3, 12
    s_cbranch_scc1 L_inte_chk_28_slow
L_inte_chk_28_back:
    ds_read_b128 v[144:147], v2 offset:38912
    v_fma_f32 v166, v164, v166, 1.0
    v_fma_f32 v167, v165, v167, 1.0
    v_rcp_f32 v166, v166
    v_mfma_f32_32x32x16_bf16 v[124:139], v[148:151], a[68:71], v[124:139]
    buffer_store_dwordx4 v[52:55], v13, s[4:7], s44 offen offset:0 sc1
    ds_read_b128 v[148:151], v2 offset:39936
    v_mfma_f32_32x32x16_bf16 v[124:139], v[152:155], a[72:75], v[124:139]
    buffer_load_dwordx4 v13, s[4:7], s41 offen offset:0 sc1 lds
    ds_read_b128 v[152:155], v2 offset:40960
    v_rcp_f32 v167, v167
    v_fma_f32 v108, -v108, v166, v108
    v_mul_f32 v111, v111, v176
    v_mfma_f32_32x32x16_bf16 v[124:139], v[156:159], a[76:79], v[124:139]
    buffer_store_dwordx4 v[56:59], v13, s[4:7], s44 offen offset:1024 sc1
    ds_read_b128 v[156:159], v2 offset:41984
    v_mfma_f32_32x32x16_bf16 v[124:139], v[160:163], a[80:83], v[124:139]
    ds_read_b128 v[160:163], v2 offset:43008
    v_fma_f32 v109, -v109, v167, v109
    v_exp_f32 v168, v110
    v_cvt_pk_bf16_f32 v60, v108, v109
    v_exp_f32 v169, v111
    v_mfma_f32_32x32x16_bf16 v[124:139], a[224:227], a[84:87], v[124:139]
    ds_read_b128 a[224:227], v2 offset:44032
    v_fma_f32 v170, v168, 0.5, 1.0
    v_fma_f32 v171, v169, 0.5, 1.0
    v_fma_f32 v170, v168, v170, 1.0
    v_fma_f32 v171, v169, v171, 1.0
    v_rcp_f32 v170, v170
    v_mfma_f32_32x32x16_bf16 v[124:139], a[228:231], a[88:91], v[124:139]
    buffer_load_dwordx4 a[144:147], v1, s[4:7], s45 offen offset:0 sc1
    ds_read_b128 a[228:231], v3 offset:23552
    v_rcp_f32 v171, v171
    v_fma_f32 v110, -v110, v170, v110
    v_mfma_f32_32x32x16_bf16 v[124:139], a[232:235], a[92:95], v[124:139]
    ds_read_b128 a[232:235], v2 offset:45056
    v_fma_f32 v111, -v111, v171, v111
    v_mul_f32 v112, v112, v176
    v_cvt_pk_bf16_f32 v61, v110, v111
    v_mul_f32 v113, v113, v176
    v_exp_f32 v178, v112
    v_mfma_f32_32x32x16_bf16 v[124:139], a[236:239], a[96:99], v[124:139]
    buffer_load_dwordx4 a[148:151], v1, s[4:7], s45 offen offset:1024 sc1
    ds_read_b128 a[236:239], v2 offset:46080
    v_exp_f32 v179, v113
    v_fma_f32 v180, v178, 0.5, 1.0
    v_mul_f32 v114, v114, v176
    v_mfma_f32_32x32x16_bf16 v[124:139], a[240:243], a[100:103], v[124:139]
    ds_read_b128 a[240:243], v2 offset:47104
    v_fma_f32 v181, v179, 0.5, 1.0
    v_fma_f32 v180, v178, v180, 1.0
    v_fma_f32 v181, v179, v181, 1.0
    v_rcp_f32 v180, v180
    v_mfma_f32_32x32x16_bf16 v[124:139], a[244:247], a[104:107], v[124:139]
    ds_read_b128 a[244:247], v2 offset:48128
    v_rcp_f32 v181, v181
    v_fma_f32 v112, -v112, v180, v112
    v_mul_f32 v115, v115, v176
    v_fma_f32 v113, -v113, v181, v113
    v_mul_f32 v116, v116, v176
    v_mfma_f32_32x32x16_bf16 v[124:139], a[248:251], a[108:111], v[124:139]
    buffer_load_dwordx4 a[152:155], v1, s[4:7], s46 offen offset:0 sc1
    ds_read_b128 a[248:251], v2 offset:49152
    v_cvt_pk_bf16_f32 v62, v112, v113
    v_exp_f32 v164, v114
    v_mul_f32 v117, v117, v176
    v_mfma_f32_32x32x16_bf16 v[124:139], a[252:255], a[112:115], v[124:139]
    s_waitcnt lgkmcnt(6)
    ds_read_b128 a[252:255], v2 offset:50176
    v_exp_f32 v165, v115
    v_fma_f32 v166, v164, 0.5, 1.0
    v_exp_f32 v168, v116
    v_fma_f32 v167, v165, 0.5, 1.0
    v_mfma_f32_32x32x16_bf16 v[124:139], v[140:143], a[116:119], v[124:139]
    ds_read_b128 v[140:143], v2 offset:51200
    v_fma_f32 v166, v164, v166, 1.0
    v_fma_f32 v167, v165, v167, 1.0
    v_rcp_f32 v166, v166
    v_fma_f32 v170, v168, 0.5, 1.0
    v_mfma_f32_32x32x16_bf16 v[124:139], v[144:147], a[120:123], v[124:139]
    buffer_load_dwordx4 a[156:159], v1, s[4:7], s46 offen offset:1024 sc1
    ds_read_b128 v[144:147], v2 offset:52224
    v_rcp_f32 v167, v167
    v_fma_f32 v114, -v114, v166, v114
    v_fma_f32 v170, v168, v170, 1.0
    v_mfma_f32_32x32x16_bf16 v[124:139], v[148:151], a[124:127], v[124:139]
    ds_read_b128 v[148:151], v2 offset:53248
    v_fma_f32 v115, -v115, v167, v115
    v_exp_f32 v169, v117
    v_cvt_pk_bf16_f32 v63, v114, v115
    v_rcp_f32 v170, v170
    v_mfma_f32_32x32x16_bf16 v[124:139], v[152:155], a[128:131], v[124:139]
    buffer_load_dwordx4 a[160:163], v1, s[4:7], s47 offen offset:0 sc1
    ds_read_b128 v[152:155], v2 offset:54272
    v_fma_f32 v171, v169, 0.5, 1.0
    v_fma_f32 v116, -v116, v170, v116
    v_fma_f32 v171, v169, v171, 1.0
    v_mfma_f32_32x32x16_bf16 v[124:139], v[156:159], a[132:135], v[124:139]
    ds_read_b128 v[156:159], v2 offset:55296
    v_rcp_f32 v171, v171
    v_mul_f32 v118, v118, v176
    v_mul_f32 v119, v119, v176
    v_fma_f32 v117, -v117, v171, v117
    v_mul_f32 v120, v120, v176
    v_mfma_f32_32x32x16_bf16 v[124:139], v[160:163], a[136:139], v[124:139]
    ds_read_b128 v[160:163], v2 offset:56320
    v_cvt_pk_bf16_f32 v64, v116, v117
    v_exp_f32 v178, v118
    v_exp_f32 v179, v119
    v_mul_f32 v121, v121, v176
    v_mfma_f32_32x32x16_bf16 v[124:139], a[224:227], a[140:143], v[124:139]
    s_waitcnt lgkmcnt(6)
    s_waitcnt vmcnt(18)
    s_barrier
    ds_read_b128 a[224:227], v2 offset:57344
    s_add_u32 m0, s42, 73728
    s_add_u32 s41, s41, 36864
    v_mfma_f32_32x32x16_bf16 v[240:255], a[228:231], v[172:175], 0
    buffer_load_dwordx4 v1, s[4:7], s41 offen offset:0 sc1 lds
    ds_read_b128 a[228:231], v2 offset:58368
    v_fma_f32 v180, v178, 0.5, 1.0
    v_fma_f32 v181, v179, 0.5, 1.0
    v_fma_f32 v180, v178, v180, 1.0
    v_fma_f32 v181, v179, v181, 1.0
    v_mfma_f32_32x32x16_bf16 v[240:255], a[232:235], a[0:3], v[240:255]
    buffer_load_dwordx4 v1, s[4:7], s41 offen offset:1024 sc1 lds
    ds_read_b128 a[232:235], v2 offset:59392
    v_rcp_f32 v180, v180
    v_rcp_f32 v181, v181
    v_mfma_f32_32x32x16_bf16 v[240:255], a[236:239], a[4:7], v[240:255]
    ds_read_b128 a[236:239], v2 offset:60416
    v_fma_f32 v118, -v118, v180, v118
    v_fma_f32 v119, -v119, v181, v119
    v_exp_f32 v164, v120
    v_cvt_pk_bf16_f32 v65, v118, v119
    v_mul_f32 v122, v122, v176
    v_mfma_f32_32x32x16_bf16 v[240:255], a[240:243], a[8:11], v[240:255]
    ds_read_b128 a[240:243], v2 offset:61440
    v_exp_f32 v165, v121
    v_fma_f32 v166, v164, 0.5, 1.0
    v_mul_f32 v123, v123, v176
    v_fma_f32 v167, v165, 0.5, 1.0
    v_mfma_f32_32x32x16_bf16 v[240:255], a[244:247], a[12:15], v[240:255]
    buffer_load_dwordx4 v1, s[4:7], s41 offen offset:2048 sc1 lds
    ds_read_b128 a[244:247], v2 offset:62464
    v_fma_f32 v166, v164, v166, 1.0
    v_fma_f32 v167, v165, v167, 1.0
    v_rcp_f32 v166, v166
    v_mfma_f32_32x32x16_bf16 v[240:255], a[248:251], a[16:19], v[240:255]
    ds_read_b128 a[248:251], v2 offset:63488
    v_rcp_f32 v167, v167
    v_fma_f32 v120, -v120, v166, v120
    v_exp_f32 v168, v122
    v_fma_f32 v121, -v121, v167, v121
    v_mfma_f32_32x32x16_bf16 v[240:255], a[252:255], a[20:23], v[240:255]
    s_waitcnt lgkmcnt(6)
    ds_read_b128 a[252:255], v2 offset:64512
    v_cvt_pk_bf16_f32 v66, v120, v121
    v_exp_f32 v169, v123
    v_fma_f32 v170, v168, 0.5, 1.0
    v_mul_f32 v124, v124, v176
    v_mfma_f32_32x32x16_bf16 v[240:255], v[140:143], a[24:27], v[240:255]
    buffer_load_dwordx4 v1, s[4:7], s41 offen offset:3072 sc1 lds
    ds_read_b128 v[140:143], v3 offset:0
    s_add_u32 m0, s42, 77824
    v_fma_f32 v171, v169, 0.5, 1.0
    v_fma_f32 v170, v168, v170, 1.0
    v_fma_f32 v171, v169, v171, 1.0
    v_mfma_f32_32x32x16_bf16 v[240:255], v[144:147], a[28:31], v[240:255]
    ds_read_b128 v[144:147], v3 offset:1024
    v_rcp_f32 v170, v170
    v_rcp_f32 v171, v171
    v_permlane16_swap_b32 v60, v64
    v_mfma_f32_32x32x16_bf16 v[240:255], v[148:151], a[32:35], v[240:255]
    buffer_load_dwordx4 v12, s[4:7], s41 offen offset:0 sc1 lds
    ds_read_b128 v[148:151], v3 offset:2048
    v_fma_f32 v122, -v122, v170, v122
    v_fma_f32 v123, -v123, v171, v123
    v_mul_f32 v125, v125, v176
    v_mfma_f32_32x32x16_bf16 v[240:255], v[152:155], a[36:39], v[240:255]
    ds_read_b128 v[152:155], v3 offset:3072
    v_cvt_pk_bf16_f32 v67, v122, v123
    v_permlane16_swap_b32 v61, v65
    v_permlane16_swap_b32 v62, v66
    v_mul_f32 v126, v126, v176
    v_mfma_f32_32x32x16_bf16 v[240:255], v[156:159], a[40:43], v[240:255]
    ds_read_b128 v[156:159], v3 offset:4096
    v_permlane16_swap_b32 v63, v67
    v_exp_f32 v178, v124
    v_exp_f32 v179, v125
    v_mfma_f32_32x32x16_bf16 v[240:255], v[160:163], a[44:47], v[240:255]
    buffer_load_dwordx4 v12, s[4:7], s41 offen offset:1024 sc1 lds
    ds_read_b128 v[160:163], v3 offset:5120
    v_fma_f32 v180, v178, 0.5, 1.0
    v_fma_f32 v181, v179, 0.5, 1.0
    v_fma_f32 v180, v178, v180, 1.0
    v_fma_f32 v181, v179, v181, 1.0
    v_mfma_f32_32x32x16_bf16 v[240:255], a[224:227], a[48:51], v[240:255]
    s_waitcnt lgkmcnt(6)
    buffer_store_dwordx4 v[60:63], v13, s[4:7], s44 offen offset:2048 sc1
    ds_read_b128 a[224:227], v3 offset:6144
    v_mfma_f32_32x32x16_bf16 v[240:255], a[228:231], a[52:55], v[240:255]
    buffer_store_dwordx4 v[64:67], v13, s[4:7], s44 offen offset:3072 sc1
    ds_read_b128 a[228:231], v3 offset:7168
    v_mfma_f32_32x32x16_bf16 v[240:255], a[232:235], a[56:59], v[240:255]
    s_waitcnt vmcnt(13)
    ds_read_b128 a[232:235], v3 offset:8192
    v_rcp_f32 v180, v180
    v_rcp_f32 v181, v181
    v_mul_f32 v127, v127, v176
    v_fma_f32 v124, -v124, v180, v124
    v_mfma_f32_32x32x16_bf16 v[240:255], a[236:239], a[60:63], v[240:255]
    buffer_atomic_add v10, v8, s[4:7], s28 offen offset:24 sc1
    buffer_load_dwordx4 v12, s[4:7], s41 offen offset:2048 sc1 lds
    ds_read_b128 a[236:239], v3 offset:9216
    v_mfma_f32_32x32x16_bf16 v[240:255], a[240:243], a[64:67], v[240:255]
    ds_read_b128 a[240:243], v3 offset:10240
    v_fma_f32 v125, -v125, v181, v125
    v_exp_f32 v164, v126
    v_cvt_pk_bf16_f32 v68, v124, v125
    v_exp_f32 v165, v127
    v_mfma_f32_32x32x16_bf16 v[240:255], a[244:247], a[68:71], v[240:255]
    ds_read_b128 a[244:247], v3 offset:11264
    v_fma_f32 v166, v164, 0.5, 1.0
    v_fma_f32 v167, v165, 0.5, 1.0
    v_fma_f32 v166, v164, v166, 1.0
    v_fma_f32 v167, v165, v167, 1.0
    v_rcp_f32 v166, v166
    v_mfma_f32_32x32x16_bf16 v[240:255], a[248:251], a[72:75], v[240:255]
    buffer_load_dwordx4 v12, s[4:7], s41 offen offset:3072 sc1 lds
    ds_read_b128 a[248:251], v3 offset:12288
    s_add_u32 m0, s42, 81920
    v_rcp_f32 v167, v167
    v_fma_f32 v126, -v126, v166, v126
    v_mfma_f32_32x32x16_bf16 v[240:255], a[252:255], a[76:79], v[240:255]
    s_waitcnt lgkmcnt(6)
    ds_read_b128 a[252:255], v3 offset:13312
    v_fma_f32 v127, -v127, v167, v127
    v_mul_f32 v128, v128, v176
    v_cvt_pk_bf16_f32 v69, v126, v127
    v_mul_f32 v129, v129, v176
    v_mul_f32 v130, v130, v176
    v_mfma_f32_32x32x16_bf16 v[240:255], v[140:143], a[80:83], v[240:255]
    buffer_load_dwordx4 v13, s[4:7], s41 offen offset:0 sc1 lds
    ds_read_b128 v[140:143], v3 offset:14336
    v_exp_f32 v168, v128
    v_exp_f32 v169, v129
    v_mfma_f32_32x32x16_bf16 v[240:255], v[144:147], a[84:87], v[240:255]
    ds_read_b128 v[144:147], v3 offset:15360
    v_fma_f32 v170, v168, 0.5, 1.0
    v_fma_f32 v171, v169, 0.5, 1.0
    v_fma_f32 v170, v168, v170, 1.0
    v_fma_f32 v171, v169, v171, 1.0
    v_rcp_f32 v170, v170
    v_mfma_f32_32x32x16_bf16 v[240:255], v[148:151], a[88:91], v[240:255]
    ds_read_b128 v[148:151], v3 offset:24576
    v_rcp_f32 v171, v171
    v_fma_f32 v128, -v128, v170, v128
    v_mul_f32 v131, v131, v176
    v_fma_f32 v129, -v129, v171, v129
    v_mfma_f32_32x32x16_bf16 v[240:255], v[152:155], a[92:95], v[240:255]
    buffer_load_dwordx4 a[164:167], v1, s[4:7], s47 offen offset:1024 sc1
    ds_read_b128 v[152:155], v1 offset:0
    v_cvt_pk_bf16_f32 v70, v128, v129
    v_exp_f32 v178, v130
    v_mul_f32 v132, v132, v176
    v_mfma_f32_32x32x16_bf16 v[240:255], v[156:159], a[96:99], v[240:255]
    ds_read_b128 v[156:159], v1 offset:1024
    v_exp_f32 v179, v131
    v_fma_f32 v180, v178, 0.5, 1.0
    v_mul_f32 v133, v133, v176
    v_fma_f32 v181, v179, 0.5, 1.0
    v_fma_f32 v180, v178, v180, 1.0
    v_mfma_f32_32x32x16_bf16 v[240:255], v[160:163], a[100:103], v[240:255]
    ds_read_b128 v[160:163], v1 offset:2048
    v_fma_f32 v181, v179, v181, 1.0
    v_rcp_f32 v180, v180
    v_rcp_f32 v181, v181
    v_mfma_f32_32x32x16_bf16 v[240:255], a[224:227], a[104:107], v[240:255]
    s_waitcnt lgkmcnt(6)
    buffer_load_dwordx4 a[168:171], v1, s[4:7], s45 offen offset:2048 sc1
    ds_read_b128 a[224:227], v1 offset:3072
    v_fma_f32 v130, -v130, v180, v130
    v_fma_f32 v131, -v131, v181, v131
    v_mul_f32 v134, v134, v176
    v_mfma_f32_32x32x16_bf16 v[240:255], a[228:231], a[108:111], v[240:255]
    ds_read_b128 a[228:231], v1 offset:4096
    v_cvt_pk_bf16_f32 v71, v130, v131
    v_exp_f32 v164, v132
    v_exp_f32 v165, v133
    v_mul_f32 v135, v135, v176
    v_mfma_f32_32x32x16_bf16 v[240:255], a[232:235], a[112:115], v[240:255]
    buffer_load_dwordx4 a[172:175], v1, s[4:7], s45 offen offset:3072 sc1
    ds_read_b128 a[232:235], v1 offset:5120
    v_fma_f32 v166, v164, 0.5, 1.0
    v_fma_f32 v167, v165, 0.5, 1.0
    v_fma_f32 v166, v164, v166, 1.0
    v_fma_f32 v167, v165, v167, 1.0
    v_mfma_f32_32x32x16_bf16 v[240:255], a[236:239], a[116:119], v[240:255]
    ds_read_b128 a[236:239], v1 offset:6144
    v_rcp_f32 v166, v166
    v_rcp_f32 v167, v167
    v_mul_f32 v136, v136, v176
    v_mfma_f32_32x32x16_bf16 v[240:255], a[240:243], a[120:123], v[240:255]
    ds_read_b128 a[240:243], v1 offset:7168
    v_fma_f32 v132, -v132, v166, v132
    v_fma_f32 v133, -v133, v167, v133
    v_exp_f32 v168, v134
    v_cvt_pk_bf16_f32 v72, v132, v133
    v_mul_f32 v137, v137, v176
    v_mfma_f32_32x32x16_bf16 v[240:255], a[244:247], a[124:127], v[240:255]
    buffer_load_dwordx4 a[176:179], v1, s[4:7], s46 offen offset:2048 sc1
    ds_read_b128 a[244:247], v1 offset:8192
    v_exp_f32 v169, v135
    v_fma_f32 v170, v168, 0.5, 1.0
    v_mul_f32 v138, v138, v176
    v_mfma_f32_32x32x16_bf16 v[240:255], a[248:251], a[128:131], v[240:255]
    ds_read_b128 a[248:251], v1 offset:9216
    v_fma_f32 v171, v169, 0.5, 1.0
    v_fma_f32 v170, v168, v170, 1.0
    v_fma_f32 v171, v169, v171, 1.0
    v_rcp_f32 v170, v170
    v_mfma_f32_32x32x16_bf16 v[240:255], a[252:255], a[132:135], v[240:255]
    s_waitcnt lgkmcnt(6)
    buffer_load_dwordx4 a[180:183], v1, s[4:7], s46 offen offset:3072 sc1
    ds_read_b128 a[252:255], v1 offset:10240
    v_rcp_f32 v171, v171
    v_fma_f32 v134, -v134, v170, v134
    v_mfma_f32_32x32x16_bf16 v[240:255], v[140:143], a[136:139], v[240:255]
    ds_read_b128 v[140:143], v1 offset:11264
    v_fma_f32 v135, -v135, v171, v135
    v_exp_f32 v178, v136
    v_cvt_pk_bf16_f32 v73, v134, v135
    v_exp_f32 v179, v137
    v_mfma_f32_32x32x16_bf16 v[240:255], v[144:147], a[140:143], v[240:255]
    s_barrier
    ds_read_b128 v[144:147], v1 offset:12288
    s_add_u32 m0, s42, 110592
    s_add_u32 s41, s41, 36864
    v_fma_f32 v180, v178, 0.5, 1.0
    v_mfma_f32_32x32x16_bf16 v[92:107], v[148:151], v[172:175], 0
    buffer_load_dwordx4 v1, s[4:7], s41 offen offset:0 sc1 lds
    ds_read_b128 v[148:151], v1 offset:13312
    s_load_dword s3, s[12:13], 24 glc
    v_fma_f32 v181, v179, 0.5, 1.0
    v_fma_f32 v180, v178, v180, 1.0
    v_fma_f32 v181, v179, v181, 1.0
    v_mfma_f32_32x32x16_bf16 v[92:107], v[152:155], a[0:3], v[92:107]
    ds_read_b128 v[152:155], v1 offset:14336
    v_rcp_f32 v180, v180
    v_rcp_f32 v181, v181
    v_mul_f32 v139, v139, v176
    v_fma_f32 v136, -v136, v180, v136
    v_mfma_f32_32x32x16_bf16 v[92:107], v[156:159], a[4:7], v[92:107]
    ds_read_b128 v[156:159], v1 offset:15360
    v_fma_f32 v137, -v137, v181, v137
    v_exp_f32 v164, v138
    v_cvt_pk_bf16_f32 v74, v136, v137
    v_exp_f32 v165, v139
    v_mfma_f32_32x32x16_bf16 v[92:107], v[160:163], a[8:11], v[92:107]
    buffer_load_dwordx4 v1, s[4:7], s41 offen offset:1024 sc1 lds
    ds_read_b128 v[160:163], v1 offset:16384
    v_fma_f32 v166, v164, 0.5, 1.0
    v_fma_f32 v167, v165, 0.5, 1.0
    v_fma_f32 v166, v164, v166, 1.0
    v_mfma_f32_32x32x16_bf16 v[92:107], a[224:227], a[12:15], v[92:107]
    s_waitcnt lgkmcnt(6)
    ds_read_b128 a[224:227], v1 offset:17408
    v_fma_f32 v167, v165, v167, 1.0
    v_rcp_f32 v166, v166
    v_rcp_f32 v167, v167
    v_mul_f32 v240, v240, v176
    v_mfma_f32_32x32x16_bf16 v[92:107], a[228:231], a[16:19], v[92:107]
    buffer_load_dwordx4 v1, s[4:7], s41 offen offset:2048 sc1 lds
    ds_read_b128 a[228:231], v1 offset:18432
    v_fma_f32 v138, -v138, v166, v138
    v_fma_f32 v139, -v139, v167, v139
    v_permlane16_swap_b32 v68, v72
    v_mfma_f32_32x32x16_bf16 v[92:107], a[232:235], a[20:23], v[92:107]
    ds_read_b128 a[232:235], v1 offset:19456
    v_cvt_pk_bf16_f32 v75, v138, v139
    v_permlane16_swap_b32 v69, v73
    v_permlane16_swap_b32 v70, v74
    v_mfma_f32_32x32x16_bf16 v[92:107], a[236:239], a[24:27], v[92:107]
    ds_read_b128 a[236:239], v1 offset:20480
    v_permlane16_swap_b32 v71, v75
    v_mul_f32 v241, v241, v176
    v_exp_f32 v168, v240
    v_mul_f32 v242, v242, v176
    v_mfma_f32_32x32x16_bf16 v[92:107], a[240:243], a[28:31], v[92:107]
    buffer_load_dwordx4 v1, s[4:7], s41 offen offset:3072 sc1 lds
    ds_read_b128 a[240:243], v1 offset:21504
    s_add_u32 m0, s42, 114688
    v_exp_f32 v169, v241
    v_fma_f32 v170, v168, 0.5, 1.0
    v_mfma_f32_32x32x16_bf16 v[92:107], a[244:247], a[32:35], v[92:107]
    buffer_store_dwordx4 v[68:71], v1, s[4:7], s48 offen offset:0 sc1
    ds_read_b128 a[244:247], v1 offset:22528
    v_mfma_f32_32x32x16_bf16 v[92:107], a[248:251], a[36:39], v[92:107]
    buffer_store_dwordx4 v[72:75], v1, s[4:7], s48 offen offset:1024 sc1
    ds_read_b128 a[248:251], v1 offset:23552
    v_mfma_f32_32x32x16_bf16 v[92:107], a[252:255], a[40:43], v[92:107]
    s_waitcnt lgkmcnt(6)
    ds_read_b128 a[252:255], v1 offset:24576
    v_fma_f32 v171, v169, 0.5, 1.0
    v_fma_f32 v170, v168, v170, 1.0
    v_fma_f32 v171, v169, v171, 1.0
    v_rcp_f32 v170, v170
    v_mul_f32 v243, v243, v176
    v_mfma_f32_32x32x16_bf16 v[92:107], v[140:143], a[44:47], v[92:107]
    buffer_load_dwordx4 v12, s[4:7], s41 offen offset:0 sc1 lds
    ds_read_b128 v[140:143], v1 offset:25600
    v_rcp_f32 v171, v171
    v_fma_f32 v240, -v240, v170, v240
    v_mul_f32 v244, v244, v176
    v_mfma_f32_32x32x16_bf16 v[92:107], v[144:147], a[48:51], v[92:107]
    ds_read_b128 v[144:147], v1 offset:26624
    v_fma_f32 v241, -v241, v171, v241
    v_exp_f32 v178, v242
    v_cvt_pk_bf16_f32 v76, v240, v241
    v_mul_f32 v245, v245, v176
    v_mfma_f32_32x32x16_bf16 v[92:107], v[148:151], a[52:55], v[92:107]
    ds_read_b128 v[148:151], v1 offset:27648
    v_exp_f32 v179, v243
    v_fma_f32 v180, v178, 0.5, 1.0
    v_exp_f32 v164, v244
    v_fma_f32 v181, v179, 0.5, 1.0
    v_mfma_f32_32x32x16_bf16 v[92:107], v[152:155], a[56:59], v[92:107]
    buffer_load_dwordx4 v12, s[4:7], s41 offen offset:1024 sc1 lds
    ds_read_b128 v[152:155], v1 offset:28672
    v_fma_f32 v180, v178, v180, 1.0
    v_fma_f32 v181, v179, v181, 1.0
    v_rcp_f32 v180, v180
    v_mfma_f32_32x32x16_bf16 v[92:107], v[156:159], a[60:63], v[92:107]
    ds_read_b128 v[156:159], v1 offset:29696
    v_rcp_f32 v181, v181
    v_fma_f32 v242, -v242, v180, v242
    v_exp_f32 v165, v245
    v_mfma_f32_32x32x16_bf16 v[92:107], v[160:163], a[64:67], v[92:107]
    s_waitcnt lgkmcnt(0)
    s_cmp_lt_u32 s3, 12
    s_cbranch_scc1 L_inte_chk_29_slow
L_inte_chk_29_back:
    buffer_load_dwordx4 v12, s[4:7], s41 offen offset:2048 sc1 lds
    ds_read_b128 v[160:163], v1 offset:30720
    v_fma_f32 v243, -v243, v181, v243
    v_mfma_f32_32x32x16_bf16 v[92:107], a[224:227], a[68:71], v[92:107]
    ds_read_b128 a[224:227], v1 offset:31744
    v_cvt_pk_bf16_f32 v77, v242, v243
    v_fma_f32 v166, v164, 0.5, 1.0
    v_fma_f32 v167, v165, 0.5, 1.0
    v_fma_f32 v166, v164, v166, 1.0
    v_fma_f32 v167, v165, v167, 1.0
    v_mul_f32 v246, v246, v176
    v_mfma_f32_32x32x16_bf16 v[92:107], a[228:231], a[72:75], v[92:107]
    ds_read_b128 a[228:231], v1 offset:32768
    v_rcp_f32 v166, v166
    v_rcp_f32 v167, v167
    v_mul_f32 v247, v247, v176
    v_fma_f32 v244, -v244, v166, v244
    v_mfma_f32_32x32x16_bf16 v[92:107], a[232:235], a[76:79], v[92:107]
    buffer_load_dwordx4 v12, s[4:7], s41 offen offset:3072 sc1 lds
    ds_read_b128 a[232:235], v1 offset:33792
    s_add_u32 m0, s42, 118784
    v_fma_f32 v245, -v245, v167, v245
    v_mul_f32 v248, v248, v176
    v_mfma_f32_32x32x16_bf16 v[92:107], a[236:239], a[80:83], v[92:107]
    ds_read_b128 a[236:239], v1 offset:34816
    v_cvt_pk_bf16_f32 v78, v244, v245
    v_exp_f32 v168, v246
    v_exp_f32 v169, v247
    v_mul_f32 v249, v249, v176
    v_mfma_f32_32x32x16_bf16 v[92:107], a[240:243], a[84:87], v[92:107]
    buffer_load_dwordx4 v13, s[4:7], s41 offen offset:0 sc1 lds
    ds_read_b128 a[240:243], v1 offset:35840
    v_fma_f32 v170, v168, 0.5, 1.0
    v_fma_f32 v171, v169, 0.5, 1.0
    v_fma_f32 v170, v168, v170, 1.0
    v_fma_f32 v171, v169, v171, 1.0
    v_mfma_f32_32x32x16_bf16 v[92:107], a[244:247], a[88:91], v[92:107]
    ds_read_b128 a[244:247], v1 offset:36864
    v_rcp_f32 v170, v170
    v_rcp_f32 v171, v171
    v_mul_f32 v250, v250, v176
    v_mfma_f32_32x32x16_bf16 v[92:107], a[248:251], a[92:95], v[92:107]
    ds_read_b128 a[248:251], v1 offset:37888
    v_fma_f32 v246, -v246, v170, v246
    v_fma_f32 v247, -v247, v171, v247
    v_exp_f32 v178, v248
    v_cvt_pk_bf16_f32 v79, v246, v247
    v_mul_f32 v251, v251, v176
    v_mfma_f32_32x32x16_bf16 v[92:107], a[252:255], a[96:99], v[92:107]
    s_waitcnt lgkmcnt(6)
    buffer_load_dwordx4 a[184:187], v1, s[4:7], s47 offen offset:2048 sc1
    ds_read_b128 a[252:255], v1 offset:38912
    v_exp_f32 v179, v249
    v_fma_f32 v180, v178, 0.5, 1.0
    v_mfma_f32_32x32x16_bf16 v[92:107], v[140:143], a[100:103], v[92:107]
    ds_read_b128 v[140:143], v1 offset:39936
    v_fma_f32 v181, v179, 0.5, 1.0
    v_fma_f32 v180, v178, v180, 1.0
    v_fma_f32 v181, v179, v181, 1.0
    v_rcp_f32 v180, v180
    v_mfma_f32_32x32x16_bf16 v[92:107], v[144:147], a[104:107], v[92:107]
    ds_read_b128 v[144:147], v1 offset:40960
    v_rcp_f32 v181, v181
    v_fma_f32 v248, -v248, v180, v248
    v_exp_f32 v164, v250
    v_fma_f32 v249, -v249, v181, v249
    v_mfma_f32_32x32x16_bf16 v[92:107], v[148:151], a[108:111], v[92:107]
    buffer_load_dwordx4 a[188:191], v1, s[4:7], s47 offen offset:3072 sc1
    ds_read_b128 v[148:151], v1 offset:41984
    v_cvt_pk_bf16_f32 v80, v248, v249
    v_exp_f32 v165, v251
    v_fma_f32 v166, v164, 0.5, 1.0
    v_mfma_f32_32x32x16_bf16 v[92:107], v[152:155], a[112:115], v[92:107]
    ds_read_b128 v[152:155], v1 offset:43008
    v_fma_f32 v167, v165, 0.5, 1.0
    v_fma_f32 v166, v164, v166, 1.0
    v_fma_f32 v167, v165, v167, 1.0
    v_rcp_f32 v166, v166
    v_mul_f32 v252, v252, v176
    v_mfma_f32_32x32x16_bf16 v[92:107], v[156:159], a[116:119], v[92:107]
    buffer_load_dwordx4 a[192:195], v12, s[4:7], s45 offen offset:0 sc1
    ds_read_b128 v[156:159], v1 offset:44032
    v_rcp_f32 v167, v167
    v_fma_f32 v250, -v250, v166, v250
    v_mfma_f32_32x32x16_bf16 v[92:107], v[160:163], a[120:123], v[92:107]
    ds_read_b128 v[160:163], v1 offset:45056
    v_fma_f32 v251, -v251, v167, v251
    v_mul_f32 v253, v253, v176
    v_cvt_pk_bf16_f32 v81, v250, v251
    v_exp_f32 v168, v252
    v_mul_f32 v254, v254, v176
    v_mfma_f32_32x32x16_bf16 v[92:107], a[224:227], a[124:127], v[92:107]
    s_waitcnt lgkmcnt(9)
    ds_read_b128 a[224:227], v1 offset:46080
    v_exp_f32 v169, v253
    v_fma_f32 v170, v168, 0.5, 1.0
    v_mul_f32 v255, v255, v176
    v_fma_f32 v171, v169, 0.5, 1.0
    v_fma_f32 v170, v168, v170, 1.0
    v_mfma_f32_32x32x16_bf16 v[92:107], a[228:231], a[128:131], v[92:107]
    buffer_load_dwordx4 a[196:199], v12, s[4:7], s45 offen offset:1024 sc1
    ds_read_b128 a[228:231], v1 offset:47104
    v_fma_f32 v171, v169, v171, 1.0
    v_rcp_f32 v170, v170
    v_mfma_f32_32x32x16_bf16 v[92:107], a[232:235], a[132:135], v[92:107]
    ds_read_b128 a[232:235], v1 offset:48128
    v_rcp_f32 v171, v171
    v_fma_f32 v252, -v252, v170, v252
    v_exp_f32 v178, v254
    v_fma_f32 v253, -v253, v171, v253
    v_mfma_f32_32x32x16_bf16 v[92:107], a[236:239], a[136:139], v[92:107]
    buffer_load_dwordx4 a[200:203], v12, s[4:7], s46 offen offset:0 sc1
    ds_read_b128 a[236:239], v1 offset:49152
    v_cvt_pk_bf16_f32 v82, v252, v253
    v_exp_f32 v179, v255
    v_fma_f32 v180, v178, 0.5, 1.0
    v_mfma_f32_32x32x16_bf16 v[92:107], a[240:243], a[140:143], v[92:107]
    s_waitcnt lgkmcnt(9)
    s_waitcnt vmcnt(21)
    s_barrier
    ds_read_b128 a[240:243], v1 offset:50176
    s_add_u32 m0, s42, 0
    s_add_u32 s41, s41, 36864
    v_mfma_f32_16x16x32_bf16 v[184:187], a[244:247], v[20:23], 0
    v_fma_f32 v181, v179, 0.5, 1.0
    v_fma_f32 v180, v178, v180, 1.0
    v_mfma_f32_16x16x32_bf16 v[184:187], a[248:251], v[28:31], v[184:187]
    v_fma_f32 v181, v179, v181, 1.0
    v_mfma_f32_16x16x32_bf16 v[184:187], a[252:255], v[36:39], v[184:187]
    buffer_load_dwordx4 v1, s[4:7], s41 offen offset:0 sc1 lds
    v_mfma_f32_16x16x32_bf16 v[184:187], v[140:143], v[44:47], v[184:187]
    v_rcp_f32 v180, v180
    v_mfma_f32_16x16x32_bf16 v[188:191], v[140:143], v[48:51], 0
    s_waitcnt vmcnt(11)
    v_rcp_f32 v181, v181
    v_mfma_f32_16x16x32_bf16 v[188:191], a[252:255], v[40:43], v[188:191]
    buffer_atomic_add v10, v8, s[4:7], s28 offen offset:28 sc1
    v_mfma_f32_16x16x32_bf16 v[188:191], a[248:251], v[32:35], v[188:191]
    v_fma_f32 v254, -v254, v180, v254
    v_fma_f32 v255, -v255, v181, v255
    v_mfma_f32_16x16x32_bf16 v[188:191], a[244:247], v[24:27], v[188:191]
    s_waitcnt lgkmcnt(6)
    ds_read_b128 a[244:247], v1 offset:51200
    ds_read_b128 a[248:251], v1 offset:52224
    v_cvt_pk_bf16_f32 v83, v254, v255
    v_mfma_f32_16x16x32_bf16 v[196:199], v[144:147], v[24:27], 0
    buffer_load_dwordx4 v1, s[4:7], s41 offen offset:1024 sc1 lds
    v_mfma_f32_16x16x32_bf16 v[196:199], v[148:151], v[32:35], v[196:199]
    v_permlane16_swap_b32 v76, v80
    v_mfma_f32_16x16x32_bf16 v[196:199], v[152:155], v[40:43], v[196:199]
    v_permlane16_swap_b32 v77, v81
    v_mul_f32 v92, v92, v176
    v_mfma_f32_16x16x32_bf16 v[196:199], v[156:159], v[48:51], v[196:199]
    ds_read_b128 a[252:255], v1 offset:53248
    ds_read_b128 v[140:143], v1 offset:54272
    v_mfma_f32_16x16x32_bf16 v[192:195], v[156:159], v[44:47], 0
    v_permlane16_swap_b32 v78, v82
    v_mul_f32 v93, v93, v176
    v_mfma_f32_16x16x32_bf16 v[192:195], v[152:155], v[36:39], v[192:195]
    buffer_load_dwordx4 v1, s[4:7], s41 offen offset:2048 sc1 lds
    v_mfma_f32_16x16x32_bf16 v[192:195], v[148:151], v[28:31], v[192:195]
    v_permlane16_swap_b32 v79, v83
    v_mfma_f32_16x16x32_bf16 v[192:195], v[144:147], v[20:23], v[192:195]
    s_waitcnt lgkmcnt(6)
    ds_read_b128 v[144:147], v1 offset:55296
    ds_read_b128 v[148:151], v1 offset:56320
    v_mul_f32 v94, v94, v176
    v_mfma_f32_16x16x32_bf16 v[200:203], v[160:163], v[20:23], 0
    buffer_store_dwordx4 v[76:79], v1, s[4:7], s48 offen offset:2048 sc1
    v_mfma_f32_16x16x32_bf16 v[200:203], a[224:227], v[28:31], v[200:203]
    buffer_store_dwordx4 v[80:83], v1, s[4:7], s48 offen offset:3072 sc1
    v_mfma_f32_16x16x32_bf16 v[200:203], a[228:231], v[36:39], v[200:203]
    v_exp_f32 v164, v92
    v_mfma_f32_16x16x32_bf16 v[200:203], a[232:235], v[44:47], v[200:203]
    ds_read_b128 v[152:155], v1 offset:57344
    ds_read_b128 v[156:159], v1 offset:58368
    v_mfma_f32_16x16x32_bf16 v[204:207], a[232:235], v[48:51], 0
    buffer_load_dwordx4 v1, s[4:7], s41 offen offset:3072 sc1 lds
    s_add_u32 m0, s42, 4096
    v_mfma_f32_16x16x32_bf16 v[204:207], a[228:231], v[40:43], v[204:207]
    v_exp_f32 v165, v93
    v_mfma_f32_16x16x32_bf16 v[204:207], a[224:227], v[32:35], v[204:207]
    v_fma_f32 v166, v164, 0.5, 1.0
    v_fma_f32 v167, v165, 0.5, 1.0
    v_fma_f32 v166, v164, v166, 1.0
    v_mfma_f32_16x16x32_bf16 v[204:207], v[160:163], v[24:27], v[204:207]
    s_waitcnt lgkmcnt(6)
    ds_read_b128 v[160:163], v1 offset:59392
    ds_read_b128 a[224:227], v1 offset:60416
    v_mfma_f32_16x16x32_bf16 v[212:215], a[236:239], v[24:27], 0
    v_fma_f32 v167, v165, v167, 1.0
    v_mul_f32 v95, v95, v176
    v_mfma_f32_16x16x32_bf16 v[212:215], a[240:243], v[32:35], v[212:215]
    buffer_load_dwordx4 v12, s[4:7], s41 offen offset:0 sc1 lds
    v_mul_f32 v96, v96, v176
    v_mfma_f32_16x16x32_bf16 v[212:215], a[244:247], v[40:43], v[212:215]
    v_rcp_f32 v166, v166
    v_mfma_f32_16x16x32_bf16 v[212:215], a[248:251], v[48:51], v[212:215]
    ds_read_b128 a[228:231], v1 offset:61440
    ds_read_b128 a[232:235], v1 offset:62464
    v_fma_f32 v92, -v92, v166, v92
    v_mfma_f32_16x16x32_bf16 v[208:211], a[248:251], v[44:47], 0
    v_rcp_f32 v167, v167
    v_mfma_f32_16x16x32_bf16 v[208:211], a[244:247], v[36:39], v[208:211]
    v_exp_f32 v168, v94
    v_mfma_f32_16x16x32_bf16 v[208:211], a[240:243], v[28:31], v[208:211]
    buffer_load_dwordx4 v12, s[4:7], s41 offen offset:1024 sc1 lds
    v_fma_f32 v93, -v93, v167, v93
    v_mfma_f32_16x16x32_bf16 v[208:211], a[236:239], v[20:23], v[208:211]
    s_waitcnt lgkmcnt(6)
    ds_read_b128 a[236:239], v1 offset:63488
    ds_read_b128 a[240:243], v1 offset:64512
    v_mfma_f32_16x16x32_bf16 v[216:219], a[252:255], v[20:23], 0
    v_cvt_pk_bf16_f32 v84, v92, v93
    v_fma_f32 v170, v168, 0.5, 1.0
    v_mfma_f32_16x16x32_bf16 v[216:219], v[140:143], v[28:31], v[216:219]
    v_exp_f32 v169, v95
    v_fma_f32 v170, v168, v170, 1.0
    v_mfma_f32_16x16x32_bf16 v[216:219], v[144:147], v[36:39], v[216:219]
    v_fma_f32 v171, v169, 0.5, 1.0
    v_mul_f32 v97, v97, v176
    v_mfma_f32_16x16x32_bf16 v[216:219], v[148:151], v[44:47], v[216:219]
    ds_read_b128 a[244:247], v2 offset:0
    ds_read_b128 a[248:251], v2 offset:1024
    v_fma_f32 v171, v169, v171, 1.0
    v_mfma_f32_16x16x32_bf16 v[220:223], v[148:151], v[48:51], 0
    buffer_load_dwordx4 v12, s[4:7], s41 offen offset:2048 sc1 lds
    v_mfma_f32_16x16x32_bf16 v[220:223], v[144:147], v[40:43], v[220:223]
    v_rcp_f32 v170, v170
    v_mfma_f32_16x16x32_bf16 v[220:223], v[140:143], v[32:35], v[220:223]
    v_rcp_f32 v171, v171
    v_fma_f32 v94, -v94, v170, v94
    v_mfma_f32_16x16x32_bf16 v[220:223], a[252:255], v[24:27], v[220:223]
    s_waitcnt lgkmcnt(6)
    ds_read_b128 a[252:255], v2 offset:2048
    ds_read_b128 v[140:143], v2 offset:3072
    v_mfma_f32_16x16x32_bf16 v[236:239], v[152:155], v[24:27], 0
    buffer_load_dwordx4 v12, s[4:7], s41 offen offset:3072 sc1 lds
    s_add_u32 m0, s42, 8192
    v_mfma_f32_16x16x32_bf16 v[236:239], v[156:159], v[32:35], v[236:239]
    v_fma_f32 v95, -v95, v171, v95
    v_mul_f32 v98, v98, v176
    v_mfma_f32_16x16x32_bf16 v[236:239], v[160:163], v[40:43], v[236:239]
    s_load_dword s3, s[12:13], 28 glc
    v_cvt_pk_bf16_f32 v85, v94, v95
    v_mul_f32 v99, v99, v176
    v_mfma_f32_16x16x32_bf16 v[236:239], a[224:227], v[48:51], v[236:239]
    ds_read_b128 v[144:147], v2 offset:4096
    ds_read_b128 v[148:151], v2 offset:5120
    v_mul_f32 v100, v100, v176
    v_mfma_f32_16x16x32_bf16 v[232:235], a[224:227], v[44:47], 0
    v_exp_f32 v178, v96
    v_mfma_f32_16x16x32_bf16 v[232:235], v[160:163], v[36:39], v[232:235]
    buffer_load_dwordx4 v13, s[4:7], s41 offen offset:0 sc1 lds
    v_fma_f32 v180, v178, 0.5, 1.0
    v_mfma_f32_16x16x32_bf16 v[232:235], v[156:159], v[28:31], v[232:235]
    v_exp_f32 v179, v97
    v_mfma_f32_16x16x32_bf16 v[232:235], v[152:155], v[20:23], v[232:235]
    s_waitcnt lgkmcnt(6)
    ds_read_b128 v[152:155], v2 offset:6144
    ds_read_b128 v[156:159], v2 offset:7168
    v_mfma_f32_16x16x32_bf16 v[184:187], a[228:231], v[52:55], v[184:187]
    v_fma_f32 v181, v179, 0.5, 1.0
    v_fma_f32 v180, v178, v180, 1.0
    v_fma_f32 v181, v179, v181, 1.0
    v_mfma_f32_16x16x32_bf16 v[184:187], a[232:235], v[60:63], v[184:187]
    v_rcp_f32 v180, v180
    v_mfma_f32_16x16x32_bf16 v[184:187], a[236:239], v[68:71], v[184:187]
    v_rcp_f32 v181, v181
    v_fma_f32 v96, -v96, v180, v96
    v_mfma_f32_16x16x32_bf16 v[184:187], a[240:243], a[144:147], v[184:187]
    ds_read_b128 v[160:163], v2 offset:8192
    ds_read_b128 a[224:227], v2 offset:9216
    v_mfma_f32_16x16x32_bf16 v[188:191], a[240:243], a[148:151], v[188:191]
    buffer_load_dwordx4 a[204:207], v12, s[4:7], s46 offen offset:1024 sc1
    v_mfma_f32_16x16x32_bf16 v[188:191], a[236:239], v[72:75], v[188:191]
    v_fma_f32 v97, -v97, v181, v97
    v_exp_f32 v164, v98
    v_mfma_f32_16x16x32_bf16 v[188:191], a[232:235], v[64:67], v[188:191]
    v_cvt_pk_bf16_f32 v86, v96, v97
    v_fma_f32 v166, v164, 0.5, 1.0
    v_mfma_f32_16x16x32_bf16 v[188:191], a[228:231], v[56:59], v[188:191]
    s_waitcnt lgkmcnt(6)
    ds_read_b128 a[228:231], v2 offset:10240
    ds_read_b128 a[232:235], v2 offset:11264
    v_mfma_f32_16x16x32_bf16 v[196:199], a[244:247], v[56:59], v[196:199]
    buffer_load_dwordx4 a[208:211], v12, s[4:7], s47 offen offset:0 sc1
    v_fma_f32 v166, v164, v166, 1.0
    v_mfma_f32_16x16x32_bf16 v[196:199], a[248:251], v[64:67], v[196:199]
    v_exp_f32 v165, v99
    v_mfma_f32_16x16x32_bf16 v[196:199], a[252:255], v[72:75], v[196:199]
    v_rcp_f32 v166, v166
    v_fma_f32 v167, v165, 0.5, 1.0
    v_mfma_f32_16x16x32_bf16 v[196:199], v[140:143], a[148:151], v[196:199]
    ds_read_b128 a[236:239], v2 offset:12288
    ds_read_b128 a[240:243], v2 offset:13312
    v_mfma_f32_16x16x32_bf16 v[192:195], v[140:143], a[144:147], v[192:195]
    v_fma_f32 v167, v165, v167, 1.0
    v_fma_f32 v98, -v98, v166, v98
    v_mfma_f32_16x16x32_bf16 v[192:195], a[252:255], v[68:71], v[192:195]
    buffer_load_dwordx4 a[212:215], v12, s[4:7], s47 offen offset:1024 sc1
    v_mul_f32 v101, v101, v176
    v_mfma_f32_16x16x32_bf16 v[192:195], a[248:251], v[60:63], v[192:195]
    v_rcp_f32 v167, v167
    v_mfma_f32_16x16x32_bf16 v[192:195], a[244:247], v[52:55], v[192:195]
    s_waitcnt lgkmcnt(6)
    ds_read_b128 a[244:247], v2 offset:14336
    ds_read_b128 a[248:251], v2 offset:15360
    v_fma_f32 v99, -v99, v167, v99
    v_mfma_f32_16x16x32_bf16 v[200:203], v[144:147], v[52:55], v[200:203]
    v_cvt_pk_bf16_f32 v87, v98, v99
    v_mul_f32 v102, v102, v176
    v_mfma_f32_16x16x32_bf16 v[200:203], v[148:151], v[60:63], v[200:203]
    v_exp_f32 v168, v100
    v_mfma_f32_16x16x32_bf16 v[200:203], v[152:155], v[68:71], v[200:203]
    buffer_load_dwordx4 a[216:219], v12, s[4:7], s45 offen offset:2048 sc1
    v_fma_f32 v170, v168, 0.5, 1.0
    v_mfma_f32_16x16x32_bf16 v[200:203], v[156:159], a[144:147], v[200:203]
    ds_read_b128 a[252:255], v2 offset:16384
    ds_read_b128 v[140:143], v2 offset:17408
    v_mfma_f32_16x16x32_bf16 v[204:207], v[156:159], a[148:151], v[204:207]
    s_waitcnt vmcnt(21)
    s_barrier
    s_add_u32 m0, s42, 36864
    v_mfma_f32_16x16x32_bf16 v[204:207], v[152:155], v[72:75], v[204:207]
    s_add_u32 s41, s41, 36864
    v_exp_f32 v169, v101
    v_mfma_f32_16x16x32_bf16 v[204:207], v[148:151], v[64:67], v[204:207]
    v_fma_f32 v170, v168, v170, 1.0
    v_fma_f32 v171, v169, 0.5, 1.0
    v_mfma_f32_16x16x32_bf16 v[204:207], v[144:147], v[56:59], v[204:207]
    s_waitcnt lgkmcnt(6)
    ds_read_b128 v[144:147], v2 offset:18432
    ds_read_b128 v[148:151], v2 offset:19456
    v_fma_f32 v171, v169, v171, 1.0
    v_mfma_f32_16x16x32_bf16 v[212:215], v[160:163], v[56:59], v[212:215]
    buffer_load_dwordx4 v1, s[4:7], s41 offen offset:0 sc1 lds
    v_mfma_f32_16x16x32_bf16 v[212:215], a[224:227], v[64:67], v[212:215]
    s_waitcnt vmcnt(11)
    v_rcp_f32 v170, v170
    v_mul_f32 v103, v103, v176
    v_mfma_f32_16x16x32_bf16 v[212:215], a[228:231], v[72:75], v[212:215]
    buffer_atomic_add v10, v8, s[4:7], s28 offen offset:32 sc1
    v_mfma_f32_16x16x32_bf16 v[212:215], a[232:235], a[148:151], v[212:215]
    ds_read_b128 v[152:155], v2 offset:20480
    ds_read_b128 v[156:159], v2 offset:21504
    v_mfma_f32_16x16x32_bf16 v[208:211], a[232:235], a[144:147], v[208:211]
    v_rcp_f32 v171, v171
    v_fma_f32 v100, -v100, v170, v100
    v_mfma_f32_16x16x32_bf16 v[208:211], a[228:231], v[68:71], v[208:211]
    buffer_load_dwordx4 v1, s[4:7], s41 offen offset:1024 sc1 lds
    v_mfma_f32_16x16x32_bf16 v[208:211], a[224:227], v[60:63], v[208:211]
    s_waitcnt lgkmcnt(0)
    s_cmp_lt_u32 s3, 12
    s_cbranch_scc1 L_inte_chk_30_slow
L_inte_chk_30_back:
    v_fma_f32 v101, -v101, v171, v101
    v_mfma_f32_16x16x32_bf16 v[208:211], v[160:163], v[52:55], v[208:211]
    ds_read_b128 v[160:163], v2 offset:22528
    ds_read_b128 a[224:227], v2 offset:23552
    v_mfma_f32_16x16x32_bf16 v[216:219], a[236:239], v[52:55], v[216:219]
    v_cvt_pk_bf16_f32 v88, v100, v101
    v_mul_f32 v104, v104, v176
    v_mfma_f32_16x16x32_bf16 v[216:219], a[240:243], v[60:63], v[216:219]
    v_exp_f32 v178, v102
    v_mul_f32 v105, v105, v176
    v_mfma_f32_16x16x32_bf16 v[216:219], a[244:247], v[68:71], v[216:219]
    buffer_load_dwordx4 v1, s[4:7], s41 offen offset:2048 sc1 lds
    v_mfma_f32_16x16x32_bf16 v[216:219], a[248:251], a[144:147], v[216:219]
    ds_read_b128 a[228:231], v2 offset:24576
    ds_read_b128 a[232:235], v2 offset:25600
    v_mfma_f32_16x16x32_bf16 v[220:223], a[248:251], a[148:151], v[220:223]
    v_exp_f32 v179, v103
    v_fma_f32 v180, v178, 0.5, 1.0
    v_mfma_f32_16x16x32_bf16 v[220:223], a[244:247], v[72:75], v[220:223]
    v_fma_f32 v181, v179, 0.5, 1.0
    v_fma_f32 v180, v178, v180, 1.0
    v_mfma_f32_16x16x32_bf16 v[220:223], a[240:243], v[64:67], v[220:223]
    v_fma_f32 v181, v179, v181, 1.0
    v_rcp_f32 v180, v180
    v_mfma_f32_16x16x32_bf16 v[220:223], a[236:239], v[56:59], v[220:223]
    ds_read_b128 a[236:239], v2 offset:26624
    ds_read_b128 a[240:243], v2 offset:27648
    v_mfma_f32_16x16x32_bf16 v[236:239], a[252:255], v[56:59], v[236:239]
    buffer_load_dwordx4 v1, s[4:7], s41 offen offset:3072 sc1 lds
    v_mfma_f32_16x16x32_bf16 v[236:239], v[140:143], v[64:67], v[236:239]
    s_add_u32 m0, s42, 40960
    v_rcp_f32 v181, v181
    v_fma_f32 v102, -v102, v180, v102
    v_mfma_f32_16x16x32_bf16 v[236:239], v[144:147], v[72:75], v[236:239]
    v_fma_f32 v103, -v103, v181, v103
    v_mul_f32 v106, v106, v176
    v_mfma_f32_16x16x32_bf16 v[236:239], v[148:151], a[148:151], v[236:239]
    ds_read_b128 a[244:247], v2 offset:28672
    ds_read_b128 a[248:251], v2 offset:29696
    v_cvt_pk_bf16_f32 v89, v102, v103
    v_mfma_f32_16x16x32_bf16 v[232:235], v[148:151], a[144:147], v[232:235]
    buffer_load_dwordx4 v12, s[4:7], s41 offen offset:0 sc1 lds
    v_mfma_f32_16x16x32_bf16 v[232:235], v[144:147], v[68:71], v[232:235]
    v_exp_f32 v164, v104
    v_mfma_f32_16x16x32_bf16 v[232:235], v[140:143], v[60:63], v[232:235]
    v_exp_f32 v165, v105
    v_fma_f32 v166, v164, 0.5, 1.0
    v_mfma_f32_16x16x32_bf16 v[232:235], a[252:255], v[52:55], v[232:235]
    s_waitcnt lgkmcnt(6)
    ds_read_b128 a[252:255], v2 offset:30720
    ds_read_b128 v[140:143], v2 offset:31744
    v_mfma_f32_16x16x32_bf16 v[184:187], v[152:155], a[152:155], v[184:187]
    v_fma_f32 v167, v165, 0.5, 1.0
    v_fma_f32 v166, v164, v166, 1.0
    v_fma_f32 v167, v165, v167, 1.0
    v_mfma_f32_16x16x32_bf16 v[184:187], v[156:159], a[160:163], v[184:187]
    buffer_load_dwordx4 v12, s[4:7], s41 offen offset:1024 sc1 lds
    v_mfma_f32_16x16x32_bf16 v[184:187], v[160:163], a[168:171], v[184:187]
    v_rcp_f32 v166, v166
    v_mfma_f32_16x16x32_bf16 v[184:187], a[224:227], a[176:179], v[184:187]
    ds_read_b128 v[144:147], v2 offset:32768
    ds_read_b128 v[148:151], v2 offset:33792
    v_fma_f32 v104, -v104, v166, v104
    v_mfma_f32_16x16x32_bf16 v[188:191], a[224:227], a[180:183], v[188:191]
    v_rcp_f32 v167, v167
    v_mfma_f32_16x16x32_bf16 v[188:191], v[160:163], a[172:175], v[188:191]
    v_mul_f32 v107, v107, v176
    v_fma_f32 v105, -v105, v167, v105
    v_cvt_pk_bf16_f32 v90, v104, v105
    v_mfma_f32_16x16x32_bf16 v[188:191], v[156:159], a[164:167], v[188:191]
    buffer_load_dwordx4 a[220:223], v12, s[4:7], s45 offen offset:3072 sc1
    v_mfma_f32_16x16x32_bf16 v[188:191], v[152:155], a[156:159], v[188:191]
    s_waitcnt lgkmcnt(6)
    ds_read_b128 v[152:155], v2 offset:34816
    ds_read_b128 v[156:159], v2 offset:35840
    v_mfma_f32_16x16x32_bf16 v[196:199], a[228:231], a[156:159], v[196:199]
    v_exp_f32 v168, v106
    v_mfma_f32_16x16x32_bf16 v[196:199], a[232:235], a[164:167], v[196:199]
    v_exp_f32 v169, v107
    v_mfma_f32_16x16x32_bf16 v[196:199], a[236:239], a[172:175], v[196:199]
    v_fma_f32 v170, v168, 0.5, 1.0
    v_fma_f32 v171, v169, 0.5, 1.0
    v_mfma_f32_16x16x32_bf16 v[196:199], a[240:243], a[180:183], v[196:199]
    ds_read_b128 v[160:163], v2 offset:36864
    ds_read_b128 a[224:227], v2 offset:37888
    v_mfma_f32_16x16x32_bf16 v[192:195], a[240:243], a[176:179], v[192:195]
    buffer_load_dwordx4 v12, s[4:7], s41 offen offset:2048 sc1 lds
    v_mfma_f32_16x16x32_bf16 v[192:195], a[236:239], a[168:171], v[192:195]
    v_fma_f32 v170, v168, v170, 1.0
    v_fma_f32 v171, v169, v171, 1.0
    v_mfma_f32_16x16x32_bf16 v[192:195], a[232:235], a[160:163], v[192:195]
    v_rcp_f32 v170, v170
    v_mfma_f32_16x16x32_bf16 v[192:195], a[228:231], a[152:155], v[192:195]
    s_waitcnt lgkmcnt(6)
    ds_read_b128 a[228:231], v2 offset:38912
    ds_read_b128 a[232:235], v2 offset:39936
    v_mfma_f32_16x16x32_bf16 v[200:203], a[244:247], a[152:155], v[200:203]
    v_rcp_f32 v171, v171
    v_mfma_f32_16x16x32_bf16 v[200:203], a[248:251], a[160:163], v[200:203]
    buffer_load_dwordx4 a[0:3], v12, s[4:7], s46 offen offset:2048 sc1
    v_mfma_f32_16x16x32_bf16 v[200:203], a[252:255], a[168:171], v[200:203]
    v_fma_f32 v106, -v106, v170, v106
    v_fma_f32 v107, -v107, v171, v107
    v_mfma_f32_16x16x32_bf16 v[200:203], v[140:143], a[176:179], v[200:203]
    s_load_dword s3, s[12:13], 32 glc
    ds_read_b128 a[236:239], v2 offset:40960
    ds_read_b128 a[240:243], v2 offset:41984
    v_mfma_f32_16x16x32_bf16 v[204:207], v[140:143], a[180:183], v[204:207]
    v_cvt_pk_bf16_f32 v91, v106, v107
    v_mfma_f32_16x16x32_bf16 v[204:207], a[252:255], a[172:175], v[204:207]
    v_permlane16_swap_b32 v84, v88
    v_mfma_f32_16x16x32_bf16 v[204:207], a[248:251], a[164:167], v[204:207]
    v_permlane16_swap_b32 v85, v89
    v_mfma_f32_16x16x32_bf16 v[204:207], a[244:247], a[156:159], v[204:207]
    s_waitcnt lgkmcnt(6)
    ds_read_b128 a[244:247], v2 offset:43008
    ds_read_b128 a[248:251], v2 offset:44032
    v_mfma_f32_16x16x32_bf16 v[212:215], v[144:147], a[156:159], v[212:215]
    buffer_load_dwordx4 a[4:7], v12, s[4:7], s46 offen offset:3072 sc1
    v_mfma_f32_16x16x32_bf16 v[212:215], v[148:151], a[164:167], v[212:215]
    v_permlane16_swap_b32 v86, v90
    v_mfma_f32_16x16x32_bf16 v[212:215], v[152:155], a[172:175], v[212:215]
    v_permlane16_swap_b32 v87, v91
    v_mfma_f32_16x16x32_bf16 v[212:215], v[156:159], a[180:183], v[212:215]
    ds_read_b128 a[252:255], v2 offset:45056
    ds_read_b128 v[140:143], v2 offset:46080
    v_mfma_f32_16x16x32_bf16 v[208:211], v[156:159], a[176:179], v[208:211]
    buffer_load_dwordx4 a[8:11], v12, s[4:7], s47 offen offset:2048 sc1
    v_mfma_f32_16x16x32_bf16 v[208:211], v[152:155], a[168:171], v[208:211]
    buffer_store_dwordx4 v[84:87], v12, s[4:7], s48 offen offset:0 sc1
    v_mfma_f32_16x16x32_bf16 v[208:211], v[148:151], a[160:163], v[208:211]
    buffer_store_dwordx4 v[88:91], v12, s[4:7], s48 offen offset:1024 sc1
    v_mfma_f32_16x16x32_bf16 v[208:211], v[144:147], a[152:155], v[208:211]
    s_waitcnt lgkmcnt(6)
    ds_read_b128 v[144:147], v2 offset:47104
    ds_read_b128 v[148:151], v2 offset:48128
    v_mfma_f32_16x16x32_bf16 v[216:219], v[160:163], a[152:155], v[216:219]
    s_lshl_b32 s30, s16, 2
    s_add_u32 s30, s30, s19
    s_mul_i32 s31, s30, 98304
    v_mfma_f32_16x16x32_bf16 v[216:219], a[224:227], a[160:163], v[216:219]
    s_add_u32 s31, s31, s21
    s_add_u32 s31, s31, 42336256
    s_lshl_b32 s32, s20, 11
    v_mfma_f32_16x16x32_bf16 v[216:219], a[228:231], a[168:171], v[216:219]
    buffer_load_dwordx4 a[12:15], v12, s[4:7], s47 offen offset:3072 sc1
    v_mfma_f32_16x16x32_bf16 v[216:219], a[232:235], a[176:179], v[216:219]
    s_add_u32 s31, s31, s32
    ds_read_b128 v[152:155], v2 offset:49152
    ds_read_b128 v[156:159], v2 offset:50176
    v_mfma_f32_16x16x32_bf16 v[220:223], a[232:235], a[180:183], v[220:223]
    s_mul_i32 s33, s30, 12288
    s_add_u32 s33, s33, s21
    s_add_u32 s33, s33, 48627712
    v_mfma_f32_16x16x32_bf16 v[220:223], a[228:231], a[172:175], v[220:223]
    s_mul_i32 s32, s20, 3072
    s_add_u32 s33, s33, s32
    s_sub_u32 s32, s20, s18
    v_mfma_f32_16x16x32_bf16 v[220:223], a[224:227], a[164:167], v[220:223]
    buffer_load_dwordx4 a[16:19], v13, s[4:7], s45 offen offset:0 sc1
    v_mfma_f32_16x16x32_bf16 v[220:223], v[160:163], a[156:159], v[220:223]
    s_waitcnt lgkmcnt(6)
    ds_read_b128 v[160:163], v2 offset:51200
    ds_read_b128 a[224:227], v2 offset:52224
    v_mfma_f32_16x16x32_bf16 v[236:239], a[236:239], a[156:159], v[236:239]
    s_sub_u32 s32, s32, 1
    s_and_b32 s32, s32, 3
    s_lshl_b32 s32, s32, 10
    v_mfma_f32_16x16x32_bf16 v[236:239], a[240:243], a[164:167], v[236:239]
    s_add_u32 s34, s33, s32
    s_mul_i32 s32, s18, 24576
    s_add_u32 s35, s31, s32
    v_mfma_f32_16x16x32_bf16 v[236:239], a[244:247], a[172:175], v[236:239]
    s_nop 0
    v_mfma_f32_16x16x32_bf16 v[236:239], a[248:251], a[180:183], v[236:239]
    ds_read_b128 a[228:231], v2 offset:53248
    ds_read_b128 a[232:235], v2 offset:54272
    v_mfma_f32_16x16x32_bf16 v[232:235], a[248:251], a[176:179], v[232:235]
    s_waitcnt vmcnt(20)
    s_barrier
    v_mfma_f32_16x16x32_bf16 v[232:235], a[244:247], a[168:171], v[232:235]
    buffer_load_dwordx4 a[20:23], v13, s[4:7], s45 offen offset:1024 sc1
    v_mfma_f32_16x16x32_bf16 v[232:235], a[240:243], a[160:163], v[232:235]
    v_mfma_f32_16x16x32_bf16 v[232:235], a[236:239], a[152:155], v[232:235]
    s_waitcnt lgkmcnt(6)
    s_waitcnt vmcnt(18)
    ds_read_b128 a[236:239], v2 offset:55296
    ds_read_b128 a[240:243], v2 offset:56320
    v_mfma_f32_16x16x32_bf16 v[184:187], a[252:255], a[184:187], v[184:187]
    buffer_load_dwordx4 v12, s[4:7], s41 offen offset:3072 sc1 lds
    v_mfma_f32_16x16x32_bf16 v[184:187], v[140:143], a[192:195], v[184:187]
    s_add_u32 m0, s42, 45056
    v_mfma_f32_16x16x32_bf16 v[184:187], v[144:147], a[200:203], v[184:187]
    v_mfma_f32_16x16x32_bf16 v[184:187], v[148:151], a[208:211], v[184:187]
    ds_read_b128 a[244:247], v2 offset:57344
    ds_read_b128 a[248:251], v2 offset:58368
    v_mfma_f32_16x16x32_bf16 v[188:191], v[148:151], a[212:215], v[188:191]
    buffer_load_dwordx4 v13, s[4:7], s41 offen offset:0 sc1 lds
    v_mfma_f32_16x16x32_bf16 v[188:191], v[144:147], a[204:207], v[188:191]
    s_add_u32 m0, s42, 73728
    s_add_u32 s41, s41, 36864
    v_mfma_f32_16x16x32_bf16 v[188:191], v[140:143], a[196:199], v[188:191]
    s_waitcnt lgkmcnt(0)
    s_cmp_lt_u32 s3, 12
    s_cbranch_scc1 L_inte_chk_31_slow
L_inte_chk_31_back:
    v_mfma_f32_16x16x32_bf16 v[188:191], a[252:255], a[188:191], v[188:191]
    ds_read_b128 a[252:255], v2 offset:59392
    ds_read_b128 v[140:143], v2 offset:60416
    v_mfma_f32_16x16x32_bf16 v[196:199], v[152:155], a[188:191], v[196:199]
    buffer_load_dwordx4 v1, s[4:7], s41 offen offset:0 sc1 lds
    v_mfma_f32_16x16x32_bf16 v[196:199], v[156:159], a[196:199], v[196:199]
    v_mfma_f32_16x16x32_bf16 v[196:199], v[160:163], a[204:207], v[196:199]
    v_mfma_f32_16x16x32_bf16 v[196:199], a[224:227], a[212:215], v[196:199]
    ds_read_b128 v[144:147], v2 offset:61440
    ds_read_b128 v[148:151], v2 offset:62464
    v_mfma_f32_16x16x32_bf16 v[192:195], a[224:227], a[208:211], v[192:195]
    v_mfma_f32_16x16x32_bf16 v[192:195], v[160:163], a[200:203], v[192:195]
    buffer_load_dwordx4 v1, s[4:7], s41 offen offset:1024 sc1 lds
    v_mfma_f32_16x16x32_bf16 v[192:195], v[156:159], a[192:195], v[192:195]
    v_mfma_f32_16x16x32_bf16 v[192:195], v[152:155], a[184:187], v[192:195]
    ds_read_b128 v[152:155], v2 offset:63488
    ds_read_b128 v[156:159], v2 offset:64512
    v_mfma_f32_16x16x32_bf16 v[200:203], a[228:231], a[184:187], v[200:203]
    v_mfma_f32_16x16x32_bf16 v[200:203], a[232:235], a[192:195], v[200:203]
    buffer_load_dwordx4 v1, s[4:7], s41 offen offset:2048 sc1 lds
    v_mfma_f32_16x16x32_bf16 v[200:203], a[236:239], a[200:203], v[200:203]
    v_mfma_f32_16x16x32_bf16 v[200:203], a[240:243], a[208:211], v[200:203]
    ds_read_b128 v[160:163], v3 offset:0
    ds_read_b128 a[224:227], v3 offset:1024
    v_mfma_f32_16x16x32_bf16 v[204:207], a[240:243], a[212:215], v[204:207]
    v_mfma_f32_16x16x32_bf16 v[204:207], a[236:239], a[204:207], v[204:207]
    v_mfma_f32_16x16x32_bf16 v[204:207], a[232:235], a[196:199], v[204:207]
    buffer_load_dwordx4 a[24:27], v13, s[4:7], s46 offen offset:0 sc1
    v_mfma_f32_16x16x32_bf16 v[204:207], a[228:231], a[188:191], v[204:207]
    s_waitcnt lgkmcnt(6)
    ds_read_b128 a[228:231], v3 offset:2048
    ds_read_b128 a[232:235], v3 offset:3072
    v_mfma_f32_16x16x32_bf16 v[212:215], a[244:247], a[188:191], v[212:215]
    v_mfma_f32_16x16x32_bf16 v[212:215], a[248:251], a[196:199], v[212:215]
    v_mfma_f32_16x16x32_bf16 v[212:215], a[252:255], a[204:207], v[212:215]
    buffer_load_dwordx4 a[28:31], v13, s[4:7], s46 offen offset:1024 sc1
    v_mfma_f32_16x16x32_bf16 v[212:215], v[140:143], a[212:215], v[212:215]
    ds_read_b128 a[236:239], v3 offset:4096
    ds_read_b128 a[240:243], v3 offset:5120
    v_mfma_f32_16x16x32_bf16 v[208:211], v[140:143], a[208:211], v[208:211]
    v_mfma_f32_16x16x32_bf16 v[208:211], a[252:255], a[200:203], v[208:211]
    v_mfma_f32_16x16x32_bf16 v[208:211], a[248:251], a[192:195], v[208:211]
    v_mfma_f32_16x16x32_bf16 v[208:211], a[244:247], a[184:187], v[208:211]
    s_waitcnt lgkmcnt(6)
    ds_read_b128 a[244:247], v3 offset:6144
    ds_read_b128 a[248:251], v3 offset:7168
    v_mfma_f32_16x16x32_bf16 v[216:219], v[144:147], a[184:187], v[216:219]
    buffer_load_dwordx4 a[32:35], v13, s[4:7], s47 offen offset:0 sc1
    v_mfma_f32_16x16x32_bf16 v[216:219], v[148:151], a[192:195], v[216:219]
    v_mfma_f32_16x16x32_bf16 v[216:219], v[152:155], a[200:203], v[216:219]
    v_mfma_f32_16x16x32_bf16 v[216:219], v[156:159], a[208:211], v[216:219]
    ds_read_b128 a[252:255], v3 offset:8192
    ds_read_b128 v[140:143], v3 offset:9216
    v_mfma_f32_16x16x32_bf16 v[220:223], v[156:159], a[212:215], v[220:223]
    buffer_load_dwordx4 a[36:39], v13, s[4:7], s47 offen offset:1024 sc1
    v_mfma_f32_16x16x32_bf16 v[220:223], v[152:155], a[204:207], v[220:223]
    v_mfma_f32_16x16x32_bf16 v[220:223], v[148:151], a[196:199], v[220:223]
    v_mfma_f32_16x16x32_bf16 v[220:223], v[144:147], a[188:191], v[220:223]
    s_waitcnt lgkmcnt(6)
    ds_read_b128 v[144:147], v3 offset:10240
    ds_read_b128 v[148:151], v3 offset:11264
    v_mfma_f32_16x16x32_bf16 v[236:239], v[160:163], a[188:191], v[236:239]
    buffer_load_dwordx4 a[40:43], v13, s[4:7], s45 offen offset:2048 sc1
    v_mfma_f32_16x16x32_bf16 v[236:239], a[224:227], a[196:199], v[236:239]
    v_mfma_f32_16x16x32_bf16 v[236:239], a[228:231], a[204:207], v[236:239]
    v_mfma_f32_16x16x32_bf16 v[236:239], a[232:235], a[212:215], v[236:239]
    s_waitcnt vmcnt(13)
    ds_read_b128 v[152:155], v3 offset:12288
    ds_read_b128 v[156:159], v3 offset:13312
    v_mfma_f32_16x16x32_bf16 v[232:235], a[232:235], a[208:211], v[232:235]
    buffer_atomic_add v10, v8, s[4:7], s28 offen offset:36 sc1
    v_mfma_f32_16x16x32_bf16 v[232:235], a[228:231], a[200:203], v[232:235]
    buffer_load_dwordx4 a[44:47], v13, s[4:7], s45 offen offset:3072 sc1
    v_mfma_f32_16x16x32_bf16 v[232:235], a[224:227], a[192:195], v[232:235]
    v_mfma_f32_16x16x32_bf16 v[232:235], v[160:163], a[184:187], v[232:235]
    s_waitcnt lgkmcnt(6)
    s_waitcnt vmcnt(12)
    ds_read_b128 v[160:163], v3 offset:14336
    ds_read_b128 a[224:227], v3 offset:15360
    v_mfma_f32_16x16x32_bf16 v[184:187], a[236:239], a[216:219], v[184:187]
    v_mfma_f32_16x16x32_bf16 v[184:187], a[240:243], a[0:3], v[184:187]
    buffer_load_dwordx4 a[48:51], v13, s[4:7], s46 offen offset:2048 sc1
    v_mfma_f32_16x16x32_bf16 v[184:187], a[244:247], a[8:11], v[184:187]
    v_mfma_f32_16x16x32_bf16 v[184:187], a[248:251], a[16:19], v[184:187]
    ds_read_b128 a[228:231], v1 offset:0
    ds_read_b128 a[232:235], v1 offset:1024
    v_mfma_f32_16x16x32_bf16 v[188:191], a[248:251], a[20:23], v[188:191]
    v_mfma_f32_16x16x32_bf16 v[188:191], a[244:247], a[12:15], v[188:191]
    buffer_load_dwordx4 a[52:55], v13, s[4:7], s46 offen offset:3072 sc1
    v_mfma_f32_16x16x32_bf16 v[188:191], a[240:243], a[4:7], v[188:191]
    v_mfma_f32_16x16x32_bf16 v[188:191], a[236:239], a[220:223], v[188:191]
    s_waitcnt lgkmcnt(6)
    ds_read_b128 a[236:239], v1 offset:2048
    ds_read_b128 a[240:243], v1 offset:3072
    v_mfma_f32_16x16x32_bf16 v[196:199], a[252:255], a[220:223], v[196:199]
    v_mfma_f32_16x16x32_bf16 v[196:199], v[140:143], a[4:7], v[196:199]
    v_mfma_f32_16x16x32_bf16 v[196:199], v[144:147], a[12:15], v[196:199]
    buffer_load_dwordx4 v1, s[4:7], s41 offen offset:3072 sc1 lds
    v_mfma_f32_16x16x32_bf16 v[196:199], v[148:151], a[20:23], v[196:199]
    s_add_u32 m0, s42, 77824
    ds_read_b128 a[244:247], v1 offset:4096
    ds_read_b128 a[248:251], v1 offset:5120
    v_mfma_f32_16x16x32_bf16 v[192:195], v[148:151], a[16:19], v[192:195]
    v_mfma_f32_16x16x32_bf16 v[192:195], v[144:147], a[8:11], v[192:195]
    v_mfma_f32_16x16x32_bf16 v[192:195], v[140:143], a[0:3], v[192:195]
    buffer_load_dwordx4 v12, s[4:7], s41 offen offset:0 sc1 lds
    v_mfma_f32_16x16x32_bf16 v[192:195], a[252:255], a[216:219], v[192:195]
    s_waitcnt lgkmcnt(6)
    ds_read_b128 a[252:255], v1 offset:6144
    ds_read_b128 v[140:143], v1 offset:7168
    v_mfma_f32_16x16x32_bf16 v[200:203], v[152:155], a[216:219], v[200:203]
    v_mfma_f32_16x16x32_bf16 v[200:203], v[156:159], a[0:3], v[200:203]
    v_mfma_f32_16x16x32_bf16 v[200:203], v[160:163], a[8:11], v[200:203]
    v_mfma_f32_16x16x32_bf16 v[200:203], a[224:227], a[16:19], v[200:203]
    ds_read_b128 v[144:147], v1 offset:8192
    ds_read_b128 v[148:151], v1 offset:9216
    v_mfma_f32_16x16x32_bf16 v[204:207], a[224:227], a[20:23], v[204:207]
    s_waitcnt vmcnt(14)
    s_barrier
    v_mfma_f32_16x16x32_bf16 v[204:207], v[160:163], a[12:15], v[204:207]
    buffer_load_dwordx4 v12, s[4:7], s41 offen offset:1024 sc1 lds
    v_mfma_f32_16x16x32_bf16 v[204:207], v[156:159], a[4:7], v[204:207]
    v_mfma_f32_16x16x32_bf16 v[204:207], v[152:155], a[220:223], v[204:207]
    s_waitcnt lgkmcnt(6)
    ds_read_b128 v[152:155], v1 offset:10240
    ds_read_b128 v[156:159], v1 offset:11264
    v_mfma_f32_16x16x32_bf16 v[212:215], a[228:231], a[220:223], v[212:215]
    buffer_load_dwordx4 v12, s[4:7], s41 offen offset:2048 sc1 lds
    v_mfma_f32_16x16x32_bf16 v[212:215], a[232:235], a[4:7], v[212:215]
    v_mfma_f32_16x16x32_bf16 v[212:215], a[236:239], a[12:15], v[212:215]
    v_mfma_f32_16x16x32_bf16 v[212:215], a[240:243], a[20:23], v[212:215]
    ds_read_b128 v[160:163], v1 offset:12288
    ds_read_b128 a[224:227], v1 offset:13312
    v_mfma_f32_16x16x32_bf16 v[208:211], a[240:243], a[16:19], v[208:211]
    buffer_load_dwordx4 v12, s[4:7], s41 offen offset:3072 sc1 lds
    v_mfma_f32_16x16x32_bf16 v[208:211], a[236:239], a[8:11], v[208:211]
    s_add_u32 m0, s42, 81920
    v_mfma_f32_16x16x32_bf16 v[208:211], a[232:235], a[0:3], v[208:211]
    v_mfma_f32_16x16x32_bf16 v[208:211], a[228:231], a[216:219], v[208:211]
    s_waitcnt lgkmcnt(6)
    ds_read_b128 a[228:231], v1 offset:14336
    ds_read_b128 a[232:235], v1 offset:15360
    v_mfma_f32_16x16x32_bf16 v[216:219], a[244:247], a[216:219], v[216:219]
    buffer_load_dwordx4 v13, s[4:7], s41 offen offset:0 sc1 lds
    v_mfma_f32_16x16x32_bf16 v[216:219], a[248:251], a[0:3], v[216:219]
    s_add_u32 m0, s42, 110592
    s_add_u32 s41, s41, 36864
    v_mfma_f32_16x16x32_bf16 v[216:219], a[252:255], a[8:11], v[216:219]
    v_mfma_f32_16x16x32_bf16 v[216:219], v[140:143], a[16:19], v[216:219]
    ds_read_b128 a[236:239], v1 offset:16384
    ds_read_b128 a[240:243], v1 offset:17408
    v_mfma_f32_16x16x32_bf16 v[220:223], v[140:143], a[20:23], v[220:223]
    v_mfma_f32_16x16x32_bf16 v[220:223], a[252:255], a[12:15], v[220:223]
    buffer_load_dwordx4 a[56:59], v13, s[4:7], s47 offen offset:2048 sc1
    v_mfma_f32_16x16x32_bf16 v[220:223], a[248:251], a[4:7], v[220:223]
    v_mfma_f32_16x16x32_bf16 v[220:223], a[244:247], a[220:223], v[220:223]
    s_waitcnt lgkmcnt(6)
    ds_read_b128 a[244:247], v1 offset:18432
    ds_read_b128 a[248:251], v1 offset:19456
    v_mfma_f32_16x16x32_bf16 v[236:239], v[144:147], a[220:223], v[236:239]
    s_load_dword s3, s[12:13], 36 glc
    v_mfma_f32_16x16x32_bf16 v[236:239], v[148:151], a[4:7], v[236:239]
    buffer_load_dwordx4 a[60:63], v13, s[4:7], s47 offen offset:3072 sc1
    v_mfma_f32_16x16x32_bf16 v[236:239], v[152:155], a[12:15], v[236:239]
    v_mfma_f32_16x16x32_bf16 v[236:239], v[156:159], a[20:23], v[236:239]
    ds_read_b128 a[252:255], v1 offset:20480
    ds_read_b128 v[140:143], v1 offset:21504
    v_mfma_f32_16x16x32_bf16 v[232:235], v[156:159], a[16:19], v[232:235]
    v_mfma_f32_16x16x32_bf16 v[232:235], v[152:155], a[8:11], v[232:235]
    v_mfma_f32_16x16x32_bf16 v[232:235], v[148:151], a[0:3], v[232:235]
    buffer_load_dwordx4 a[64:67], v1, s[4:7], s49 offen offset:0 sc1
    v_mfma_f32_16x16x32_bf16 v[232:235], v[144:147], a[216:219], v[232:235]
    s_waitcnt lgkmcnt(6)
    s_waitcnt vmcnt(9)
    ds_read_b128 v[144:147], v1 offset:22528
    ds_read_b128 v[148:151], v1 offset:23552
    v_mfma_f32_16x16x32_bf16 v[184:187], v[160:163], a[24:27], v[184:187]
    buffer_load_dwordx4 a[68:71], v1, s[4:7], s49 offen offset:1024 sc1
    v_mfma_f32_16x16x32_bf16 v[184:187], a[224:227], a[32:35], v[184:187]
    buffer_load_dwordx4 a[72:75], v1, s[4:7], s50 offen offset:0 sc1
    v_mfma_f32_16x16x32_bf16 v[184:187], a[228:231], a[40:43], v[184:187]
    v_mfma_f32_16x16x32_bf16 v[184:187], a[232:235], a[48:51], v[184:187]
    ds_read_b128 v[152:155], v1 offset:24576
    ds_read_b128 v[156:159], v1 offset:25600
    v_mfma_f32_16x16x32_bf16 v[188:191], a[232:235], a[52:55], v[188:191]
    v_mfma_f32_16x16x32_bf16 v[188:191], a[228:231], a[44:47], v[188:191]
    buffer_load_dwordx4 a[76:79], v1, s[4:7], s50 offen offset:1024 sc1
    v_mfma_f32_16x16x32_bf16 v[188:191], a[224:227], a[36:39], v[188:191]
    v_mfma_f32_16x16x32_bf16 v[188:191], v[160:163], a[28:31], v[188:191]
    s_waitcnt lgkmcnt(6)
    ds_read_b128 v[160:163], v1 offset:26624
    ds_read_b128 a[224:227], v1 offset:27648
    v_mfma_f32_16x16x32_bf16 v[196:199], a[236:239], a[28:31], v[196:199]
    v_mfma_f32_16x16x32_bf16 v[196:199], a[240:243], a[36:39], v[196:199]
    buffer_load_dwordx4 a[80:83], v1, s[4:7], s51 offen offset:0 sc1
    v_mfma_f32_16x16x32_bf16 v[196:199], a[244:247], a[44:47], v[196:199]
    v_mfma_f32_16x16x32_bf16 v[196:199], a[248:251], a[52:55], v[196:199]
    ds_read_b128 a[228:231], v1 offset:28672
    ds_read_b128 a[232:235], v1 offset:29696
    v_mfma_f32_16x16x32_bf16 v[192:195], a[248:251], a[48:51], v[192:195]
    v_mfma_f32_16x16x32_bf16 v[192:195], a[244:247], a[40:43], v[192:195]
    v_mfma_f32_16x16x32_bf16 v[192:195], a[240:243], a[32:35], v[192:195]
    buffer_load_dwordx4 a[84:87], v1, s[4:7], s51 offen offset:1024 sc1
    v_mfma_f32_16x16x32_bf16 v[192:195], a[236:239], a[24:27], v[192:195]
    s_waitcnt lgkmcnt(6)
    ds_read_b128 a[236:239], v1 offset:30720
    ds_read_b128 a[240:243], v1 offset:31744
    v_mfma_f32_16x16x32_bf16 v[200:203], a[252:255], a[24:27], v[200:203]
    v_mfma_f32_16x16x32_bf16 v[200:203], v[140:143], a[32:35], v[200:203]
    v_mfma_f32_16x16x32_bf16 v[200:203], v[144:147], a[40:43], v[200:203]
    buffer_load_dwordx4 v1, s[4:7], s41 offen offset:0 sc1 lds
    v_mfma_f32_16x16x32_bf16 v[200:203], v[148:151], a[48:51], v[200:203]
    ds_read_b128 a[244:247], v1 offset:32768
    ds_read_b128 a[248:251], v1 offset:33792
    v_mfma_f32_16x16x32_bf16 v[204:207], v[148:151], a[52:55], v[204:207]
    v_mfma_f32_16x16x32_bf16 v[204:207], v[144:147], a[44:47], v[204:207]
    v_mfma_f32_16x16x32_bf16 v[204:207], v[140:143], a[36:39], v[204:207]
    s_waitcnt lgkmcnt(0)
    s_cmp_lt_u32 s3, 12
    s_cbranch_scc1 L_inte_chk_32_slow
L_inte_chk_32_back:
    v_mfma_f32_16x16x32_bf16 v[204:207], a[252:255], a[28:31], v[204:207]
    ds_read_b128 a[252:255], v1 offset:34816
    ds_read_b128 v[140:143], v1 offset:35840
    v_mfma_f32_16x16x32_bf16 v[212:215], v[152:155], a[28:31], v[212:215]
    buffer_load_dwordx4 v1, s[4:7], s41 offen offset:1024 sc1 lds
    v_mfma_f32_16x16x32_bf16 v[212:215], v[156:159], a[36:39], v[212:215]
    v_mfma_f32_16x16x32_bf16 v[212:215], v[160:163], a[44:47], v[212:215]
    v_mfma_f32_16x16x32_bf16 v[212:215], a[224:227], a[52:55], v[212:215]
    ds_read_b128 v[144:147], v1 offset:36864
    ds_read_b128 v[148:151], v1 offset:37888
    v_mfma_f32_16x16x32_bf16 v[208:211], a[224:227], a[48:51], v[208:211]
    buffer_load_dwordx4 v1, s[4:7], s41 offen offset:2048 sc1 lds
    v_mfma_f32_16x16x32_bf16 v[208:211], v[160:163], a[40:43], v[208:211]
    v_mfma_f32_16x16x32_bf16 v[208:211], v[156:159], a[32:35], v[208:211]
    v_mfma_f32_16x16x32_bf16 v[208:211], v[152:155], a[24:27], v[208:211]
    ds_read_b128 v[152:155], v1 offset:38912
    ds_read_b128 v[156:159], v1 offset:39936
    v_mfma_f32_16x16x32_bf16 v[216:219], a[228:231], a[24:27], v[216:219]
    buffer_load_dwordx4 v1, s[4:7], s41 offen offset:3072 sc1 lds
    v_mfma_f32_16x16x32_bf16 v[216:219], a[232:235], a[32:35], v[216:219]
    s_add_u32 m0, s42, 114688
    v_mfma_f32_16x16x32_bf16 v[216:219], a[236:239], a[40:43], v[216:219]
    v_mfma_f32_16x16x32_bf16 v[216:219], a[240:243], a[48:51], v[216:219]
    ds_read_b128 v[160:163], v1 offset:40960
    ds_read_b128 a[224:227], v1 offset:41984
    v_mfma_f32_16x16x32_bf16 v[220:223], a[240:243], a[52:55], v[220:223]
    buffer_load_dwordx4 v12, s[4:7], s41 offen offset:0 sc1 lds
    v_mfma_f32_16x16x32_bf16 v[220:223], a[236:239], a[44:47], v[220:223]
    v_mfma_f32_16x16x32_bf16 v[220:223], a[232:235], a[36:39], v[220:223]
    v_mfma_f32_16x16x32_bf16 v[220:223], a[228:231], a[28:31], v[220:223]
    s_waitcnt lgkmcnt(6)
    ds_read_b128 a[228:231], v1 offset:43008
    ds_read_b128 a[232:235], v1 offset:44032
    v_mfma_f32_16x16x32_bf16 v[236:239], a[244:247], a[28:31], v[236:239]
    v_mfma_f32_16x16x32_bf16 v[236:239], a[248:251], a[36:39], v[236:239]
    buffer_load_dwordx4 v12, s[4:7], s41 offen offset:1024 sc1 lds
    v_mfma_f32_16x16x32_bf16 v[236:239], a[252:255], a[44:47], v[236:239]
    v_mfma_f32_16x16x32_bf16 v[236:239], v[140:143], a[52:55], v[236:239]
    ds_read_b128 a[236:239], v1 offset:45056
    ds_read_b128 a[240:243], v1 offset:46080
    v_mfma_f32_16x16x32_bf16 v[232:235], v[140:143], a[48:51], v[232:235]
    s_waitcnt vmcnt(14)
    s_barrier
    v_mfma_f32_16x16x32_bf16 v[232:235], a[252:255], a[40:43], v[232:235]
    buffer_load_dwordx4 v12, s[4:7], s41 offen offset:2048 sc1 lds
    v_mfma_f32_16x16x32_bf16 v[232:235], a[248:251], a[32:35], v[232:235]
    v_mfma_f32_16x16x32_bf16 v[232:235], a[244:247], a[24:27], v[232:235]
    s_waitcnt lgkmcnt(6)
    s_waitcnt vmcnt(7)
    ds_read_b128 a[244:247], v1 offset:47104
    ds_read_b128 a[248:251], v1 offset:48128
    v_mfma_f32_16x16x32_bf16 v[184:187], v[144:147], a[56:59], v[184:187]
    buffer_load_dwordx4 a[88:91], v1, s[4:7], s49 offen offset:2048 sc1
    v_mfma_f32_16x16x32_bf16 v[184:187], v[148:151], a[64:67], v[184:187]
    buffer_load_dwordx4 a[92:95], v1, s[4:7], s49 offen offset:3072 sc1
    v_mfma_f32_16x16x32_bf16 v[184:187], v[152:155], a[72:75], v[184:187]
    v_mfma_f32_16x16x32_bf16 v[184:187], v[156:159], a[80:83], v[184:187]
    ds_read_b128 a[252:255], v1 offset:49152
    ds_read_b128 v[140:143], v1 offset:50176
    v_mfma_f32_16x16x32_bf16 v[188:191], v[156:159], a[84:87], v[188:191]
    v_mfma_f32_16x16x32_bf16 v[188:191], v[152:155], a[76:79], v[188:191]
    buffer_load_dwordx4 a[96:99], v1, s[4:7], s50 offen offset:2048 sc1
    v_mfma_f32_16x16x32_bf16 v[188:191], v[148:151], a[68:71], v[188:191]
    v_mfma_f32_16x16x32_bf16 v[188:191], v[144:147], a[60:63], v[188:191]
    s_waitcnt lgkmcnt(6)
    ds_read_b128 v[144:147], v1 offset:51200
    ds_read_b128 v[148:151], v1 offset:52224
    v_mfma_f32_16x16x32_bf16 v[196:199], v[160:163], a[60:63], v[196:199]
    v_mfma_f32_16x16x32_bf16 v[196:199], a[224:227], a[68:71], v[196:199]
    buffer_load_dwordx4 a[100:103], v1, s[4:7], s50 offen offset:3072 sc1
    v_mfma_f32_16x16x32_bf16 v[196:199], a[228:231], a[76:79], v[196:199]
    v_mfma_f32_16x16x32_bf16 v[196:199], a[232:235], a[84:87], v[196:199]
    ds_read_b128 v[152:155], v1 offset:53248
    ds_read_b128 v[156:159], v1 offset:54272
    v_mfma_f32_16x16x32_bf16 v[192:195], a[232:235], a[80:83], v[192:195]
    v_mfma_f32_16x16x32_bf16 v[192:195], a[228:231], a[72:75], v[192:195]
    v_mfma_f32_16x16x32_bf16 v[192:195], a[224:227], a[64:67], v[192:195]
    buffer_load_dwordx4 a[104:107], v1, s[4:7], s51 offen offset:2048 sc1
    v_mfma_f32_16x16x32_bf16 v[192:195], v[160:163], a[56:59], v[192:195]
    s_waitcnt lgkmcnt(6)
    ds_read_b128 v[160:163], v1 offset:55296
    ds_read_b128 a[224:227], v1 offset:56320
    v_mfma_f32_16x16x32_bf16 v[200:203], a[236:239], a[56:59], v[200:203]
    v_mfma_f32_16x16x32_bf16 v[200:203], a[240:243], a[64:67], v[200:203]
    v_mfma_f32_16x16x32_bf16 v[200:203], a[244:247], a[72:75], v[200:203]
    buffer_load_dwordx4 a[108:111], v1, s[4:7], s51 offen offset:3072 sc1
    v_mfma_f32_16x16x32_bf16 v[200:203], a[248:251], a[80:83], v[200:203]
    ds_read_b128 a[228:231], v1 offset:57344
    ds_read_b128 a[232:235], v1 offset:58368
    v_mfma_f32_16x16x32_bf16 v[204:207], a[248:251], a[84:87], v[204:207]
    v_mfma_f32_16x16x32_bf16 v[204:207], a[244:247], a[76:79], v[204:207]
    v_mfma_f32_16x16x32_bf16 v[204:207], a[240:243], a[68:71], v[204:207]
    v_mfma_f32_16x16x32_bf16 v[204:207], a[236:239], a[60:63], v[204:207]
    s_waitcnt lgkmcnt(6)
    ds_read_b128 a[236:239], v1 offset:59392
    ds_read_b128 a[240:243], v1 offset:60416
    v_mfma_f32_16x16x32_bf16 v[212:215], a[252:255], a[60:63], v[212:215]
    buffer_load_dwordx4 v12, s[4:7], s41 offen offset:3072 sc1 lds
    v_mfma_f32_16x16x32_bf16 v[212:215], v[140:143], a[68:71], v[212:215]
    s_add_u32 m0, s42, 118784
    v_mfma_f32_16x16x32_bf16 v[212:215], v[144:147], a[76:79], v[212:215]
    v_mfma_f32_16x16x32_bf16 v[212:215], v[148:151], a[84:87], v[212:215]
    ds_read_b128 a[244:247], v1 offset:61440
    ds_read_b128 a[248:251], v1 offset:62464
    v_mfma_f32_16x16x32_bf16 v[208:211], v[148:151], a[80:83], v[208:211]
    buffer_load_dwordx4 v13, s[4:7], s41 offen offset:0 sc1 lds
    v_mfma_f32_16x16x32_bf16 v[208:211], v[144:147], a[72:75], v[208:211]
    s_add_u32 m0, s42, 0
    s_add_u32 s41, s41, 36864
    v_mfma_f32_16x16x32_bf16 v[208:211], v[140:143], a[64:67], v[208:211]
    v_mfma_f32_16x16x32_bf16 v[208:211], a[252:255], a[56:59], v[208:211]
    s_waitcnt lgkmcnt(6)
    ds_read_b128 a[252:255], v1 offset:63488
    ds_read_b128 v[140:143], v1 offset:64512
    v_mfma_f32_16x16x32_bf16 v[216:219], v[152:155], a[56:59], v[216:219]
    buffer_load_dwordx4 v1, s[4:7], s41 offen offset:0 sc1 lds
    v_mfma_f32_16x16x32_bf16 v[216:219], v[156:159], a[64:67], v[216:219]
    v_mfma_f32_16x16x32_bf16 v[216:219], v[160:163], a[72:75], v[216:219]
    v_mfma_f32_16x16x32_bf16 v[216:219], a[224:227], a[80:83], v[216:219]
    ds_read_b128 v[144:147], v2 offset:0
    ds_read_b128 v[148:151], v2 offset:1024
    v_mfma_f32_16x16x32_bf16 v[220:223], a[224:227], a[84:87], v[220:223]
    buffer_load_dwordx4 v1, s[4:7], s41 offen offset:1024 sc1 lds
    v_mfma_f32_16x16x32_bf16 v[220:223], v[160:163], a[76:79], v[220:223]
    v_mfma_f32_16x16x32_bf16 v[220:223], v[156:159], a[68:71], v[220:223]
    v_mfma_f32_16x16x32_bf16 v[220:223], v[152:155], a[60:63], v[220:223]
    s_waitcnt lgkmcnt(6)
    ds_read_b128 v[152:155], v2 offset:2048
    ds_read_b128 v[156:159], v2 offset:3072
    v_mfma_f32_16x16x32_bf16 v[236:239], a[228:231], a[60:63], v[236:239]
    v_mfma_f32_16x16x32_bf16 v[236:239], a[232:235], a[68:71], v[236:239]
    buffer_load_dwordx4 v1, s[4:7], s41 offen offset:2048 sc1 lds
    v_mfma_f32_16x16x32_bf16 v[236:239], a[236:239], a[76:79], v[236:239]
    v_mfma_f32_16x16x32_bf16 v[236:239], a[240:243], a[84:87], v[236:239]
    ds_read_b128 v[160:163], v2 offset:4096
    ds_read_b128 a[224:227], v2 offset:5120
    v_mfma_f32_16x16x32_bf16 v[232:235], a[240:243], a[80:83], v[232:235]
    v_mfma_f32_16x16x32_bf16 v[232:235], a[236:239], a[72:75], v[232:235]
    buffer_load_dwordx4 a[112:115], v12, s[4:7], s49 offen offset:0 sc1
    v_mfma_f32_16x16x32_bf16 v[232:235], a[232:235], a[64:67], v[232:235]
    v_mfma_f32_16x16x32_bf16 v[232:235], a[228:231], a[56:59], v[232:235]
    s_waitcnt lgkmcnt(6)
    ds_read_b128 a[228:231], v2 offset:6144
    ds_read_b128 a[232:235], v2 offset:7168
    v_mfma_f32_16x16x32_bf16 v[184:187], a[244:247], v[76:79], v[184:187]
    s_waitcnt vmcnt(6)
    v_mfma_f32_16x16x32_bf16 v[184:187], a[248:251], a[88:91], v[184:187]
    buffer_load_dwordx4 a[116:119], v12, s[4:7], s49 offen offset:1024 sc1
    v_mfma_f32_16x16x32_bf16 v[184:187], a[252:255], a[96:99], v[184:187]
    buffer_load_dwordx4 a[120:123], v12, s[4:7], s50 offen offset:0 sc1
    v_mfma_f32_16x16x32_bf16 v[184:187], v[140:143], a[104:107], v[184:187]
    ds_read_b128 a[236:239], v2 offset:8192
    ds_read_b128 a[240:243], v2 offset:9216
    v_mfma_f32_16x16x32_bf16 v[188:191], v[140:143], a[108:111], v[188:191]
    v_mfma_f32_16x16x32_bf16 v[188:191], a[252:255], a[100:103], v[188:191]
    v_mfma_f32_16x16x32_bf16 v[188:191], a[248:251], a[92:95], v[188:191]
    buffer_load_dwordx4 a[124:127], v12, s[4:7], s50 offen offset:1024 sc1
    v_mfma_f32_16x16x32_bf16 v[188:191], a[244:247], v[80:83], v[188:191]
    s_waitcnt lgkmcnt(6)
    ds_read_b128 a[244:247], v2 offset:10240
    ds_read_b128 a[248:251], v2 offset:11264
    v_mfma_f32_16x16x32_bf16 v[196:199], v[144:147], v[80:83], v[196:199]
    v_mfma_f32_16x16x32_bf16 v[196:199], v[148:151], a[92:95], v[196:199]
    v_mfma_f32_16x16x32_bf16 v[196:199], v[152:155], a[100:103], v[196:199]
    buffer_load_dwordx4 a[128:131], v12, s[4:7], s51 offen offset:0 sc1
    v_mfma_f32_16x16x32_bf16 v[196:199], v[156:159], a[108:111], v[196:199]
    ds_read_b128 a[252:255], v2 offset:12288
    ds_read_b128 v[140:143], v2 offset:13312
    v_mfma_f32_16x16x32_bf16 v[192:195], v[156:159], a[104:107], v[192:195]
    v_mfma_f32_16x16x32_bf16 v[192:195], v[152:155], a[96:99], v[192:195]
    v_mfma_f32_16x16x32_bf16 v[192:195], v[148:151], a[88:91], v[192:195]
    v_mfma_f32_16x16x32_bf16 v[192:195], v[144:147], v[76:79], v[192:195]
    s_waitcnt lgkmcnt(6)
    ds_read_b128 v[144:147], v2 offset:14336
    ds_read_b128 v[148:151], v2 offset:15360
    v_mfma_f32_16x16x32_bf16 v[200:203], v[160:163], v[76:79], v[200:203]
    buffer_load_dwordx4 a[132:135], v12, s[4:7], s51 offen offset:1024 sc1
    v_mfma_f32_16x16x32_bf16 v[200:203], a[224:227], a[88:91], v[200:203]
    v_mfma_f32_16x16x32_bf16 v[200:203], a[228:231], a[96:99], v[200:203]
    v_mfma_f32_16x16x32_bf16 v[200:203], a[232:235], a[104:107], v[200:203]
    ds_read_b128 v[152:155], v2 offset:16384
    ds_read_b128 v[156:159], v2 offset:17408
    v_mfma_f32_16x16x32_bf16 v[204:207], a[232:235], a[108:111], v[204:207]
    s_waitcnt vmcnt(9)
    s_barrier
    v_mfma_f32_16x16x32_bf16 v[204:207], a[228:231], a[100:103], v[204:207]
    buffer_load_dwordx4 v1, s[4:7], s41 offen offset:3072 sc1 lds
    v_mfma_f32_16x16x32_bf16 v[204:207], a[224:227], a[92:95], v[204:207]
    s_add_u32 m0, s42, 4096
    v_mfma_f32_16x16x32_bf16 v[204:207], v[160:163], v[80:83], v[204:207]
    s_waitcnt lgkmcnt(6)
    ds_read_b128 v[160:163], v2 offset:18432
    ds_read_b128 a[224:227], v2 offset:19456
    v_mfma_f32_16x16x32_bf16 v[212:215], a[236:239], v[80:83], v[212:215]
    buffer_load_dwordx4 v12, s[4:7], s41 offen offset:0 sc1 lds
    v_mfma_f32_16x16x32_bf16 v[212:215], a[240:243], a[92:95], v[212:215]
    v_mfma_f32_16x16x32_bf16 v[212:215], a[244:247], a[100:103], v[212:215]
    v_mfma_f32_16x16x32_bf16 v[212:215], a[248:251], a[108:111], v[212:215]
    ds_read_b128 a[228:231], v2 offset:20480
    ds_read_b128 a[232:235], v2 offset:21504
    v_mfma_f32_16x16x32_bf16 v[208:211], a[248:251], a[104:107], v[208:211]
    buffer_load_dwordx4 v12, s[4:7], s41 offen offset:1024 sc1 lds
    v_mfma_f32_16x16x32_bf16 v[208:211], a[244:247], a[96:99], v[208:211]
    v_mfma_f32_16x16x32_bf16 v[208:211], a[240:243], a[88:91], v[208:211]
    v_mfma_f32_16x16x32_bf16 v[208:211], a[236:239], v[76:79], v[208:211]
    s_waitcnt lgkmcnt(6)
    ds_read_b128 a[236:239], v2 offset:22528
    ds_read_b128 a[240:243], v2 offset:23552
    v_mfma_f32_16x16x32_bf16 v[216:219], a[252:255], v[76:79], v[216:219]
    v_mfma_f32_16x16x32_bf16 v[216:219], v[140:143], a[88:91], v[216:219]
    buffer_load_dwordx4 v12, s[4:7], s41 offen offset:2048 sc1 lds
    v_mfma_f32_16x16x32_bf16 v[216:219], v[144:147], a[96:99], v[216:219]
    v_mfma_f32_16x16x32_bf16 v[216:219], v[148:151], a[104:107], v[216:219]
    s_add_u32 s32, s18, 1
    ds_read_b128 a[244:247], v2 offset:24576
    ds_read_b128 a[248:251], v2 offset:25600
    v_mfma_f32_16x16x32_bf16 v[220:223], v[148:151], a[108:111], v[220:223]
    s_and_b32 s32, s32, 3
    s_mul_i32 s32, s32, 24576
    s_add_u32 s32, s32, s31
    v_mfma_f32_16x16x32_bf16 v[220:223], v[144:147], a[100:103], v[220:223]
    buffer_load_dwordx4 v12, s[4:7], s41 offen offset:3072 sc1 lds
    v_mfma_f32_16x16x32_bf16 v[220:223], v[140:143], a[92:95], v[220:223]
    s_add_u32 s32, s32, 0
    s_add_u32 m0, s42, 8192
    v_mfma_f32_16x16x32_bf16 v[220:223], a[252:255], v[80:83], v[220:223]
    s_waitcnt lgkmcnt(6)
    ds_read_b128 a[252:255], v2 offset:26624
    ds_read_b128 v[140:143], v2 offset:27648
    v_mfma_f32_16x16x32_bf16 v[236:239], v[152:155], v[80:83], v[236:239]
    v_mfma_f32_16x16x32_bf16 v[236:239], v[156:159], a[92:95], v[236:239]
    v_mfma_f32_16x16x32_bf16 v[236:239], v[160:163], a[100:103], v[236:239]
    buffer_load_dwordx4 v13, s[4:7], s41 offen offset:0 sc1 lds
    v_mfma_f32_16x16x32_bf16 v[236:239], a[224:227], a[108:111], v[236:239]
    s_add_u32 m0, s42, 36864
    ds_read_b128 v[144:147], v2 offset:28672
    ds_read_b128 v[148:151], v2 offset:29696
    v_mfma_f32_16x16x32_bf16 v[232:235], a[224:227], a[104:107], v[232:235]
    s_add_u32 s41, s41, 36864
    v_mfma_f32_16x16x32_bf16 v[232:235], v[160:163], a[96:99], v[232:235]
    v_mfma_f32_16x16x32_bf16 v[232:235], v[156:159], a[88:91], v[232:235]
    buffer_load_dwordx4 v1, s[4:7], s41 offen offset:0 sc1 lds
    v_mfma_f32_16x16x32_bf16 v[232:235], v[152:155], v[76:79], v[232:235]
    s_waitcnt lgkmcnt(6)
    ds_read_b128 v[152:155], v2 offset:30720
    ds_read_b128 v[156:159], v2 offset:31744
    v_mfma_f32_16x16x32_bf16 v[184:187], a[228:231], v[84:87], v[184:187]
    s_waitcnt vmcnt(7)
    v_mfma_f32_16x16x32_bf16 v[184:187], a[232:235], a[112:115], v[184:187]
    buffer_load_dwordx4 v1, s[4:7], s41 offen offset:1024 sc1 lds
    v_mfma_f32_16x16x32_bf16 v[184:187], a[236:239], a[120:123], v[184:187]
    buffer_load_dwordx4 v1, s[4:7], s41 offen offset:2048 sc1 lds
    v_mfma_f32_16x16x32_bf16 v[184:187], a[240:243], a[128:131], v[184:187]
    ds_read_b128 v[160:163], v2 offset:32768
    ds_read_b128 a[224:227], v2 offset:33792
    v_mfma_f32_16x16x32_bf16 v[188:191], a[240:243], a[132:135], v[188:191]
    v_mfma_f32_16x16x32_bf16 v[188:191], a[236:239], a[124:127], v[188:191]
    v_mfma_f32_16x16x32_bf16 v[188:191], a[232:235], a[116:119], v[188:191]
    buffer_load_dwordx4 v1, s[4:7], s41 offen offset:3072 sc1 lds
    v_mfma_f32_16x16x32_bf16 v[188:191], a[228:231], v[88:91], v[188:191]
    s_waitcnt lgkmcnt(6)
    ds_read_b128 a[228:231], v2 offset:34816
    ds_read_b128 a[232:235], v2 offset:35840
    v_mfma_f32_16x16x32_bf16 v[196:199], a[244:247], v[88:91], v[196:199]
    s_add_u32 m0, s42, 40960
    v_cvt_pk_bf16_f32 v184, v184, v185
    v_mfma_f32_16x16x32_bf16 v[196:199], a[248:251], a[116:119], v[196:199]
    v_cvt_pk_bf16_f32 v185, v186, v187
    v_cvt_pk_bf16_f32 v186, v188, v189
    v_mfma_f32_16x16x32_bf16 v[196:199], a[252:255], a[124:127], v[196:199]
    buffer_load_dwordx4 v12, s[4:7], s41 offen offset:0 sc1 lds
    v_mfma_f32_16x16x32_bf16 v[196:199], v[140:143], a[132:135], v[196:199]
    ds_read_b128 a[236:239], v2 offset:36864
    ds_read_b128 a[240:243], v2 offset:37888
    v_mfma_f32_16x16x32_bf16 v[192:195], v[140:143], a[128:131], v[192:195]
    v_cvt_pk_bf16_f32 v187, v190, v191
    v_mfma_f32_16x16x32_bf16 v[192:195], a[252:255], a[120:123], v[192:195]
    buffer_store_dwordx4 v[184:187], v1, s[4:7], s32 offen offset:0 sc1
    v_mfma_f32_16x16x32_bf16 v[192:195], a[248:251], a[112:115], v[192:195]
    v_mfma_f32_16x16x32_bf16 v[192:195], a[244:247], v[84:87], v[192:195]
    s_waitcnt lgkmcnt(6)
    ds_read_b128 a[244:247], v2 offset:38912
    ds_read_b128 a[248:251], v2 offset:39936
    v_mfma_f32_16x16x32_bf16 v[200:203], v[144:147], v[84:87], v[200:203]
    buffer_load_dwordx4 v12, s[4:7], s41 offen offset:1024 sc1 lds
    v_mfma_f32_16x16x32_bf16 v[200:203], v[148:151], a[112:115], v[200:203]
    v_mfma_f32_16x16x32_bf16 v[200:203], v[152:155], a[120:123], v[200:203]
    v_mfma_f32_16x16x32_bf16 v[200:203], v[156:159], a[128:131], v[200:203]
    ds_read_b128 a[252:255], v2 offset:40960
    ds_read_b128 v[140:143], v2 offset:41984
    v_mfma_f32_16x16x32_bf16 v[204:207], v[156:159], a[132:135], v[204:207]
    buffer_load_dwordx4 v12, s[4:7], s41 offen offset:2048 sc1 lds
    v_mfma_f32_16x16x32_bf16 v[204:207], v[152:155], a[124:127], v[204:207]
    v_cvt_pk_bf16_f32 v192, v192, v193
    v_cvt_pk_bf16_f32 v193, v194, v195
    v_mfma_f32_16x16x32_bf16 v[204:207], v[148:151], a[116:119], v[204:207]
    v_cvt_pk_bf16_f32 v194, v196, v197
    v_cvt_pk_bf16_f32 v195, v198, v199
    v_mfma_f32_16x16x32_bf16 v[204:207], v[144:147], v[88:91], v[204:207]
    s_waitcnt lgkmcnt(6)
    ds_read_b128 v[144:147], v2 offset:43008
    ds_read_b128 v[148:151], v2 offset:44032
    v_mfma_f32_16x16x32_bf16 v[212:215], v[160:163], v[88:91], v[212:215]
    buffer_store_dwordx4 v[192:195], v1, s[4:7], s32 offen offset:1024 sc1
    v_mfma_f32_16x16x32_bf16 v[212:215], a[224:227], a[116:119], v[212:215]
    buffer_load_dwordx4 v12, s[4:7], s41 offen offset:3072 sc1 lds
    v_mfma_f32_16x16x32_bf16 v[212:215], a[228:231], a[124:127], v[212:215]
    s_add_u32 s32, s18, 2
    s_and_b32 s32, s32, 3
    s_mul_i32 s32, s32, 24576
    v_mfma_f32_16x16x32_bf16 v[212:215], a[232:235], a[132:135], v[212:215]
    s_add_u32 s32, s32, s31
    ds_read_b128 v[152:155], v2 offset:45056
    ds_read_b128 v[156:159], v2 offset:46080
    v_mfma_f32_16x16x32_bf16 v[208:211], a[232:235], a[128:131], v[208:211]
    s_add_u32 s32, s32, 8192
    v_cvt_pk_bf16_f32 v200, v200, v201
    v_mfma_f32_16x16x32_bf16 v[208:211], a[228:231], a[120:123], v[208:211]
    s_add_u32 m0, s42, 45056
    v_cvt_pk_bf16_f32 v201, v202, v203
    v_mfma_f32_16x16x32_bf16 v[208:211], a[224:227], a[112:115], v[208:211]
    buffer_load_dwordx4 v13, s[4:7], s41 offen offset:0 sc1 lds
    v_mfma_f32_16x16x32_bf16 v[208:211], v[160:163], v[84:87], v[208:211]
    s_waitcnt lgkmcnt(6)
    ds_read_b128 v[160:163], v2 offset:47104
    ds_read_b128 a[224:227], v2 offset:48128
    v_mfma_f32_16x16x32_bf16 v[216:219], a[236:239], v[84:87], v[216:219]
    v_cvt_pk_bf16_f32 v202, v204, v205
    v_cvt_pk_bf16_f32 v203, v206, v207
    v_mfma_f32_16x16x32_bf16 v[216:219], a[240:243], a[112:115], v[216:219]
    buffer_store_dwordx4 v[200:203], v1, s[4:7], s32 offen offset:0 sc1
    v_mfma_f32_16x16x32_bf16 v[216:219], a[244:247], a[120:123], v[216:219]
    v_cvt_pk_bf16_f32 v208, v208, v209
    v_cvt_pk_bf16_f32 v209, v210, v211
    v_mfma_f32_16x16x32_bf16 v[216:219], a[248:251], a[128:131], v[216:219]
    ds_read_b128 a[228:231], v2 offset:49152
    ds_read_b128 a[232:235], v2 offset:50176
    v_mfma_f32_16x16x32_bf16 v[220:223], a[248:251], a[132:135], v[220:223]
    v_cvt_pk_bf16_f32 v210, v212, v213
    v_cvt_pk_bf16_f32 v211, v214, v215
    v_mfma_f32_16x16x32_bf16 v[220:223], a[244:247], a[124:127], v[220:223]
    buffer_store_dwordx4 v[208:211], v1, s[4:7], s32 offen offset:1024 sc1
    v_mfma_f32_16x16x32_bf16 v[220:223], a[240:243], a[116:119], v[220:223]
    s_add_u32 s32, s18, 3
    s_and_b32 s32, s32, 3
    s_mul_i32 s32, s32, 24576
    v_mfma_f32_16x16x32_bf16 v[220:223], a[236:239], v[88:91], v[220:223]
    s_waitcnt lgkmcnt(6)
    ds_read_b128 a[236:239], v2 offset:51200
    ds_read_b128 a[240:243], v2 offset:52224
    v_mfma_f32_16x16x32_bf16 v[236:239], a[252:255], v[88:91], v[236:239]
    s_add_u32 s32, s32, s31
    s_add_u32 s32, s32, 16384
    v_cvt_pk_bf16_f32 v216, v216, v217
    v_mfma_f32_16x16x32_bf16 v[236:239], v[140:143], a[116:119], v[236:239]
    v_cvt_pk_bf16_f32 v217, v218, v219
    v_cvt_pk_bf16_f32 v218, v220, v221
    v_mfma_f32_16x16x32_bf16 v[236:239], v[144:147], a[124:127], v[236:239]
    v_cvt_pk_bf16_f32 v219, v222, v223
    v_mfma_f32_16x16x32_bf16 v[236:239], v[148:151], a[132:135], v[236:239]
    ds_read_b128 a[244:247], v2 offset:53248
    ds_read_b128 a[248:251], v2 offset:54272
    v_mfma_f32_16x16x32_bf16 v[232:235], v[148:151], a[128:131], v[232:235]
    s_waitcnt vmcnt(13)
    s_barrier
    v_mfma_f32_16x16x32_bf16 v[232:235], v[144:147], a[120:123], v[232:235]
    buffer_store_dwordx4 v[216:219], v1, s[4:7], s32 offen offset:0 sc1
    v_mfma_f32_16x16x32_bf16 v[232:235], v[140:143], a[112:115], v[232:235]
    v_mfma_f32_16x16x32_bf16 v[232:235], a[252:255], v[84:87], v[232:235]
    s_waitcnt lgkmcnt(6)
    ds_read_b128 a[252:255], v2 offset:55296
    ds_read_b128 v[140:143], v2 offset:56320
    v_mfma_f32_16x16x32_bf16 v[224:227], v[152:155], v[20:23], 0
    v_mfma_f32_16x16x32_bf16 v[224:227], v[156:159], v[28:31], v[224:227]
    v_mfma_f32_16x16x32_bf16 v[224:227], v[160:163], v[36:39], v[224:227]
    v_mfma_f32_16x16x32_bf16 v[224:227], a[224:227], v[44:47], v[224:227]
    ds_read_b128 v[144:147], v2 offset:57344
    ds_read_b128 v[148:151], v2 offset:58368
    v_mfma_f32_16x16x32_bf16 v[228:231], a[224:227], v[48:51], 0
    v_cvt_pk_bf16_f32 v128, v232, v233
    v_cvt_pk_bf16_f32 v129, v234, v235
    v_mfma_f32_16x16x32_bf16 v[228:231], v[160:163], v[40:43], v[228:231]
    v_cvt_pk_bf16_f32 v130, v236, v237
    v_cvt_pk_bf16_f32 v131, v238, v239
    v_mfma_f32_16x16x32_bf16 v[228:231], v[156:159], v[32:35], v[228:231]
    buffer_store_dwordx4 v[128:131], v18, s[4:7], s34 offen sc1
    v_mfma_f32_16x16x32_bf16 v[228:231], v[152:155], v[24:27], v[228:231]
    s_waitcnt lgkmcnt(6)
    ds_read_b128 v[152:155], v2 offset:59392
    ds_read_b128 v[156:159], v2 offset:60416
    v_mfma_f32_16x16x32_bf16 v[228:231], a[228:231], v[56:59], v[228:231]
    v_mfma_f32_16x16x32_bf16 v[228:231], a[232:235], v[64:67], v[228:231]
    v_mfma_f32_16x16x32_bf16 v[228:231], a[236:239], v[72:75], v[228:231]
    v_mfma_f32_16x16x32_bf16 v[228:231], a[240:243], a[148:151], v[228:231]
    s_add_u32 s32, s18, 3
    ds_read_b128 v[160:163], v2 offset:61440
    ds_read_b128 a[224:227], v2 offset:62464
    v_mfma_f32_16x16x32_bf16 v[224:227], a[240:243], a[144:147], v[224:227]
    s_and_b32 s32, s32, 3
    s_mul_i32 s32, s32, 24576
    s_add_u32 s32, s32, s31
    v_mfma_f32_16x16x32_bf16 v[224:227], a[236:239], v[68:71], v[224:227]
    s_add_u32 s32, s32, 16384
    v_mfma_f32_16x16x32_bf16 v[224:227], a[232:235], v[60:63], v[224:227]
    v_mfma_f32_16x16x32_bf16 v[224:227], a[228:231], v[52:55], v[224:227]
    s_waitcnt lgkmcnt(6)
    ds_read_b128 a[228:231], v2 offset:63488
    ds_read_b128 a[232:235], v2 offset:64512
    v_mfma_f32_16x16x32_bf16 v[224:227], a[244:247], a[152:155], v[224:227]
    v_mfma_f32_16x16x32_bf16 v[224:227], a[248:251], a[160:163], v[224:227]
    v_mfma_f32_16x16x32_bf16 v[224:227], a[252:255], a[168:171], v[224:227]
    v_mfma_f32_16x16x32_bf16 v[224:227], v[140:143], a[176:179], v[224:227]
    ds_read_b128 a[236:239], v3 offset:0
    ds_read_b128 a[240:243], v3 offset:1024
    v_mfma_f32_16x16x32_bf16 v[228:231], v[140:143], a[180:183], v[228:231]
    v_mfma_f32_16x16x32_bf16 v[228:231], a[252:255], a[172:175], v[228:231]
    v_mfma_f32_16x16x32_bf16 v[228:231], a[248:251], a[164:167], v[228:231]
    v_mfma_f32_16x16x32_bf16 v[228:231], a[244:247], a[156:159], v[228:231]
    s_waitcnt lgkmcnt(6)
    ds_read_b128 a[244:247], v3 offset:2048
    ds_read_b128 a[248:251], v3 offset:3072
    v_mfma_f32_16x16x32_bf16 v[228:231], v[144:147], a[188:191], v[228:231]
    v_mfma_f32_16x16x32_bf16 v[228:231], v[148:151], a[196:199], v[228:231]
    v_mfma_f32_16x16x32_bf16 v[228:231], v[152:155], a[204:207], v[228:231]
    v_mfma_f32_16x16x32_bf16 v[228:231], v[156:159], a[212:215], v[228:231]
    ds_read_b128 a[252:255], v3 offset:4096
    ds_read_b128 v[140:143], v3 offset:5120
    v_mfma_f32_16x16x32_bf16 v[224:227], v[156:159], a[208:211], v[224:227]
    v_mfma_f32_16x16x32_bf16 v[224:227], v[152:155], a[200:203], v[224:227]
    v_mfma_f32_16x16x32_bf16 v[224:227], v[148:151], a[192:195], v[224:227]
    v_mfma_f32_16x16x32_bf16 v[224:227], v[144:147], a[184:187], v[224:227]
    s_waitcnt lgkmcnt(6)
    ds_read_b128 v[144:147], v3 offset:6144
    ds_read_b128 v[148:151], v3 offset:7168
    v_mfma_f32_16x16x32_bf16 v[224:227], v[160:163], a[216:219], v[224:227]
    v_mfma_f32_16x16x32_bf16 v[224:227], a[224:227], a[0:3], v[224:227]
    v_mfma_f32_16x16x32_bf16 v[224:227], a[228:231], a[8:11], v[224:227]
    v_mfma_f32_16x16x32_bf16 v[224:227], a[232:235], a[16:19], v[224:227]
    ds_read_b128 v[152:155], v3 offset:8192
    ds_read_b128 v[156:159], v3 offset:9216
    v_mfma_f32_16x16x32_bf16 v[228:231], a[232:235], a[20:23], v[228:231]
    v_mfma_f32_16x16x32_bf16 v[228:231], a[228:231], a[12:15], v[228:231]
    v_mfma_f32_16x16x32_bf16 v[228:231], a[224:227], a[4:7], v[228:231]
    v_mfma_f32_16x16x32_bf16 v[228:231], v[160:163], a[220:223], v[228:231]
    s_waitcnt lgkmcnt(6)
    ds_read_b128 v[160:163], v3 offset:10240
    ds_read_b128 a[224:227], v3 offset:11264
    v_mfma_f32_16x16x32_bf16 v[228:231], a[236:239], a[28:31], v[228:231]
    v_mfma_f32_16x16x32_bf16 v[228:231], a[240:243], a[36:39], v[228:231]
    v_mfma_f32_16x16x32_bf16 v[228:231], a[244:247], a[44:47], v[228:231]
    v_mfma_f32_16x16x32_bf16 v[228:231], a[248:251], a[52:55], v[228:231]
    ds_read_b128 a[228:231], v3 offset:12288
    ds_read_b128 a[232:235], v3 offset:13312
    v_mfma_f32_16x16x32_bf16 v[224:227], a[248:251], a[48:51], v[224:227]
    v_mfma_f32_16x16x32_bf16 v[224:227], a[244:247], a[40:43], v[224:227]
    v_mfma_f32_16x16x32_bf16 v[224:227], a[240:243], a[32:35], v[224:227]
    v_mfma_f32_16x16x32_bf16 v[224:227], a[236:239], a[24:27], v[224:227]
    s_waitcnt lgkmcnt(6)
    ds_read_b128 a[236:239], v3 offset:14336
    ds_read_b128 a[240:243], v3 offset:15360
    v_mfma_f32_16x16x32_bf16 v[224:227], a[252:255], a[56:59], v[224:227]
    v_mfma_f32_16x16x32_bf16 v[224:227], v[140:143], a[64:67], v[224:227]
    v_mfma_f32_16x16x32_bf16 v[224:227], v[144:147], a[72:75], v[224:227]
    v_mfma_f32_16x16x32_bf16 v[224:227], v[148:151], a[80:83], v[224:227]
    ds_read_b128 a[244:247], v1 offset:0
    ds_read_b128 a[248:251], v1 offset:1024
    v_mfma_f32_16x16x32_bf16 v[228:231], v[148:151], a[84:87], v[228:231]
    v_mfma_f32_16x16x32_bf16 v[228:231], v[144:147], a[76:79], v[228:231]
    v_mfma_f32_16x16x32_bf16 v[228:231], v[140:143], a[68:71], v[228:231]
    v_mfma_f32_16x16x32_bf16 v[228:231], a[252:255], a[60:63], v[228:231]
    s_waitcnt lgkmcnt(6)
    ds_read_b128 a[252:255], v1 offset:2048
    ds_read_b128 v[140:143], v1 offset:3072
    v_mfma_f32_16x16x32_bf16 v[228:231], v[152:155], v[80:83], v[228:231]
    buffer_load_dword v15, v4, s[80:83], s79 offen offset:0
    v_mfma_f32_16x16x32_bf16 v[228:231], v[156:159], a[92:95], v[228:231]
    buffer_load_dword v15, v4, s[80:83], s79 offen offset:256
    v_mfma_f32_16x16x32_bf16 v[228:231], v[160:163], a[100:103], v[228:231]
    v_mfma_f32_16x16x32_bf16 v[228:231], a[224:227], a[108:111], v[228:231]
    ds_read_b128 v[144:147], v1 offset:4096
    ds_read_b128 v[148:151], v1 offset:5120
    v_mfma_f32_16x16x32_bf16 v[224:227], a[224:227], a[104:107], v[224:227]
    s_waitcnt vmcnt(2)
    v_mfma_f32_16x16x32_bf16 v[224:227], v[160:163], a[96:99], v[224:227]
    buffer_atomic_add v10, v9, s[4:7], s28 offen offset:12 sc1
    v_mfma_f32_16x16x32_bf16 v[224:227], v[156:159], a[88:91], v[224:227]
    buffer_load_dwordx2 v[178:179], v17, s[4:7], s53 offen offset:0 sc1
    v_mfma_f32_16x16x32_bf16 v[224:227], v[152:155], v[76:79], v[224:227]
    s_waitcnt lgkmcnt(6)
    ds_read_b128 v[152:155], v1 offset:6144
    ds_read_b128 v[156:159], v1 offset:7168
    v_mfma_f32_16x16x32_bf16 v[224:227], a[228:231], v[84:87], v[224:227]
    buffer_load_dwordx2 v[180:181], v17, s[4:7], s53 offen offset:256 sc1
    v_mfma_f32_16x16x32_bf16 v[224:227], a[232:235], a[112:115], v[224:227]
    buffer_load_dwordx4 v[164:167], v5, s[4:7], s54 offen offset:0 sc1
    v_mfma_f32_16x16x32_bf16 v[224:227], a[236:239], a[120:123], v[224:227]
    buffer_load_dwordx4 v[168:171], v5, s[4:7], s54 offen offset:256 sc1
    v_mfma_f32_16x16x32_bf16 v[224:227], a[240:243], a[128:131], v[224:227]
    ds_read_b128 v[160:163], v1 offset:8192
    ds_read_b128 a[224:227], v1 offset:9216
    v_mfma_f32_16x16x32_bf16 v[228:231], a[240:243], a[132:135], v[228:231]
    s_barrier
    v_mfma_f32_16x16x32_bf16 v[228:231], a[236:239], a[124:127], v[228:231]
    s_mul_i32 s43, s20, 16384
    s_add_u32 m0, s43, 73728
    v_mfma_f32_16x16x32_bf16 v[228:231], a[232:235], a[116:119], v[228:231]
    s_add_u32 s55, s43, 524288
    v_cvt_pk_bf16_f32 v224, v224, v225
    s_add_u32 s55, s55, s40
    v_mfma_f32_16x16x32_bf16 v[228:231], a[228:231], v[88:91], v[228:231]
    s_waitcnt lgkmcnt(6)
    ds_read_b128 a[228:231], v1 offset:10240
    ds_read_b128 a[232:235], v1 offset:11264
    v_mfma_f32_16x16x32_bf16 v[244:247], a[244:247], v[24:27], 0
    buffer_load_dwordx4 v183, s[4:7], s55 offen offset:0 sc1 lds
    v_mfma_f32_16x16x32_bf16 v[244:247], a[248:251], v[32:35], v[244:247]
    v_cvt_pk_bf16_f32 v225, v226, v227
    v_mfma_f32_16x16x32_bf16 v[244:247], a[252:255], v[40:43], v[244:247]
    v_cvt_pk_bf16_f32 v226, v228, v229
    v_cvt_pk_bf16_f32 v227, v230, v231
    v_mfma_f32_16x16x32_bf16 v[244:247], v[140:143], v[48:51], v[244:247]
    ds_read_b128 a[236:239], v1 offset:12288
    ds_read_b128 a[240:243], v1 offset:13312
    v_mfma_f32_16x16x32_bf16 v[240:243], v[140:143], v[44:47], 0
    buffer_store_dwordx4 v[224:227], v1, s[4:7], s32 offen offset:1024 sc1
    v_mfma_f32_16x16x32_bf16 v[240:243], a[252:255], v[36:39], v[240:243]
    buffer_load_dwordx4 v183, s[4:7], s55 offen offset:1024 sc1 lds
    v_mfma_f32_16x16x32_bf16 v[240:243], a[248:251], v[28:31], v[240:243]
    v_mfma_f32_16x16x32_bf16 v[240:243], a[244:247], v[20:23], v[240:243]
    s_waitcnt lgkmcnt(6)
    ds_read_b128 a[244:247], v1 offset:14336
    ds_read_b128 a[248:251], v1 offset:15360
    v_mfma_f32_16x16x32_bf16 v[248:251], v[144:147], v[20:23], 0
    v_mfma_f32_16x16x32_bf16 v[248:251], v[148:151], v[28:31], v[248:251]
    buffer_load_dwordx4 v183, s[4:7], s55 offen offset:2048 sc1 lds
    v_mfma_f32_16x16x32_bf16 v[248:251], v[152:155], v[36:39], v[248:251]
    v_mfma_f32_16x16x32_bf16 v[248:251], v[156:159], v[44:47], v[248:251]
    ds_read_b128 a[252:255], v1 offset:16384
    ds_read_b128 v[140:143], v1 offset:17408
    v_mfma_f32_16x16x32_bf16 v[252:255], v[156:159], v[48:51], 0
    v_mfma_f32_16x16x32_bf16 v[252:255], v[152:155], v[40:43], v[252:255]
    buffer_load_dwordx4 v183, s[4:7], s55 offen offset:3072 sc1 lds
    v_mfma_f32_16x16x32_bf16 v[252:255], v[148:151], v[32:35], v[252:255]
    s_add_u32 m0, s43, 77824
    s_add_u32 s55, s43, 528384
    s_add_u32 s55, s55, s40
    v_mfma_f32_16x16x32_bf16 v[252:255], v[144:147], v[24:27], v[252:255]
    s_waitcnt lgkmcnt(6)
    ds_read_b128 v[144:147], v1 offset:18432
    ds_read_b128 v[148:151], v1 offset:19456
    v_mfma_f32_16x16x32_bf16 v[244:247], v[160:163], v[56:59], v[244:247]
    v_mfma_f32_16x16x32_bf16 v[244:247], a[224:227], v[64:67], v[244:247]
    v_mfma_f32_16x16x32_bf16 v[244:247], a[228:231], v[72:75], v[244:247]
    buffer_load_dwordx4 v183, s[4:7], s55 offen offset:0 sc1 lds
    v_mfma_f32_16x16x32_bf16 v[244:247], a[232:235], a[148:151], v[244:247]
    ds_read_b128 v[152:155], v1 offset:20480
    ds_read_b128 v[156:159], v1 offset:21504
    v_mfma_f32_16x16x32_bf16 v[240:243], a[232:235], a[144:147], v[240:243]
    v_mfma_f32_16x16x32_bf16 v[240:243], a[228:231], v[68:71], v[240:243]
    v_mfma_f32_16x16x32_bf16 v[240:243], a[224:227], v[60:63], v[240:243]
    buffer_load_dwordx4 v183, s[4:7], s55 offen offset:1024 sc1 lds
    v_mfma_f32_16x16x32_bf16 v[240:243], v[160:163], v[52:55], v[240:243]
    s_waitcnt lgkmcnt(6)
    ds_read_b128 v[160:163], v1 offset:22528
    ds_read_b128 a[224:227], v1 offset:23552
    v_mfma_f32_16x16x32_bf16 v[248:251], a[236:239], v[52:55], v[248:251]
    v_mfma_f32_16x16x32_bf16 v[248:251], a[240:243], v[60:63], v[248:251]
    v_mfma_f32_16x16x32_bf16 v[248:251], a[244:247], v[68:71], v[248:251]
    v_mfma_f32_16x16x32_bf16 v[248:251], a[248:251], a[144:147], v[248:251]
    ds_read_b128 a[228:231], v1 offset:24576
    ds_read_b128 a[232:235], v1 offset:25600
    v_mfma_f32_16x16x32_bf16 v[252:255], a[248:251], a[148:151], v[252:255]
    buffer_load_dwordx4 v183, s[4:7], s55 offen offset:2048 sc1 lds
    v_mfma_f32_16x16x32_bf16 v[252:255], a[244:247], v[72:75], v[252:255]
    v_mfma_f32_16x16x32_bf16 v[252:255], a[240:243], v[64:67], v[252:255]
    v_mfma_f32_16x16x32_bf16 v[252:255], a[236:239], v[56:59], v[252:255]
    s_waitcnt lgkmcnt(6)
    ds_read_b128 a[236:239], v1 offset:26624
    ds_read_b128 a[240:243], v1 offset:27648
    v_mfma_f32_16x16x32_bf16 v[244:247], a[252:255], a[156:159], v[244:247]
    buffer_load_dwordx4 v183, s[4:7], s55 offen offset:3072 sc1 lds
    v_mfma_f32_16x16x32_bf16 v[244:247], v[140:143], a[164:167], v[244:247]
    s_add_u32 m0, s43, 81920
    s_add_u32 s55, s43, 532480
    s_add_u32 s55, s55, s40
    v_mfma_f32_16x16x32_bf16 v[244:247], v[144:147], a[172:175], v[244:247]
    v_mfma_f32_16x16x32_bf16 v[244:247], v[148:151], a[180:183], v[244:247]
    ds_read_b128 a[244:247], v1 offset:28672
    ds_read_b128 a[248:251], v1 offset:29696
    v_mfma_f32_16x16x32_bf16 v[240:243], v[148:151], a[176:179], v[240:243]
    buffer_load_dwordx4 v183, s[4:7], s55 offen offset:0 sc1 lds
    v_mfma_f32_16x16x32_bf16 v[240:243], v[144:147], a[168:171], v[240:243]
    v_mfma_f32_16x16x32_bf16 v[240:243], v[140:143], a[160:163], v[240:243]
    v_mfma_f32_16x16x32_bf16 v[240:243], a[252:255], a[152:155], v[240:243]
    s_waitcnt lgkmcnt(6)
    ds_read_b128 a[252:255], v1 offset:30720
    ds_read_b128 v[140:143], v1 offset:31744
    v_mfma_f32_16x16x32_bf16 v[248:251], v[152:155], a[152:155], v[248:251]
    buffer_load_dwordx4 v183, s[4:7], s55 offen offset:1024 sc1 lds
    v_mfma_f32_16x16x32_bf16 v[248:251], v[156:159], a[160:163], v[248:251]
    v_mfma_f32_16x16x32_bf16 v[248:251], v[160:163], a[168:171], v[248:251]
    v_mfma_f32_16x16x32_bf16 v[248:251], a[224:227], a[176:179], v[248:251]
    ds_read_b128 v[144:147], v1 offset:32768
    ds_read_b128 v[148:151], v1 offset:33792
    v_mfma_f32_16x16x32_bf16 v[252:255], a[224:227], a[180:183], v[252:255]
    v_mfma_f32_16x16x32_bf16 v[252:255], v[160:163], a[172:175], v[252:255]
    buffer_load_dwordx4 v183, s[4:7], s55 offen offset:2048 sc1 lds
    v_mfma_f32_16x16x32_bf16 v[252:255], v[156:159], a[164:167], v[252:255]
    v_mfma_f32_16x16x32_bf16 v[252:255], v[152:155], a[156:159], v[252:255]
    s_waitcnt lgkmcnt(6)
    ds_read_b128 v[152:155], v1 offset:34816
    ds_read_b128 v[156:159], v1 offset:35840
    v_mfma_f32_16x16x32_bf16 v[244:247], a[228:231], a[188:191], v[244:247]
    v_mfma_f32_16x16x32_bf16 v[244:247], a[232:235], a[196:199], v[244:247]
    buffer_load_dwordx4 v183, s[4:7], s55 offen offset:3072 sc1 lds
    v_mfma_f32_16x16x32_bf16 v[244:247], a[236:239], a[204:207], v[244:247]
    s_add_u32 m0, s43, 86016
    s_add_u32 s55, s43, 536576
    s_add_u32 s55, s55, s40
    v_mfma_f32_16x16x32_bf16 v[244:247], a[240:243], a[212:215], v[244:247]
    s_waitcnt vmcnt(13)
    ds_read_b128 v[160:163], v1 offset:36864
    ds_read_b128 a[224:227], v1 offset:37888
    v_mfma_f32_16x16x32_bf16 v[240:243], a[240:243], a[208:211], v[240:243]
    v_lshlrev_b32 v184, 16, v178
    v_and_b32 v185, 0xffff0000, v178
    v_mfma_f32_16x16x32_bf16 v[240:243], a[236:239], a[200:203], v[240:243]
    v_lshlrev_b32 v186, 16, v179
    v_and_b32 v187, 0xffff0000, v179
    v_mfma_f32_16x16x32_bf16 v[240:243], a[232:235], a[192:195], v[240:243]
    buffer_load_dwordx4 v183, s[4:7], s55 offen offset:0 sc1 lds
    v_mfma_f32_16x16x32_bf16 v[240:243], a[228:231], a[184:187], v[240:243]
    s_waitcnt lgkmcnt(6)
    ds_read_b128 a[228:231], v1 offset:38912
    ds_read_b128 a[232:235], v1 offset:39936
    v_mfma_f32_16x16x32_bf16 v[248:251], a[244:247], a[184:187], v[248:251]
    v_lshlrev_b32 v188, 16, v180
    v_and_b32 v189, 0xffff0000, v180
    v_mfma_f32_16x16x32_bf16 v[248:251], a[248:251], a[192:195], v[248:251]
    v_lshlrev_b32 v190, 16, v181
    v_and_b32 v191, 0xffff0000, v181
    v_mfma_f32_16x16x32_bf16 v[248:251], a[252:255], a[200:203], v[248:251]
    buffer_load_dwordx4 v183, s[4:7], s55 offen offset:1024 sc1 lds
    v_mfma_f32_16x16x32_bf16 v[248:251], v[140:143], a[208:211], v[248:251]
    ds_read_b128 a[236:239], v1 offset:40960
    ds_read_b128 a[240:243], v1 offset:41984
    v_mfma_f32_16x16x32_bf16 v[252:255], v[140:143], a[212:215], v[252:255]
    v_lshlrev_b32 v192, 16, v164
    v_and_b32 v193, 0xffff0000, v164
    v_mfma_f32_16x16x32_bf16 v[252:255], a[252:255], a[204:207], v[252:255]
    v_lshlrev_b32 v194, 16, v165
    v_and_b32 v195, 0xffff0000, v165
    v_mfma_f32_16x16x32_bf16 v[252:255], a[248:251], a[196:199], v[252:255]
    s_waitcnt vmcnt(13)
    s_load_dword s3, s[12:13], 12 glc
    v_lshlrev_b32 v200, 16, v166
    v_mfma_f32_16x16x32_bf16 v[252:255], a[244:247], a[188:191], v[252:255]
    s_waitcnt lgkmcnt(6)
    ds_read_b128 a[244:247], v1 offset:43008
    ds_read_b128 a[248:251], v1 offset:44032
    v_mfma_f32_16x16x32_bf16 v[244:247], v[144:147], a[220:223], v[244:247]
    buffer_atomic_add v10, v14, s[4:7], s28 offen offset:16 sc1
    v_mfma_f32_16x16x32_bf16 v[244:247], v[148:151], a[4:7], v[244:247]
    buffer_load_dwordx4 v183, s[4:7], s55 offen offset:2048 sc1 lds
    v_mfma_f32_16x16x32_bf16 v[244:247], v[152:155], a[12:15], v[244:247]
    v_and_b32 v201, 0xffff0000, v166
    v_lshlrev_b32 v202, 16, v167
    v_mfma_f32_16x16x32_bf16 v[244:247], v[156:159], a[20:23], v[244:247]
    ds_read_b128 a[252:255], v1 offset:45056
    ds_read_b128 v[140:143], v1 offset:46080
    v_mfma_f32_16x16x32_bf16 v[240:243], v[156:159], a[16:19], v[240:243]
    s_barrier
    v_mfma_f32_16x16x32_bf16 v[240:243], v[152:155], a[8:11], v[240:243]
    buffer_load_dwordx4 v183, s[4:7], s55 offen offset:3072 sc1 lds
    v_mfma_f32_16x16x32_bf16 v[240:243], v[148:151], a[0:3], v[240:243]
    s_mul_i32 s43, s20, 9216
    s_add_u32 m0, s43, 0
    s_add_u32 s55, s43, 588800
    v_mfma_f32_16x16x32_bf16 v[240:243], v[144:147], a[216:219], v[240:243]
    s_waitcnt lgkmcnt(6)
    ds_read_b128 v[144:147], v1 offset:47104
    ds_read_b128 v[148:151], v1 offset:48128
    v_mfma_f32_16x16x32_bf16 v[248:251], v[160:163], a[216:219], v[248:251]
    s_add_u32 s55, s55, s40
    v_and_b32 v203, 0xffff0000, v167
    v_lshlrev_b32 v196, 16, v168
    v_mfma_f32_16x16x32_bf16 v[248:251], a[224:227], a[0:3], v[248:251]
    buffer_load_dwordx4 v183, s[4:7], s55 offen offset:0 sc1 lds
    v_mfma_f32_16x16x32_bf16 v[248:251], a[228:231], a[8:11], v[248:251]
    v_and_b32 v197, 0xffff0000, v168
    v_lshlrev_b32 v198, 16, v169
    v_mfma_f32_16x16x32_bf16 v[248:251], a[232:235], a[16:19], v[248:251]
    ds_read_b128 v[152:155], v1 offset:49152
    ds_read_b128 v[156:159], v1 offset:50176
    v_mfma_f32_16x16x32_bf16 v[252:255], a[232:235], a[20:23], v[252:255]
    v_and_b32 v199, 0xffff0000, v169
    v_lshlrev_b32 v204, 16, v170
    v_mfma_f32_16x16x32_bf16 v[252:255], a[228:231], a[12:15], v[252:255]
    buffer_load_dwordx4 v183, s[4:7], s55 offen offset:1024 sc1 lds
    v_mfma_f32_16x16x32_bf16 v[252:255], a[224:227], a[4:7], v[252:255]
    v_and_b32 v205, 0xffff0000, v170
    v_lshlrev_b32 v206, 16, v171
    v_mfma_f32_16x16x32_bf16 v[252:255], v[160:163], a[220:223], v[252:255]
    s_waitcnt lgkmcnt(6)
    ds_read_b128 v[160:163], v1 offset:51200
    ds_read_b128 a[224:227], v1 offset:52224
    v_mfma_f32_16x16x32_bf16 v[244:247], a[236:239], a[28:31], v[244:247]
    v_and_b32 v207, 0xffff0000, v171
    s_mov_b32 s36, 0x00003f80
    v_mfma_f32_16x16x32_bf16 v[244:247], a[240:243], a[36:39], v[244:247]
    buffer_load_dwordx4 v183, s[4:7], s55 offen offset:2048 sc1 lds
    v_mfma_f32_16x16x32_bf16 v[244:247], a[244:247], a[44:47], v[244:247]
    s_mov_b32 s37, 0x3f800000
    v_mov_b32 v182, 0x3f317218
    v_mfma_f32_16x16x32_bf16 v[244:247], a[248:251], a[52:55], v[244:247]
    ds_read_b128 a[228:231], v1 offset:53248
    ds_read_b128 a[232:235], v1 offset:54272
    v_mfma_f32_16x16x32_bf16 v[240:243], a[248:251], a[48:51], v[240:243]
    s_cmp_eq_u32 s20, s18
    s_cselect_b32 s38, 0x3f317218, 0
    v_mov_b32 v172, s38
    v_mfma_f32_16x16x32_bf16 v[240:243], a[244:247], a[40:43], v[240:243]
    v_mfma_f32_16x16x32_bf16 v[240:243], a[240:243], a[32:35], v[240:243]
    buffer_load_dwordx4 v183, s[4:7], s55 offen offset:3072 sc1 lds
    v_mfma_f32_16x16x32_bf16 v[240:243], a[236:239], a[24:27], v[240:243]
    s_waitcnt lgkmcnt(6)
    ds_read_b128 a[236:239], v1 offset:55296
    ds_read_b128 a[240:243], v1 offset:56320
    v_mfma_f32_16x16x32_bf16 v[248:251], a[252:255], a[24:27], v[248:251]
    s_add_u32 m0, s43, 4096
    s_add_u32 s55, s43, 592896
    s_add_u32 s55, s55, s40
    v_mfma_f32_16x16x32_bf16 v[248:251], v[140:143], a[32:35], v[248:251]
    v_mfma_f32_16x16x32_bf16 v[248:251], v[144:147], a[40:43], v[248:251]
    buffer_load_dwordx4 v183, s[4:7], s55 offen offset:0 sc1 lds
    v_mfma_f32_16x16x32_bf16 v[248:251], v[148:151], a[48:51], v[248:251]
    ds_read_b128 a[244:247], v1 offset:57344
    ds_read_b128 a[248:251], v1 offset:58368
    v_mfma_f32_16x16x32_bf16 v[252:255], v[148:151], a[52:55], v[252:255]
    v_mfma_f32_16x16x32_bf16 v[252:255], v[144:147], a[44:47], v[252:255]
    v_mfma_f32_16x16x32_bf16 v[252:255], v[140:143], a[36:39], v[252:255]
    v_mfma_f32_16x16x32_bf16 v[252:255], a[252:255], a[28:31], v[252:255]
    s_waitcnt lgkmcnt(6)
    ds_read_b128 a[252:255], v1 offset:59392
    ds_read_b128 v[140:143], v1 offset:60416
    v_mfma_f32_16x16x32_bf16 v[244:247], v[152:155], a[60:63], v[244:247]
    buffer_load_dwordx4 v183, s[4:7], s55 offen offset:1024 sc1 lds
    v_mfma_f32_16x16x32_bf16 v[244:247], v[156:159], a[68:71], v[244:247]
    v_mfma_f32_16x16x32_bf16 v[244:247], v[160:163], a[76:79], v[244:247]
    v_mfma_f32_16x16x32_bf16 v[244:247], a[224:227], a[84:87], v[244:247]
    ds_read_b128 v[144:147], v1 offset:61440
    ds_read_b128 v[148:151], v1 offset:62464
    v_mfma_f32_16x16x32_bf16 v[240:243], a[224:227], a[80:83], v[240:243]
    buffer_load_dwordx4 v183, s[4:7], s55 offen offset:2048 sc1 lds
    v_mfma_f32_16x16x32_bf16 v[240:243], v[160:163], a[72:75], v[240:243]
    v_mfma_f32_16x16x32_bf16 v[240:243], v[156:159], a[64:67], v[240:243]
    s_waitcnt lgkmcnt(0)
    s_cmp_lt_u32 s3, 12
    s_cbranch_scc1 L_inte_chk_33_slow
L_inte_chk_33_back:
    v_mfma_f32_16x16x32_bf16 v[240:243], v[152:155], a[56:59], v[240:243]
    s_add_u32 s58, s35, 0
    ds_read_b128 v[152:155], v1 offset:63488
    ds_read_b128 v[156:159], v1 offset:64512
    v_mfma_f32_16x16x32_bf16 v[248:251], a[228:231], a[56:59], v[248:251]
    buffer_load_dwordx4 v[92:95], v1, s[4:7], s58 offen offset:0 sc1
    v_mfma_f32_16x16x32_bf16 v[248:251], a[232:235], a[64:67], v[248:251]
    buffer_load_dwordx4 v[96:99], v1, s[4:7], s58 offen offset:1024 sc1
    v_mfma_f32_16x16x32_bf16 v[248:251], a[236:239], a[72:75], v[248:251]
    s_add_u32 s58, s35, 8192
    v_mfma_f32_16x16x32_bf16 v[248:251], a[240:243], a[80:83], v[248:251]
    ds_read_b128 v[160:163], v2 offset:0
    ds_read_b128 a[224:227], v2 offset:1024
    v_mfma_f32_16x16x32_bf16 v[252:255], a[240:243], a[84:87], v[252:255]
    buffer_load_dwordx4 v[100:103], v1, s[4:7], s58 offen offset:0 sc1
    v_mfma_f32_16x16x32_bf16 v[252:255], a[236:239], a[76:79], v[252:255]
    buffer_load_dwordx4 v[104:107], v1, s[4:7], s58 offen offset:1024 sc1
    v_mfma_f32_16x16x32_bf16 v[252:255], a[232:235], a[68:71], v[252:255]
    s_add_u32 s58, s35, 16384
    v_mfma_f32_16x16x32_bf16 v[252:255], a[228:231], a[60:63], v[252:255]
    ds_read_b128 a[228:231], v2 offset:2048
    ds_read_b128 a[232:235], v2 offset:3072
    v_mfma_f32_16x16x32_bf16 v[244:247], a[244:247], v[80:83], v[244:247]
    buffer_load_dwordx4 v[108:111], v1, s[4:7], s58 offen offset:0 sc1
    v_mfma_f32_16x16x32_bf16 v[244:247], a[248:251], a[92:95], v[244:247]
    buffer_load_dwordx4 v[116:119], v19, s[4:7], s33 offen offset:0 sc1
    v_mfma_f32_16x16x32_bf16 v[244:247], a[252:255], a[100:103], v[244:247]
    s_load_dword s2, s[12:13], 16 glc
    buffer_load_dwordx4 v[120:123], v19, s[4:7], s33 offen offset:1024 sc1
    v_mfma_f32_16x16x32_bf16 v[244:247], v[140:143], a[108:111], v[244:247]
    ds_read_b128 a[236:239], v2 offset:4096
    ds_read_b128 a[240:243], v2 offset:5120
    v_mfma_f32_16x16x32_bf16 v[240:243], v[140:143], a[104:107], v[240:243]
    buffer_load_dwordx4 v[124:127], v19, s[4:7], s33 offen offset:2048 sc1
    v_mfma_f32_16x16x32_bf16 v[240:243], a[252:255], a[96:99], v[240:243]
    v_mfma_f32_16x16x32_bf16 v[240:243], a[248:251], a[88:91], v[240:243]
    v_mfma_f32_16x16x32_bf16 v[240:243], a[244:247], v[76:79], v[240:243]
    s_waitcnt lgkmcnt(6)
    ds_read_b128 a[244:247], v2 offset:6144
    ds_read_b128 a[248:251], v2 offset:7168
    v_mfma_f32_16x16x32_bf16 v[248:251], v[144:147], v[76:79], v[248:251]
    v_mfma_f32_16x16x32_bf16 v[248:251], v[148:151], a[88:91], v[248:251]
    v_mfma_f32_16x16x32_bf16 v[248:251], v[152:155], a[96:99], v[248:251]
    v_mfma_f32_16x16x32_bf16 v[248:251], v[156:159], a[104:107], v[248:251]
    v_mfma_f32_16x16x32_bf16 v[252:255], v[156:159], a[108:111], v[252:255]
    v_mfma_f32_16x16x32_bf16 v[252:255], v[152:155], a[100:103], v[252:255]
    v_mfma_f32_16x16x32_bf16 v[252:255], v[148:151], a[92:95], v[252:255]
    v_mfma_f32_16x16x32_bf16 v[252:255], v[144:147], v[80:83], v[252:255]
    s_waitcnt lgkmcnt(4)
    v_mfma_f32_16x16x32_bf16 v[244:247], v[160:163], v[88:91], v[244:247]
    v_mfma_f32_16x16x32_bf16 v[244:247], a[224:227], a[116:119], v[244:247]
    v_mfma_f32_16x16x32_bf16 v[244:247], a[228:231], a[124:127], v[244:247]
    v_mfma_f32_16x16x32_bf16 v[244:247], a[232:235], a[132:135], v[244:247]
    v_mfma_f32_16x16x32_bf16 v[240:243], a[232:235], a[128:131], v[240:243]
    v_mfma_f32_16x16x32_bf16 v[240:243], a[228:231], a[120:123], v[240:243]
    v_mfma_f32_16x16x32_bf16 v[240:243], a[224:227], a[112:115], v[240:243]
    v_mfma_f32_16x16x32_bf16 v[240:243], v[160:163], v[84:87], v[240:243]
    s_waitcnt lgkmcnt(0)
    v_mfma_f32_16x16x32_bf16 v[248:251], a[236:239], v[84:87], v[248:251]
    v_mfma_f32_16x16x32_bf16 v[248:251], a[240:243], a[112:115], v[248:251]
    v_mfma_f32_16x16x32_bf16 v[248:251], a[244:247], a[120:123], v[248:251]
    v_mfma_f32_16x16x32_bf16 v[248:251], a[248:251], a[128:131], v[248:251]
    buffer_load_dwordx4 v183, s[4:7], s55 offen offset:3072 sc1 lds
    v_mfma_f32_16x16x32_bf16 v[252:255], a[248:251], a[132:135], v[252:255]
    s_add_u32 m0, s43, 8192
    s_add_u32 s55, s43, 596992
    s_add_u32 s55, s55, s40
    v_mfma_f32_16x16x32_bf16 v[252:255], a[244:247], a[124:127], v[252:255]
    v_mfma_f32_16x16x32_bf16 v[252:255], a[240:243], a[116:119], v[252:255]
    v_mfma_f32_16x16x32_bf16 v[252:255], a[236:239], v[88:91], v[252:255]
    buffer_load_dwordx4 v183, s[4:7], s55 offen offset:0 sc1 lds
    s_waitcnt lgkmcnt(0)
    s_cmp_ge_u32 s2, 4
    s_cbranch_scc1 L_inte_cf_39
L_inte_poll_40:
    s_load_dword s57, s[12:13], 16 glc
    s_waitcnt lgkmcnt(0)
    s_cmp_ge_u32 s57, 4
    s_cbranch_scc1 L_inte_poll_40_x
    s_sub_u32 s27, s27, 1
    s_cmp_gt_i32 s27, 0
    s_cbranch_scc1 L_inte_poll_40
L_inte_poll_40_x:
L_inte_cf_39:
    s_add_u32 s58, s35, 16384
    buffer_load_dwordx4 v[112:115], v1, s[4:7], s58 offen offset:1024 sc1
    s_cmp_eq_u32 s22, 1
    s_cbranch_scc1 L_inte_side_41
    s_add_u32 s53, s53, s15
    s_add_u32 s53, s53, 28573696
    s_add_u32 s54, s54, 28573696
    s_lshl_b32 s34, s23, 12
    s_lshl_b32 s35, s17, 8
    s_add_u32 s34, s34, s35
    s_add_u32 s34, s34, s21
    s_add_u32 s34, s34, 51773440
    s_waitcnt vmcnt(5)
    v_dot2c_f32_bf16 v232, s36, v116
    v_dot2c_f32_bf16 v233, s37, v116
    v_dot2c_f32_bf16 v234, s36, v117
    v_dot2c_f32_bf16 v235, s37, v117
    v_dot2c_f32_bf16 v236, s36, v118
    v_dot2c_f32_bf16 v237, s37, v118
    v_dot2c_f32_bf16 v238, s36, v119
    v_dot2c_f32_bf16 v239, s37, v119
    s_waitcnt vmcnt(4)
    v_dot2c_f32_bf16 v232, s36, v120
    v_dot2c_f32_bf16 v233, s37, v120
    v_dot2c_f32_bf16 v234, s36, v121
    v_dot2c_f32_bf16 v235, s37, v121
    v_dot2c_f32_bf16 v236, s36, v122
    v_dot2c_f32_bf16 v237, s37, v122
    v_dot2c_f32_bf16 v238, s36, v123
    v_dot2c_f32_bf16 v239, s37, v123
    s_waitcnt vmcnt(3)
    v_dot2c_f32_bf16 v232, s36, v124
    v_dot2c_f32_bf16 v233, s37, v124
    v_dot2c_f32_bf16 v234, s36, v125
    v_dot2c_f32_bf16 v235, s37, v125
    v_dot2c_f32_bf16 v236, s36, v126
    v_dot2c_f32_bf16 v237, s37, v126
    v_dot2c_f32_bf16 v238, s36, v127
    v_dot2c_f32_bf16 v239, s37, v127
    v_pk_fma_f32 v[232:233], v[232:233], v[172:173], v[184:185] op_sel_hi:[1,0,1]
    v_pk_fma_f32 v[234:235], v[234:235], v[172:173], v[186:187] op_sel_hi:[1,0,1]
    v_pk_fma_f32 v[236:237], v[236:237], v[172:173], v[188:189] op_sel_hi:[1,0,1]
    v_pk_fma_f32 v[238:239], v[238:239], v[172:173], v[190:191] op_sel_hi:[1,0,1]
    v_cvt_pk_bf16_f32 v148, v232, v233
    v_cvt_pk_bf16_f32 v149, v234, v235
    v_cvt_pk_bf16_f32 v150, v236, v237
    v_cvt_pk_bf16_f32 v151, v238, v239
    s_nop 0
    v_permlane16_swap_b32 v148, v150
    v_permlane16_swap_b32 v149, v151
    buffer_store_dwordx4 v[148:151], v19, s[4:7], s53 offen sc1
    v_dot2c_f32_bf16 v240, s36, v92
    v_dot2c_f32_bf16 v241, s37, v92
    v_dot2c_f32_bf16 v242, s36, v93
    v_dot2c_f32_bf16 v243, s37, v93
    v_dot2c_f32_bf16 v244, s36, v94
    v_dot2c_f32_bf16 v245, s37, v94
    v_dot2c_f32_bf16 v246, s36, v95
    v_dot2c_f32_bf16 v247, s37, v95
    v_dot2c_f32_bf16 v240, s36, v100
    v_dot2c_f32_bf16 v241, s37, v100
    v_dot2c_f32_bf16 v242, s36, v101
    v_dot2c_f32_bf16 v243, s37, v101
    v_dot2c_f32_bf16 v244, s36, v102
    v_dot2c_f32_bf16 v245, s37, v102
    v_dot2c_f32_bf16 v246, s36, v103
    v_dot2c_f32_bf16 v247, s37, v103
    v_dot2c_f32_bf16 v240, s36, v108
    v_dot2c_f32_bf16 v241, s37, v108
    v_dot2c_f32_bf16 v242, s36, v109
    v_dot2c_f32_bf16 v243, s37, v109
    v_dot2c_f32_bf16 v244, s36, v110
    v_dot2c_f32_bf16 v245, s37, v110
    v_dot2c_f32_bf16 v246, s36, v111
    v_dot2c_f32_bf16 v247, s37, v111
    v_pk_fma_f32 v[240:241], v[240:241], v[182:183], v[192:193] op_sel_hi:[1,0,1]
    v_pk_fma_f32 v[242:243], v[242:243], v[182:183], v[194:195] op_sel_hi:[1,0,1]
    v_pk_fma_f32 v[244:245], v[244:245], v[182:183], v[196:197] op_sel_hi:[1,0,1]
    v_pk_fma_f32 v[246:247], v[246:247], v[182:183], v[198:199] op_sel_hi:[1,0,1]
    v_cvt_pk_bf16_f32 v152, v240, v241
    v_cvt_pk_bf16_f32 v153, v242, v243
    v_cvt_pk_bf16_f32 v156, v244, v245
    v_cvt_pk_bf16_f32 v157, v246, v247
    v_dot2c_f32_bf16 v248, s36, v96
    v_dot2c_f32_bf16 v249, s37, v96
    v_dot2c_f32_bf16 v250, s36, v97
    v_dot2c_f32_bf16 v251, s37, v97
    v_dot2c_f32_bf16 v252, s36, v98
    v_dot2c_f32_bf16 v253, s37, v98
    v_dot2c_f32_bf16 v254, s36, v99
    v_dot2c_f32_bf16 v255, s37, v99
    v_dot2c_f32_bf16 v248, s36, v104
    v_dot2c_f32_bf16 v249, s37, v104
    v_dot2c_f32_bf16 v250, s36, v105
    v_dot2c_f32_bf16 v251, s37, v105
    v_dot2c_f32_bf16 v252, s36, v106
    v_dot2c_f32_bf16 v253, s37, v106
    v_dot2c_f32_bf16 v254, s36, v107
    v_dot2c_f32_bf16 v255, s37, v107
.p2align 3
    v_pk_add_f32 v[140:141], v[232:233], v[234:235]
    v_pk_add_f32 v[142:143], v[236:237], v[238:239]
    v_pk_mul_f32 v[144:145], v[232:233], v[232:233]
    v_pk_mul_f32 v[146:147], v[236:237], v[236:237]
    v_pk_fma_f32 v[144:145], v[234:235], v[234:235], v[144:145]
    v_pk_fma_f32 v[146:147], v[238:239], v[238:239], v[146:147]
    v_pk_add_f32 v[140:141], v[140:141], v[240:241]
    v_pk_add_f32 v[142:143], v[142:143], v[244:245]
    v_pk_fma_f32 v[144:145], v[240:241], v[240:241], v[144:145]
    v_pk_fma_f32 v[146:147], v[244:245], v[244:245], v[146:147]
    v_pk_add_f32 v[140:141], v[140:141], v[242:243]
    v_pk_add_f32 v[142:143], v[142:143], v[246:247]
    v_pk_fma_f32 v[144:145], v[242:243], v[242:243], v[144:145]
    v_pk_fma_f32 v[146:147], v[246:247], v[246:247], v[146:147]
    s_waitcnt vmcnt(1)
    v_dot2c_f32_bf16 v248, s36, v112
    v_dot2c_f32_bf16 v249, s37, v112
    v_dot2c_f32_bf16 v250, s36, v113
    v_dot2c_f32_bf16 v251, s37, v113
    v_dot2c_f32_bf16 v252, s36, v114
    v_dot2c_f32_bf16 v253, s37, v114
    v_dot2c_f32_bf16 v254, s36, v115
    v_dot2c_f32_bf16 v255, s37, v115
    v_pk_fma_f32 v[248:249], v[248:249], v[182:183], v[200:201] op_sel_hi:[1,0,1]
    v_pk_fma_f32 v[250:251], v[250:251], v[182:183], v[202:203] op_sel_hi:[1,0,1]
    v_pk_fma_f32 v[252:253], v[252:253], v[182:183], v[204:205] op_sel_hi:[1,0,1]
    v_pk_fma_f32 v[254:255], v[254:255], v[182:183], v[206:207] op_sel_hi:[1,0,1]
    v_cvt_pk_bf16_f32 v154, v248, v249
    v_cvt_pk_bf16_f32 v155, v250, v251
    v_cvt_pk_bf16_f32 v158, v252, v253
    v_cvt_pk_bf16_f32 v159, v254, v255
    buffer_store_dwordx4 v[152:155], v5, s[4:7], s54 offen sc1
    buffer_store_dwordx4 v[156:159], v5, s[4:7], s54 offen offset:256 sc1
.p2align 3
    v_pk_add_f32 v[140:141], v[140:141], v[248:249]
    v_pk_add_f32 v[142:143], v[142:143], v[252:253]
    v_pk_fma_f32 v[144:145], v[248:249], v[248:249], v[144:145]
    v_pk_fma_f32 v[146:147], v[252:253], v[252:253], v[146:147]
    v_pk_add_f32 v[140:141], v[140:141], v[250:251]
    v_pk_add_f32 v[142:143], v[142:143], v[254:255]
    v_pk_fma_f32 v[144:145], v[250:251], v[250:251], v[144:145]
    v_pk_fma_f32 v[146:147], v[254:255], v[254:255], v[146:147]
    v_add_f32 v140, v140, v141
    v_add_f32 v142, v142, v143
    v_add_f32 v144, v144, v145
    v_add_f32 v146, v146, v147
    v_permlane16_swap_b32 v140, v142
    s_nop 0
    v_permlane16_swap_b32 v144, v146
    v_add_f32 v140, v140, v142
    v_add_f32 v144, v144, v146
    s_nop 1
    v_permlane32_swap_b32 v140, v144
    v_add_f32 v140, v140, v144
    buffer_store_dword v140, v4, s[4:7], s34 offen sc1
    s_mov_b32 s22, 1
    s_cmp_eq_u32 s16, 0
    s_cselect_b32 s56, 0, 16
    s_mov_b32 s21, 33554432
    s_add_u32 s28, s28, 48
    s_add_u32 s29, s29, 48
    s_add_u32 s12, s12, 48
    s_addc_u32 s13, s13, 0
    s_waitcnt lgkmcnt(0)
    s_branch L_main_layer
L_main_fin:
L_main_end:
    s_endpgm
L_inte_chk_15_slow:
L_inte_poll_42:
    s_load_dword s57, s[12:13], 140 glc
    s_waitcnt lgkmcnt(0)
    s_cmp_ge_u32 s57, 18
    s_cbranch_scc1 L_inte_poll_42_x
    s_sub_u32 s27, s27, 1
    s_cmp_gt_i32 s27, 0
    s_cbranch_scc1 L_inte_poll_42
L_inte_poll_42_x:
    s_branch L_inte_chk_15_back
L_inte_chk_28_slow:
L_inte_poll_43:
    s_load_dword s57, s[12:13], 20 glc
    s_waitcnt lgkmcnt(0)
    s_cmp_ge_u32 s57, 12
    s_cbranch_scc1 L_inte_poll_43_x
    s_sub_u32 s27, s27, 1
    s_cmp_gt_i32 s27, 0
    s_cbranch_scc1 L_inte_poll_43
L_inte_poll_43_x:
    s_branch L_inte_chk_28_back
L_inte_chk_29_slow:
L_inte_poll_44:
    s_load_dword s57, s[12:13], 24 glc
    s_waitcnt lgkmcnt(0)
    s_cmp_ge_u32 s57, 12
    s_cbranch_scc1 L_inte_poll_44_x
    s_sub_u32 s27, s27, 1
    s_cmp_gt_i32 s27, 0
    s_cbranch_scc1 L_inte_poll_44
L_inte_poll_44_x:
    s_branch L_inte_chk_29_back
L_inte_chk_30_slow:
L_inte_poll_45:
    s_load_dword s57, s[12:13], 28 glc
    s_waitcnt lgkmcnt(0)
    s_cmp_ge_u32 s57, 12
    s_cbranch_scc1 L_inte_poll_45_x
    s_sub_u32 s27, s27, 1
    s_cmp_gt_i32 s27, 0
    s_cbranch_scc1 L_inte_poll_45
L_inte_poll_45_x:
    s_branch L_inte_chk_30_back
L_inte_chk_31_slow:
L_inte_poll_46:
    s_load_dword s57, s[12:13], 32 glc
    s_waitcnt lgkmcnt(0)
    s_cmp_ge_u32 s57, 12
    s_cbranch_scc1 L_inte_poll_46_x
    s_sub_u32 s27, s27, 1
    s_cmp_gt_i32 s27, 0
    s_cbranch_scc1 L_inte_poll_46
L_inte_poll_46_x:
    s_branch L_inte_chk_31_back
L_inte_chk_32_slow:
L_inte_poll_47:
    s_load_dword s57, s[12:13], 36 glc
    s_waitcnt lgkmcnt(0)
    s_cmp_ge_u32 s57, 12
    s_cbranch_scc1 L_inte_poll_47_x
    s_sub_u32 s27, s27, 1
    s_cmp_gt_i32 s27, 0
    s_cbranch_scc1 L_inte_poll_47
L_inte_poll_47_x:
    s_branch L_inte_chk_32_back
L_inte_chk_33_slow:
L_inte_poll_48:
    s_load_dword s57, s[12:13], 12 glc
    s_waitcnt lgkmcnt(0)
    s_cmp_ge_u32 s57, 12
    s_cbranch_scc1 L_inte_poll_48_x
    s_sub_u32 s27, s27, 1
    s_cmp_gt_i32 s27, 0
    s_cbranch_scc1 L_inte_poll_48
L_inte_poll_48_x:
    s_branch L_inte_chk_33_back
L_inte_side_23:
    s_min_u32 s30, s20, 2
    s_mul_i32 s30, s30, 3072
    s_add_u32 m0, s30, 147456
    s_mul_i32 s31, s17, 9216
    s_add_u32 s30, s30, s31
    s_add_u32 s30, s30, 360448
    buffer_load_dwordx4 v1, s[4:7], s30 offen sc1 lds
    buffer_load_dwordx4 v1, s[4:7], s30 offen offset:1024 sc1 lds
    buffer_load_dwordx4 v1, s[4:7], s30 offen offset:2048 sc1 lds
    s_branch L_inte_side_23_back
L_inte_side_24:
    s_bitcmp0_b32 s24, 2
    s_cbranch_scc1 L_inte_role_25
    buffer_store_dwordx4 v[216:219], v1, s[4:7], s60 offen sc1
    s_add_u32 s60, s60, 4096
    buffer_store_dwordx4 v[220:223], v1, s[4:7], s60 offen sc1
    s_add_u32 s60, s60, 4096
    buffer_store_dwordx4 v[224:227], v1, s[4:7], s60 offen sc1
    s_add_u32 s60, s60, 4096
    buffer_store_dwordx4 v[228:231], v1, s[4:7], s60 offen sc1
    s_add_u32 s60, s60, 4096
    buffer_store_dwordx4 v[232:235], v1, s[4:7], s60 offen sc1
    s_add_u32 s60, s60, 4096
    buffer_store_dwordx4 v[240:243], v1, s[4:7], s60 offen sc1
    buffer_store_dwordx4 v[236:239], v1, s[4:7], s61 offen sc1
    buffer_store_dwordx4 v[244:247], v1, s[4:7], s62 offen sc1
    s_add_u32 s62, s62, 4096
    buffer_store_dwordx4 v[248:251], v1, s[4:7], s62 offen sc1
L_inte_role_25:
    s_branch L_inte_side_24_back
L_inte_side_34:
    s_lshl_b32 s36, s17, 8
    v_lshlrev_b32 v184, 4, v6
    v_and_b32 v185, 2147483648, v6
    v_or_b32 v184, v184, v185
    buffer_atomic_add v10, v184, s[4:7], s36 offen offset:136 sc1
    s_branch L_inte_side_34_back
L_inte_side_35:
    s_load_dword s2, s[12:13], 136 glc
    s_branch L_inte_side_35_back
L_inte_side_36:
    s_waitcnt lgkmcnt(0)
    s_cmp_ge_u32 s2, 16
    s_cbranch_scc1 L_inte_cf_37
L_inte_poll_38:
    s_load_dword s57, s[12:13], 136 glc
    s_waitcnt lgkmcnt(0)
    s_cmp_ge_u32 s57, 16
    s_cbranch_scc1 L_inte_poll_38_x
    s_sub_u32 s27, s27, 1
    s_cmp_gt_i32 s27, 0
    s_cbranch_scc1 L_inte_poll_38
L_inte_poll_38_x:
L_inte_cf_37:
    s_branch L_inte_side_36_back
L_inte_side_41:
    v_and_b32 v20, 31, v0
    v_mul_u32_u24 v20, 1152, v20
    v_lshrrev_b32 v21, 5, v0
    v_lshl_add_u32 v20, v21, 4, v20
    v_and_b32 v21, 2147483648, v19
    v_or_b32 v21, v21, v20
    v_and_b32 v20, 15, v0
    v_mul_u32_u24 v20, 1152, v20
    v_lshrrev_b32 v22, 4, v0
    v_lshl_add_u32 v20, v22, 4, v20
    s_mul_i32 s30, s23, 36864
    s_lshl_b32 s31, s19, 2
    s_add_u32 s31, s31, s18
    s_lshl_b32 s31, s31, 6
    s_add_u32 s31, s31, s30
    s_lshl_b32 s32, s19, 5
    s_add_u32 s30, s30, s32
    s_add_u32 s32, s31, 18432
    s_waitcnt vmcnt(5)
    v_dot2c_f32_bf16 v232, s36, v116
    v_dot2c_f32_bf16 v233, s37, v116
    v_dot2c_f32_bf16 v234, s36, v117
    v_dot2c_f32_bf16 v235, s37, v117
    v_dot2c_f32_bf16 v236, s36, v118
    v_dot2c_f32_bf16 v237, s37, v118
    v_dot2c_f32_bf16 v238, s36, v119
    v_dot2c_f32_bf16 v239, s37, v119
    s_waitcnt vmcnt(4)
    v_dot2c_f32_bf16 v232, s36, v120
    v_dot2c_f32_bf16 v233, s37, v120
    v_dot2c_f32_bf16 v234, s36, v121
    v_dot2c_f32_bf16 v235, s37, v121
    v_dot2c_f32_bf16 v236, s36, v122
    v_dot2c_f32_bf16 v237, s37, v122
    v_dot2c_f32_bf16 v238, s36, v123
    v_dot2c_f32_bf16 v239, s37, v123
    s_waitcnt vmcnt(3)
    v_dot2c_f32_bf16 v232, s36, v124
    v_dot2c_f32_bf16 v233, s37, v124
    v_dot2c_f32_bf16 v234, s36, v125
    v_dot2c_f32_bf16 v235, s37, v125
    v_dot2c_f32_bf16 v236, s36, v126
    v_dot2c_f32_bf16 v237, s37, v126
    v_dot2c_f32_bf16 v238, s36, v127
    v_dot2c_f32_bf16 v239, s37, v127
    v_pk_fma_f32 v[232:233], v[232:233], v[172:173], v[184:185] op_sel_hi:[1,0,1]
    v_pk_fma_f32 v[234:235], v[234:235], v[172:173], v[186:187] op_sel_hi:[1,0,1]
    v_pk_fma_f32 v[236:237], v[236:237], v[172:173], v[188:189] op_sel_hi:[1,0,1]
    v_pk_fma_f32 v[238:239], v[238:239], v[172:173], v[190:191] op_sel_hi:[1,0,1]
    v_cvt_pk_bf16_f32 v148, v232, v233
    v_cvt_pk_bf16_f32 v149, v234, v235
    v_cvt_pk_bf16_f32 v150, v236, v237
    v_cvt_pk_bf16_f32 v151, v238, v239
    s_nop 0
    v_permlane16_swap_b32 v148, v150
    v_permlane16_swap_b32 v149, v151
    buffer_store_dwordx4 v[148:151], v21, s[8:11], s30 offen offset:1024
    v_dot2c_f32_bf16 v240, s36, v92
    v_dot2c_f32_bf16 v241, s37, v92
    v_dot2c_f32_bf16 v242, s36, v93
    v_dot2c_f32_bf16 v243, s37, v93
    v_dot2c_f32_bf16 v244, s36, v94
    v_dot2c_f32_bf16 v245, s37, v94
    v_dot2c_f32_bf16 v246, s36, v95
    v_dot2c_f32_bf16 v247, s37, v95
    v_dot2c_f32_bf16 v240, s36, v100
    v_dot2c_f32_bf16 v241, s37, v100
    v_dot2c_f32_bf16 v242, s36, v101
    v_dot2c_f32_bf16 v243, s37, v101
    v_dot2c_f32_bf16 v244, s36, v102
    v_dot2c_f32_bf16 v245, s37, v102
    v_dot2c_f32_bf16 v246, s36, v103
    v_dot2c_f32_bf16 v247, s37, v103
    v_dot2c_f32_bf16 v240, s36, v108
    v_dot2c_f32_bf16 v241, s37, v108
    v_dot2c_f32_bf16 v242, s36, v109
    v_dot2c_f32_bf16 v243, s37, v109
    v_dot2c_f32_bf16 v244, s36, v110
    v_dot2c_f32_bf16 v245, s37, v110
    v_dot2c_f32_bf16 v246, s36, v111
    v_dot2c_f32_bf16 v247, s37, v111
    v_pk_fma_f32 v[240:241], v[240:241], v[182:183], v[192:193] op_sel_hi:[1,0,1]
    v_pk_fma_f32 v[242:243], v[242:243], v[182:183], v[194:195] op_sel_hi:[1,0,1]
    v_pk_fma_f32 v[244:245], v[244:245], v[182:183], v[196:197] op_sel_hi:[1,0,1]
    v_pk_fma_f32 v[246:247], v[246:247], v[182:183], v[198:199] op_sel_hi:[1,0,1]
    v_cvt_pk_bf16_f32 v152, v240, v241
    v_cvt_pk_bf16_f32 v153, v242, v243
    v_cvt_pk_bf16_f32 v156, v244, v245
    v_cvt_pk_bf16_f32 v157, v246, v247
    v_dot2c_f32_bf16 v248, s36, v96
    v_dot2c_f32_bf16 v249, s37, v96
    v_dot2c_f32_bf16 v250, s36, v97
    v_dot2c_f32_bf16 v251, s37, v97
    v_dot2c_f32_bf16 v252, s36, v98
    v_dot2c_f32_bf16 v253, s37, v98
    v_dot2c_f32_bf16 v254, s36, v99
    v_dot2c_f32_bf16 v255, s37, v99
    v_dot2c_f32_bf16 v248, s36, v104
    v_dot2c_f32_bf16 v249, s37, v104
    v_dot2c_f32_bf16 v250, s36, v105
    v_dot2c_f32_bf16 v251, s37, v105
    v_dot2c_f32_bf16 v252, s36, v106
    v_dot2c_f32_bf16 v253, s37, v106
    v_dot2c_f32_bf16 v254, s36, v107
    v_dot2c_f32_bf16 v255, s37, v107
    s_waitcnt vmcnt(1)
    v_dot2c_f32_bf16 v248, s36, v112
    v_dot2c_f32_bf16 v249, s37, v112
    v_dot2c_f32_bf16 v250, s36, v113
    v_dot2c_f32_bf16 v251, s37, v113
    v_dot2c_f32_bf16 v252, s36, v114
    v_dot2c_f32_bf16 v253, s37, v114
    v_dot2c_f32_bf16 v254, s36, v115
    v_dot2c_f32_bf16 v255, s37, v115
    v_pk_fma_f32 v[248:249], v[248:249], v[182:183], v[200:201] op_sel_hi:[1,0,1]
    v_pk_fma_f32 v[250:251], v[250:251], v[182:183], v[202:203] op_sel_hi:[1,0,1]
    v_pk_fma_f32 v[252:253], v[252:253], v[182:183], v[204:205] op_sel_hi:[1,0,1]
    v_pk_fma_f32 v[254:255], v[254:255], v[182:183], v[206:207] op_sel_hi:[1,0,1]
    v_cvt_pk_bf16_f32 v154, v248, v249
    v_cvt_pk_bf16_f32 v155, v250, v251
    v_cvt_pk_bf16_f32 v158, v252, v253
    v_cvt_pk_bf16_f32 v159, v254, v255
    buffer_store_dwordx4 v[152:155], v20, s[8:11], s31 offen
    buffer_store_dwordx4 v[156:159], v20, s[8:11], s32 offen
    s_branch L_main_fin
L_code_end:
.section .rodata,"a"
.p2align 6
.amdhsa_kernel interleave_layers__sliding_local_dilated__dense_activation_mish__prompt_kernel
  .amdhsa_next_free_vgpr 512
  .amdhsa_next_free_sgpr 102
  .amdhsa_accum_offset 256
  .amdhsa_group_segment_fixed_size 0
  .amdhsa_kernarg_size 80
  .amdhsa_user_sgpr_count 2
  .amdhsa_user_sgpr_kernarg_segment_ptr 1
  .amdhsa_system_sgpr_workgroup_id_x 1
.end_amdhsa_kernel
```
